```python
import torch

def _softmax(x, axis=-1):
    return torch.softmax(x, dim=axis)
def _gelu(x):
    return torch.nn.functional.gelu(x, approximate="tanh")
def _silu(x):
    return torch.nn.functional.silu(x)
def _sigmoid(x):
    return torch.sigmoid(x)
def _layernorm(x, axis=-1, eps=1e-5):
    m = x.mean(dim=axis, keepdim=True)
    v = x.var(dim=axis, keepdim=True, unbiased=False)
    return (x - m) / torch.sqrt(v + eps)
def _scatter_add(tgt, idx, src, axis=0):
    return tgt.clone().index_add_(axis, idx, src)
def _segment_sum(src, seg, n):
    out = torch.zeros((n,) + src.shape[1:], dtype=src.dtype)
    return out.index_add_(0, seg, src)
def _pad(x, pw):
    flat = tuple(v for pair in reversed(pw) for v in pair)
    return torch.nn.functional.pad(x, flat)

kernel_name = 'concat_heads__mha_block_cached__mha_block_cached__near_ridge'

def setup_inputs():

    _w = (lambda a: (lambda t: t.to(torch.bfloat16) if t.is_floating_point() else t)(torch.as_tensor(a)))
    def _A_setup():
        B, Sq, D = 8, 112, 1024
        H, Sk, Dh = 32, 512, 128
        return {
            "x": _w((lambda *s: torch.randn(*s, dtype=torch.bfloat16) * 0.8)(B, Sq, D)),
            "k_cache": _w((lambda *s: torch.randn(*s, dtype=torch.bfloat16) * 0.8)(B, H, Sk, Dh)),
            "v_cache": _w((lambda *s: torch.randn(*s, dtype=torch.bfloat16) * 0.05)(B, H, Sk, Dh)),
            "wq": _w((lambda *s: torch.randn(*s, dtype=torch.bfloat16) * 0.8)(D, H * Dh) * (D ** -0.5)),
            "wo": _w((lambda *s: torch.randn(*s, dtype=torch.bfloat16) * 0.05)(H * Dh, D) * ((H * Dh) ** -0.5)),
        }
    _A_in = _A_setup()

    def _B_setup():
        B, Sq, D = 8, 112, 1024
        H, Sk, Dh = 32, 512, 128
        return {
            "x": _w((lambda *s: torch.randn(*s, dtype=torch.bfloat16) * 0.8)(B, Sq, D)),
            "k_cache": _w((lambda *s: torch.randn(*s, dtype=torch.bfloat16) * 0.8)(B, H, Sk, Dh)),
            "v_cache": _w((lambda *s: torch.randn(*s, dtype=torch.bfloat16) * 0.05)(B, H, Sk, Dh)),
            "wq": _w((lambda *s: torch.randn(*s, dtype=torch.bfloat16) * 0.8)(D, H * Dh) * (D ** -0.5)),
            "wo": _w((lambda *s: torch.randn(*s, dtype=torch.bfloat16) * 0.05)(H * Dh, D) * ((H * Dh) ** -0.5)),
        }
    _B_in = _B_setup()

    return {
        "A_x": _A_in["x"],
        "A_k_cache": _A_in["k_cache"],
        "A_v_cache": _A_in["v_cache"],
        "A_wq": _A_in["wq"],
        "A_wo": _A_in["wo"],
        "B_x": _B_in["x"],
        "B_k_cache": _B_in["k_cache"],
        "B_v_cache": _B_in["v_cache"],
        "B_wq": _B_in["wq"],
        "B_wo": _B_in["wo"],
    }

def reference(A_x, A_k_cache, A_v_cache, A_wq, A_wo, B_x, B_k_cache, B_v_cache, B_wq, B_wo):
    def _A_ref(x, k_cache, v_cache, wq, wo):
        B, Sq, D = x.shape
        H, Dh = 32, 128
        q = (lambda x, *d: x.permute(*d))((x @ wq).reshape(B, Sq, H, Dh), 0, 2, 1, 3)
        scores = torch.einsum("bhqd,bhkd->bhqk", q, k_cache) * (Dh ** -0.5)
        p = _softmax(scores, axis=-1)
        o = torch.einsum("bhqk,bhkd->bhqd", p, v_cache)
        return (lambda x, *d: x.permute(*d))(o, 0, 2, 1, 3).reshape(B, Sq, H * Dh) @ wo

    def _B_ref(x, k_cache, v_cache, wq, wo):
        B, Sq, D = x.shape
        H, Dh = 32, 128
        q = (lambda x, *d: x.permute(*d))((x @ wq).reshape(B, Sq, H, Dh), 0, 2, 1, 3)
        scores = torch.einsum("bhqd,bhkd->bhqk", q, k_cache) * (Dh ** -0.5)
        p = _softmax(scores, axis=-1)
        o = torch.einsum("bhqk,bhkd->bhqd", p, v_cache)
        return (lambda x, *d: x.permute(*d))(o, 0, 2, 1, 3).reshape(B, Sq, H * Dh) @ wo

    a = _A_ref(A_x, A_k_cache, A_v_cache, A_wq, A_wo)
    b = _B_ref(B_x, B_k_cache, B_v_cache, B_wq, B_wo)
    return torch.concatenate([a, b], axis=-1)
```

```asm
; @launch kernel=attn_kernel grid=(512,1,1) block=(256,1,1) lds=81920
; @launch kernel=oproj_kernel grid=(256,1,1) block=(256,1,1) lds=114688
.amdgcn_target "amdgcn-amd-amdhsa--gfx950"
.text
.globl attn_kernel
.p2align 8
.type attn_kernel,@function
attn_kernel:
    s_cmp_ge_u32 s2, 512
    s_cbranch_scc1 L_attn_done
    s_load_dwordx8 s[44:51], s[0:1], 0
    s_load_dwordx8 s[52:59], s[0:1], 40
    s_load_dwordx2 s[60:61], s[0:1], 96
    s_load_dwordx2 s[62:63], s[0:1], 32
    s_load_dwordx2 s[68:69], s[0:1], 72
    v_lshrrev_b32 v192, 6, v0
    v_and_b32 v251, 63, v0
    s_nop 0
    v_readfirstlane_b32 s24, v192
    s_and_b32 s30, s2, 7
    s_lshr_b32 s31, s2, 3
    s_lshr_b32 s32, s30, 2
    s_and_b32 s33, s30, 3
    s_lshl_b32 s33, s33, 3
    s_and_b32 s34, s31, 7
    s_add_u32 s33, s33, s34
    s_lshr_b32 s34, s31, 3
    s_mul_i32 s25, s34, 229376
    s_lshl_b32 s26, s33, 8
    s_lshl_b32 s27, s34, 5
    s_add_u32 s27, s27, s33
    s_lshl_b32 s27, s27, 17
    s_lshl_b32 s28, s32, 3
    s_add_u32 s28, s28, s34
    s_lshl_b32 s28, s28, 2
    s_add_u32 s28, s28, s24
    s_lshl_b32 s28, s28, 18
    s_lshl_b32 s35, s33, 13
    s_add_u32 s28, s28, s35
    s_lshl_b32 s29, s24, 12
    s_lshl_b32 s36, s24, 11
    s_mov_b32 s42, 0x3e0293ee
    s_add_u32 s43, s33, s34
    s_and_b32 s43, s43, 7
    s_mov_b32 s43, 0
    s_mov_b32 s38, -1
    s_mov_b32 s39, -1
    s_cmp_eq_u32 s24, 3
    s_cselect_b32 s38, 0, s38
    s_cselect_b32 s39, 0, s39
    s_waitcnt lgkmcnt(0)
    s_cmp_eq_u32 s32, 0
    s_cselect_b32 s4, s44, s52
    s_cselect_b32 s5, s45, s53
    s_cselect_b32 s12, s46, s54
    s_cselect_b32 s13, s47, s55
    s_cselect_b32 s16, s48, s56
    s_cselect_b32 s17, s49, s57
    s_cselect_b32 s8, s50, s58
    s_cselect_b32 s9, s51, s59
    s_cselect_b32 s76, s62, s68
    s_cselect_b32 s77, s63, s69
    s_mov_b32 s6, 1835008
    s_mov_b32 s7, 0x00020000
    s_mov_b32 s10, 0x800000
    s_mov_b32 s11, 0x00020000
    s_mov_b32 s14, 0x2000000
    s_mov_b32 s15, 0x00020000
    s_mov_b32 s18, 0x2000000
    s_mov_b32 s19, 0x00020000
    s_mov_b32 s20, s60
    s_mov_b32 s21, s61
    s_mov_b32 s22, 0x1000000
    s_mov_b32 s23, 0x00020000
    s_mov_b32 s78, 0x800000
    s_mov_b32 s79, 0x00020000
    v_lshrrev_b32 v192, 4, v251
    v_and_b32 v193, 15, v251
    v_xor_b32 v194, v192, v193
    v_lshlrev_b32 v195, 8, v192
    v_add_u32 v195, s29, v195
    v_xor_b32 v196, 0, v194
    v_lshl_add_u32 v236, v196, 4, v195
    v_xor_b32 v196, 4, v194
    v_lshl_add_u32 v237, v196, 4, v195
    v_xor_b32 v196, 8, v194
    v_lshl_add_u32 v238, v196, 4, v195
    v_xor_b32 v196, 12, v194
    v_lshl_add_u32 v239, v196, 4, v195
    v_lshlrev_b32 v196, 2, v192
    v_xor_b32 v196, v196, v193
    v_lshl_add_u32 v240, v196, 4, v195
    s_lshl_b32 s30, s24, 17
    v_lshlrev_b32 v195, 13, v192
    v_add_u32 v195, s30, v195
    v_lshl_add_u32 v195, v196, 4, v195
    v_add_u32 v224, 0, v195
    v_add_u32 v225, 31744, v195
    v_add_u32 v226, 63488, v195
    v_add_u32 v227, 95232, v195
    v_and_b32 v192, 31, v251
    v_lshrrev_b32 v193, 5, v251
    v_bfe_u32 v194, v192, 1, 3
    v_xor_b32 v194, v194, v193
    v_lshlrev_b32 v194, 4, v194
    v_lshl_add_u32 v194, v192, 7, v194
    s_add_u32 s30, s29, 49152
    v_add_u32 v194, s30, v194
    v_xor_b32 v243, 0, v194
    v_xor_b32 v244, 32, v194
    v_xor_b32 v245, 64, v194
    v_xor_b32 v246, 96, v194
    v_lshrrev_b32 v194, 3, v251
    v_and_b32 v195, 7, v251
    s_lshl_b32 s31, s24, 16
    v_lshlrev_b32 v194, 11, v194
    v_add_u32 v194, s31, v194
    v_lshrrev_b32 v196, 4, v251
    v_xor_b32 v195, v195, v196
    v_xor_b32 v196, 0, v195
    v_lshl_add_u32 v196, v196, 4, v194
    v_add_u32 v228, 0, v196
    v_xor_b32 v196, 4, v195
    v_lshl_add_u32 v196, v196, 4, v194
    v_add_u32 v229, 15360, v196
    v_xor_b32 v196, 0, v195
    v_lshl_add_u32 v196, v196, 4, v194
    v_add_u32 v230, 30720, v196
    v_xor_b32 v196, 4, v195
    v_lshl_add_u32 v196, v196, 4, v194
    v_add_u32 v231, 46080, v196
    v_bfe_u32 v194, v251, 2, 2
    v_bfe_u32 v195, v251, 4, 1
    v_and_b32 v196, 1, v251
    v_lshl_add_u32 v195, v195, 1, v196
    v_lshl_add_u32 v195, v194, 2, v195
    v_lshlrev_b32 v195, 4, v195
    v_bfe_u32 v196, v251, 1, 1
    v_lshl_add_u32 v195, v196, 3, v195
    v_lshl_add_u32 v195, v194, 8, v195
    v_lshl_add_u32 v195, v193, 11, v195
    v_xor_b32 v232, 0, v195
    v_xor_b32 v233, 64, v195
    v_xor_b32 v234, 128, v195
    v_xor_b32 v235, 192, v195
    v_lshlrev_b32 v241, 10, v193
    v_lshlrev_b32 v242, 4, v251
    v_add_u32 v254, s29, v242
    s_add_u32 m0, s29, 49152
    s_add_u32 s37, s25, 0
    buffer_load_dwordx4 v228, s[4:7], s37 offen offset:0 lds
    buffer_load_dwordx4 v229, s[4:7], s37 offen offset:1024 lds
    s_add_u32 m0, s29, 49152
    s_add_u32 s37, s25, 0
    s_mov_b64 exec, s[38:39]
    buffer_load_dwordx4 v230, s[4:7], s37 offen offset:2048 lds
    buffer_load_dwordx4 v231, s[4:7], s37 offen offset:3072 lds
    s_mov_b64 exec, -1
    s_add_u32 m0, s29, 0
    s_add_u32 s31, s26, 0
    buffer_load_dwordx4 v224, s[8:11], s31 offen offset:0 lds
    buffer_load_dwordx4 v225, s[8:11], s31 offen offset:1024 lds
    s_add_u32 m0, s29, 0
    s_add_u32 s31, s26, 0
    buffer_load_dwordx4 v226, s[8:11], s31 offen offset:2048 lds
    buffer_load_dwordx4 v227, s[8:11], s31 offen offset:3072 lds
    s_add_u32 m0, s29, 65536
    s_add_u32 s37, s25, 128
    buffer_load_dwordx4 v228, s[4:7], s37 offen offset:0 lds
    buffer_load_dwordx4 v229, s[4:7], s37 offen offset:1024 lds
    s_add_u32 m0, s29, 65536
    s_add_u32 s37, s25, 128
    s_mov_b64 exec, s[38:39]
    buffer_load_dwordx4 v230, s[4:7], s37 offen offset:2048 lds
    buffer_load_dwordx4 v231, s[4:7], s37 offen offset:3072 lds
    s_mov_b64 exec, -1
    s_add_u32 m0, s29, 16384
    s_add_u32 s31, s26, 524288
    buffer_load_dwordx4 v224, s[8:11], s31 offen offset:0 lds
    buffer_load_dwordx4 v225, s[8:11], s31 offen offset:1024 lds
    s_add_u32 m0, s29, 16384
    s_add_u32 s31, s26, 524288
    buffer_load_dwordx4 v226, s[8:11], s31 offen offset:2048 lds
    buffer_load_dwordx4 v227, s[8:11], s31 offen offset:3072 lds
    s_add_u32 m0, s29, 32768
    s_add_u32 s31, s26, 1048576
    buffer_load_dwordx4 v224, s[8:11], s31 offen offset:0 lds
    buffer_load_dwordx4 v225, s[8:11], s31 offen offset:1024 lds
    s_add_u32 m0, s29, 32768
    s_add_u32 s31, s26, 1048576
    buffer_load_dwordx4 v226, s[8:11], s31 offen offset:2048 lds
    buffer_load_dwordx4 v227, s[8:11], s31 offen offset:3072 lds
    s_waitcnt vmcnt(12) lgkmcnt(0)
    s_barrier
    ds_read_b128 v[112:115], v243 offset:0
    ds_read_b64_tr_b16 v[192:193], v232 offset:0
    ds_read_b64_tr_b16 v[194:195], v232 offset:1024
    ds_read_b128 v[116:119], v244 offset:0
    ds_read_b64_tr_b16 v[196:197], v233 offset:0
    ds_read_b64_tr_b16 v[198:199], v233 offset:1024
    ds_read_b128 v[120:123], v245 offset:0
    ds_read_b64_tr_b16 v[200:201], v234 offset:0
    ds_read_b64_tr_b16 v[202:203], v234 offset:1024
    ds_read_b128 v[124:127], v246 offset:0
    ds_read_b64_tr_b16 v[204:205], v235 offset:0
    ds_read_b64_tr_b16 v[206:207], v235 offset:1024
    ds_read_b64_tr_b16 v[208:209], v232 offset:4096
    ds_read_b64_tr_b16 v[210:211], v232 offset:5120
    ds_read_b64_tr_b16 v[212:213], v233 offset:4096
    ds_read_b64_tr_b16 v[214:215], v233 offset:5120
    s_waitcnt lgkmcnt(10)
    v_mfma_f32_32x32x16_bf16 v[0:15], v[192:195], v[112:115], 0
    ds_read_b64_tr_b16 v[216:217], v234 offset:4096
    ds_read_b64_tr_b16 v[218:219], v234 offset:5120
    v_mfma_f32_32x32x16_bf16 v[16:31], v[196:199], v[112:115], 0
    ds_read_b64_tr_b16 v[192:193], v235 offset:4096
    ds_read_b64_tr_b16 v[194:195], v235 offset:5120
    s_waitcnt lgkmcnt(8)
    v_mfma_f32_32x32x16_bf16 v[32:47], v[200:203], v[112:115], 0
    ds_read_b64_tr_b16 v[196:197], v232 offset:8192
    ds_read_b64_tr_b16 v[198:199], v232 offset:9216
    v_mfma_f32_32x32x16_bf16 v[48:63], v[204:207], v[112:115], 0
    s_waitcnt lgkmcnt(12)
    s_add_u32 m0, s29, 49152
    s_add_u32 s37, s25, 256
    buffer_load_dwordx4 v228, s[4:7], s37 offen offset:0 lds
    buffer_load_dwordx4 v229, s[4:7], s37 offen offset:1024 lds
    ds_read_b64_tr_b16 v[200:201], v233 offset:8192
    ds_read_b64_tr_b16 v[202:203], v233 offset:9216
    s_waitcnt lgkmcnt(8)
    v_mfma_f32_32x32x16_bf16 v[0:15], v[208:211], v[116:119], v[0:15]
    s_add_u32 m0, s29, 49152
    s_add_u32 s37, s25, 256
    s_mov_b64 exec, s[38:39]
    buffer_load_dwordx4 v230, s[4:7], s37 offen offset:2048 lds
    buffer_load_dwordx4 v231, s[4:7], s37 offen offset:3072 lds
    s_mov_b64 exec, -1
    ds_read_b64_tr_b16 v[204:205], v234 offset:8192
    ds_read_b64_tr_b16 v[206:207], v234 offset:9216
    v_mfma_f32_32x32x16_bf16 v[16:31], v[212:215], v[116:119], v[16:31]
    ds_read_b64_tr_b16 v[208:209], v235 offset:8192
    ds_read_b64_tr_b16 v[210:211], v235 offset:9216
    s_waitcnt lgkmcnt(8)
    v_mfma_f32_32x32x16_bf16 v[32:47], v[216:219], v[116:119], v[32:47]
    ds_read_b64_tr_b16 v[212:213], v232 offset:12288
    ds_read_b64_tr_b16 v[214:215], v232 offset:13312
    v_mfma_f32_32x32x16_bf16 v[48:63], v[192:195], v[116:119], v[48:63]
    ds_read_b64_tr_b16 v[216:217], v233 offset:12288
    ds_read_b64_tr_b16 v[218:219], v233 offset:13312
    s_waitcnt lgkmcnt(8)
    v_mfma_f32_32x32x16_bf16 v[0:15], v[196:199], v[120:123], v[0:15]
    ds_read_b64_tr_b16 v[192:193], v234 offset:12288
    ds_read_b64_tr_b16 v[194:195], v234 offset:13312
    v_mfma_f32_32x32x16_bf16 v[16:31], v[200:203], v[120:123], v[16:31]
    ds_read_b64_tr_b16 v[196:197], v235 offset:12288
    ds_read_b64_tr_b16 v[198:199], v235 offset:13312
    s_waitcnt lgkmcnt(8)
    v_mfma_f32_32x32x16_bf16 v[32:47], v[204:207], v[120:123], v[32:47]
    s_waitcnt vmcnt(8) lgkmcnt(0)
    s_barrier
    ds_read_b128 v[128:131], v243 offset:16384
    ds_read_b64_tr_b16 v[200:201], v232 offset:16384
    ds_read_b64_tr_b16 v[202:203], v232 offset:17408
    v_mfma_f32_32x32x16_bf16 v[48:63], v[208:211], v[120:123], v[48:63]
    s_add_u32 m0, s29, 0
    s_add_u32 s31, s26, 1572864
    buffer_load_dwordx4 v224, s[8:11], s31 offen offset:0 lds
    buffer_load_dwordx4 v225, s[8:11], s31 offen offset:1024 lds
    ds_read_b128 v[132:135], v244 offset:16384
    ds_read_b64_tr_b16 v[204:205], v233 offset:16384
    ds_read_b64_tr_b16 v[206:207], v233 offset:17408
    s_waitcnt lgkmcnt(10)
    v_mfma_f32_32x32x16_bf16 v[0:15], v[212:215], v[124:127], v[0:15]
    s_add_u32 m0, s29, 0
    s_add_u32 s31, s26, 1572864
    buffer_load_dwordx4 v226, s[8:11], s31 offen offset:2048 lds
    buffer_load_dwordx4 v227, s[8:11], s31 offen offset:3072 lds
    ds_read_b128 v[136:139], v245 offset:16384
    ds_read_b64_tr_b16 v[208:209], v234 offset:16384
    ds_read_b64_tr_b16 v[210:211], v234 offset:17408
    v_mfma_f32_32x32x16_bf16 v[16:31], v[216:219], v[124:127], v[16:31]
    ds_read_b128 v[140:143], v246 offset:16384
    ds_read_b64_tr_b16 v[212:213], v235 offset:16384
    ds_read_b64_tr_b16 v[214:215], v235 offset:17408
    s_waitcnt lgkmcnt(12)
    v_mfma_f32_32x32x16_bf16 v[32:47], v[192:195], v[124:127], v[32:47]
    ds_read_b64_tr_b16 v[216:217], v232 offset:20480
    ds_read_b64_tr_b16 v[218:219], v232 offset:21504
    v_mfma_f32_32x32x16_bf16 v[48:63], v[196:199], v[124:127], v[48:63]
    ds_read_b64_tr_b16 v[192:193], v233 offset:20480
    ds_read_b64_tr_b16 v[194:195], v233 offset:21504
    s_waitcnt lgkmcnt(10)
    v_mfma_f32_32x32x16_bf16 v[0:15], v[200:203], v[128:131], v[0:15]
    ds_read_b64_tr_b16 v[196:197], v234 offset:20480
    ds_read_b64_tr_b16 v[198:199], v234 offset:21504
    v_mfma_f32_32x32x16_bf16 v[16:31], v[204:207], v[128:131], v[16:31]
    ds_read_b64_tr_b16 v[200:201], v235 offset:20480
    ds_read_b64_tr_b16 v[202:203], v235 offset:21504
    s_waitcnt lgkmcnt(8)
    v_mfma_f32_32x32x16_bf16 v[32:47], v[208:211], v[128:131], v[32:47]
    ds_read_b64_tr_b16 v[204:205], v232 offset:24576
    ds_read_b64_tr_b16 v[206:207], v232 offset:25600
    v_mfma_f32_32x32x16_bf16 v[48:63], v[212:215], v[128:131], v[48:63]
    s_waitcnt lgkmcnt(12)
    s_add_u32 m0, s29, 65536
    s_add_u32 s37, s25, 384
    buffer_load_dwordx4 v228, s[4:7], s37 offen offset:0 lds
    buffer_load_dwordx4 v229, s[4:7], s37 offen offset:1024 lds
    ds_read_b64_tr_b16 v[208:209], v233 offset:24576
    ds_read_b64_tr_b16 v[210:211], v233 offset:25600
    s_waitcnt lgkmcnt(8)
    v_mfma_f32_32x32x16_bf16 v[0:15], v[216:219], v[132:135], v[0:15]
    s_add_u32 m0, s29, 65536
    s_add_u32 s37, s25, 384
    s_mov_b64 exec, s[38:39]
    buffer_load_dwordx4 v230, s[4:7], s37 offen offset:2048 lds
    buffer_load_dwordx4 v231, s[4:7], s37 offen offset:3072 lds
    s_mov_b64 exec, -1
    ds_read_b64_tr_b16 v[212:213], v234 offset:24576
    ds_read_b64_tr_b16 v[214:215], v234 offset:25600
    v_mfma_f32_32x32x16_bf16 v[16:31], v[192:195], v[132:135], v[16:31]
    ds_read_b64_tr_b16 v[216:217], v235 offset:24576
    ds_read_b64_tr_b16 v[218:219], v235 offset:25600
    s_waitcnt lgkmcnt(8)
    v_mfma_f32_32x32x16_bf16 v[32:47], v[196:199], v[132:135], v[32:47]
    ds_read_b64_tr_b16 v[192:193], v232 offset:28672
    ds_read_b64_tr_b16 v[194:195], v232 offset:29696
    v_mfma_f32_32x32x16_bf16 v[48:63], v[200:203], v[132:135], v[48:63]
    ds_read_b64_tr_b16 v[196:197], v233 offset:28672
    ds_read_b64_tr_b16 v[198:199], v233 offset:29696
    s_waitcnt lgkmcnt(8)
    v_mfma_f32_32x32x16_bf16 v[0:15], v[204:207], v[136:139], v[0:15]
    ds_read_b64_tr_b16 v[200:201], v234 offset:28672
    ds_read_b64_tr_b16 v[202:203], v234 offset:29696
    v_mfma_f32_32x32x16_bf16 v[16:31], v[208:211], v[136:139], v[16:31]
    ds_read_b64_tr_b16 v[204:205], v235 offset:28672
    ds_read_b64_tr_b16 v[206:207], v235 offset:29696
    s_waitcnt lgkmcnt(8)
    v_mfma_f32_32x32x16_bf16 v[32:47], v[212:215], v[136:139], v[32:47]
    s_waitcnt vmcnt(8) lgkmcnt(0)
    s_barrier
    ds_read_b128 v[112:115], v243 offset:0
    ds_read_b64_tr_b16 v[208:209], v232 offset:32768
    ds_read_b64_tr_b16 v[210:211], v232 offset:33792
    v_mfma_f32_32x32x16_bf16 v[48:63], v[216:219], v[136:139], v[48:63]
    s_add_u32 s31, s27, 0
    buffer_load_dwordx4 v[144:147], v236, s[12:15], s31 offen offset:0 nt
    buffer_load_dwordx4 v[148:151], v237, s[12:15], s31 offen offset:1024 nt
    buffer_load_dwordx4 v[152:155], v238, s[12:15], s31 offen offset:2048 nt
    buffer_load_dwordx4 v[156:159], v239, s[12:15], s31 offen offset:3072 nt
    ds_read_b128 v[116:119], v244 offset:0
    ds_read_b64_tr_b16 v[212:213], v233 offset:32768
    ds_read_b64_tr_b16 v[214:215], v233 offset:33792
    s_waitcnt lgkmcnt(10)
    v_mfma_f32_32x32x16_bf16 v[0:15], v[192:195], v[140:143], v[0:15]
    s_add_u32 m0, s29, 16384
    s_add_u32 s31, s26, 2097152
    buffer_load_dwordx4 v224, s[8:11], s31 offen offset:0 lds
    buffer_load_dwordx4 v225, s[8:11], s31 offen offset:1024 lds
    ds_read_b128 v[120:123], v245 offset:0
    ds_read_b64_tr_b16 v[216:217], v234 offset:32768
    ds_read_b64_tr_b16 v[218:219], v234 offset:33792
    v_mfma_f32_32x32x16_bf16 v[16:31], v[196:199], v[140:143], v[16:31]
    s_add_u32 m0, s29, 16384
    s_add_u32 s31, s26, 2097152
    buffer_load_dwordx4 v226, s[8:11], s31 offen offset:2048 lds
    buffer_load_dwordx4 v227, s[8:11], s31 offen offset:3072 lds
    ds_read_b128 v[124:127], v246 offset:0
    ds_read_b64_tr_b16 v[192:193], v235 offset:32768
    ds_read_b64_tr_b16 v[194:195], v235 offset:33792
    s_waitcnt lgkmcnt(12)
    v_mfma_f32_32x32x16_bf16 v[32:47], v[200:203], v[140:143], v[32:47]
    ds_read_b64_tr_b16 v[196:197], v232 offset:36864
    ds_read_b64_tr_b16 v[198:199], v232 offset:37888
    v_mfma_f32_32x32x16_bf16 v[48:63], v[204:207], v[140:143], v[48:63]
    ds_read_b64_tr_b16 v[200:201], v233 offset:36864
    ds_read_b64_tr_b16 v[202:203], v233 offset:37888
    s_waitcnt lgkmcnt(10)
    v_mfma_f32_32x32x16_bf16 v[0:15], v[208:211], v[112:115], v[0:15]
    ds_read_b64_tr_b16 v[204:205], v234 offset:36864
    ds_read_b64_tr_b16 v[206:207], v234 offset:37888
    v_mfma_f32_32x32x16_bf16 v[16:31], v[212:215], v[112:115], v[16:31]
    ds_read_b64_tr_b16 v[208:209], v235 offset:36864
    ds_read_b64_tr_b16 v[210:211], v235 offset:37888
    s_waitcnt lgkmcnt(8)
    v_mfma_f32_32x32x16_bf16 v[32:47], v[216:219], v[112:115], v[32:47]
    ds_read_b64_tr_b16 v[212:213], v232 offset:40960
    ds_read_b64_tr_b16 v[214:215], v232 offset:41984
    v_mfma_f32_32x32x16_bf16 v[48:63], v[192:195], v[112:115], v[48:63]
    s_waitcnt lgkmcnt(12)
    s_add_u32 m0, s29, 49152
    s_add_u32 s37, s25, 512
    buffer_load_dwordx4 v228, s[4:7], s37 offen offset:0 lds
    buffer_load_dwordx4 v229, s[4:7], s37 offen offset:1024 lds
    ds_read_b64_tr_b16 v[216:217], v233 offset:40960
    ds_read_b64_tr_b16 v[218:219], v233 offset:41984
    s_waitcnt lgkmcnt(8)
    v_mfma_f32_32x32x16_bf16 v[0:15], v[196:199], v[116:119], v[0:15]
    s_add_u32 m0, s29, 49152
    s_add_u32 s37, s25, 512
    s_mov_b64 exec, s[38:39]
    buffer_load_dwordx4 v230, s[4:7], s37 offen offset:2048 lds
    buffer_load_dwordx4 v231, s[4:7], s37 offen offset:3072 lds
    s_mov_b64 exec, -1
    ds_read_b64_tr_b16 v[192:193], v234 offset:40960
    ds_read_b64_tr_b16 v[194:195], v234 offset:41984
    v_mfma_f32_32x32x16_bf16 v[16:31], v[200:203], v[116:119], v[16:31]
    ds_read_b64_tr_b16 v[196:197], v235 offset:40960
    ds_read_b64_tr_b16 v[198:199], v235 offset:41984
    s_waitcnt lgkmcnt(8)
    v_mfma_f32_32x32x16_bf16 v[32:47], v[204:207], v[116:119], v[32:47]
    ds_read_b64_tr_b16 v[200:201], v232 offset:45056
    ds_read_b64_tr_b16 v[202:203], v232 offset:46080
    v_mfma_f32_32x32x16_bf16 v[48:63], v[208:211], v[116:119], v[48:63]
    ds_read_b64_tr_b16 v[204:205], v233 offset:45056
    ds_read_b64_tr_b16 v[206:207], v233 offset:46080
    s_waitcnt lgkmcnt(8)
    v_mfma_f32_32x32x16_bf16 v[0:15], v[212:215], v[120:123], v[0:15]
    ds_read_b64_tr_b16 v[208:209], v234 offset:45056
    ds_read_b64_tr_b16 v[210:211], v234 offset:46080
    v_mfma_f32_32x32x16_bf16 v[16:31], v[216:219], v[120:123], v[16:31]
    ds_read_b64_tr_b16 v[212:213], v235 offset:45056
    ds_read_b64_tr_b16 v[214:215], v235 offset:46080
    s_waitcnt lgkmcnt(8)
    v_mfma_f32_32x32x16_bf16 v[32:47], v[192:195], v[120:123], v[32:47]
    s_waitcnt vmcnt(12) lgkmcnt(0)
    s_barrier
    ds_read_b128 v[128:131], v243 offset:16384
    ds_read_b64_tr_b16 v[216:217], v232 offset:0
    ds_read_b64_tr_b16 v[218:219], v232 offset:1024
    v_mfma_f32_32x32x16_bf16 v[48:63], v[196:199], v[120:123], v[48:63]
    s_add_u32 m0, s29, 32768
    s_add_u32 s31, s26, 2621440
    buffer_load_dwordx4 v224, s[8:11], s31 offen offset:0 lds
    buffer_load_dwordx4 v225, s[8:11], s31 offen offset:1024 lds
    ds_read_b128 v[132:135], v244 offset:16384
    ds_read_b64_tr_b16 v[192:193], v233 offset:0
    ds_read_b64_tr_b16 v[194:195], v233 offset:1024
    s_waitcnt lgkmcnt(10)
    v_mfma_f32_32x32x16_bf16 v[0:15], v[200:203], v[124:127], v[0:15]
    s_add_u32 m0, s29, 32768
    s_add_u32 s31, s26, 2621440
    buffer_load_dwordx4 v226, s[8:11], s31 offen offset:2048 lds
    buffer_load_dwordx4 v227, s[8:11], s31 offen offset:3072 lds
    ds_read_b128 v[136:139], v245 offset:16384
    ds_read_b64_tr_b16 v[196:197], v234 offset:0
    ds_read_b64_tr_b16 v[198:199], v234 offset:1024
    v_mfma_f32_32x32x16_bf16 v[16:31], v[204:207], v[124:127], v[16:31]
    ds_read_b128 v[140:143], v246 offset:16384
    ds_read_b64_tr_b16 v[200:201], v235 offset:0
    ds_read_b64_tr_b16 v[202:203], v235 offset:1024
    s_waitcnt lgkmcnt(12)
    v_mfma_f32_32x32x16_bf16 v[32:47], v[208:211], v[124:127], v[32:47]
    ds_read_b64_tr_b16 v[204:205], v232 offset:4096
    ds_read_b64_tr_b16 v[206:207], v232 offset:5120
    v_mfma_f32_32x32x16_bf16 v[48:63], v[212:215], v[124:127], v[48:63]
    ds_read_b64_tr_b16 v[208:209], v233 offset:4096
    ds_read_b64_tr_b16 v[210:211], v233 offset:5120
    s_waitcnt lgkmcnt(10)
    v_mfma_f32_32x32x16_bf16 v[0:15], v[216:219], v[128:131], v[0:15]
    ds_read_b64_tr_b16 v[212:213], v234 offset:4096
    ds_read_b64_tr_b16 v[214:215], v234 offset:5120
    v_mfma_f32_32x32x16_bf16 v[16:31], v[192:195], v[128:131], v[16:31]
    ds_read_b64_tr_b16 v[216:217], v235 offset:4096
    ds_read_b64_tr_b16 v[218:219], v235 offset:5120
    s_waitcnt lgkmcnt(8)
    v_mfma_f32_32x32x16_bf16 v[32:47], v[196:199], v[128:131], v[32:47]
    ds_read_b64_tr_b16 v[192:193], v232 offset:8192
    ds_read_b64_tr_b16 v[194:195], v232 offset:9216
    v_mfma_f32_32x32x16_bf16 v[48:63], v[200:203], v[128:131], v[48:63]
    s_waitcnt lgkmcnt(12)
    s_add_u32 m0, s29, 65536
    s_add_u32 s37, s25, 640
    buffer_load_dwordx4 v228, s[4:7], s37 offen offset:0 lds
    buffer_load_dwordx4 v229, s[4:7], s37 offen offset:1024 lds
    ds_read_b64_tr_b16 v[196:197], v233 offset:8192
    ds_read_b64_tr_b16 v[198:199], v233 offset:9216
    s_waitcnt lgkmcnt(8)
    v_mfma_f32_32x32x16_bf16 v[0:15], v[204:207], v[132:135], v[0:15]
    s_add_u32 m0, s29, 65536
    s_add_u32 s37, s25, 640
    s_mov_b64 exec, s[38:39]
    buffer_load_dwordx4 v230, s[4:7], s37 offen offset:2048 lds
    buffer_load_dwordx4 v231, s[4:7], s37 offen offset:3072 lds
    s_mov_b64 exec, -1
    ds_read_b64_tr_b16 v[200:201], v234 offset:8192
    ds_read_b64_tr_b16 v[202:203], v234 offset:9216
    v_mfma_f32_32x32x16_bf16 v[16:31], v[208:211], v[132:135], v[16:31]
    ds_read_b64_tr_b16 v[204:205], v235 offset:8192
    ds_read_b64_tr_b16 v[206:207], v235 offset:9216
    s_waitcnt lgkmcnt(8)
    v_mfma_f32_32x32x16_bf16 v[32:47], v[212:215], v[132:135], v[32:47]
    ds_read_b64_tr_b16 v[208:209], v232 offset:12288
    ds_read_b64_tr_b16 v[210:211], v232 offset:13312
    v_mfma_f32_32x32x16_bf16 v[48:63], v[216:219], v[132:135], v[48:63]
    ds_read_b64_tr_b16 v[212:213], v233 offset:12288
    ds_read_b64_tr_b16 v[214:215], v233 offset:13312
    s_waitcnt lgkmcnt(8)
    v_mfma_f32_32x32x16_bf16 v[0:15], v[192:195], v[136:139], v[0:15]
    ds_read_b64_tr_b16 v[216:217], v234 offset:12288
    ds_read_b64_tr_b16 v[218:219], v234 offset:13312
    v_mfma_f32_32x32x16_bf16 v[16:31], v[196:199], v[136:139], v[16:31]
    ds_read_b64_tr_b16 v[192:193], v235 offset:12288
    ds_read_b64_tr_b16 v[194:195], v235 offset:13312
    s_waitcnt lgkmcnt(8)
    v_mfma_f32_32x32x16_bf16 v[32:47], v[200:203], v[136:139], v[32:47]
    s_waitcnt vmcnt(8) lgkmcnt(0)
    s_barrier
    ds_read_b128 v[112:115], v243 offset:0
    ds_read_b64_tr_b16 v[196:197], v232 offset:16384
    ds_read_b64_tr_b16 v[198:199], v232 offset:17408
    v_mfma_f32_32x32x16_bf16 v[48:63], v[204:207], v[136:139], v[48:63]
    s_add_u32 s31, s27, 16384
    buffer_load_dwordx4 v[160:163], v236, s[12:15], s31 offen offset:0 nt
    buffer_load_dwordx4 v[164:167], v237, s[12:15], s31 offen offset:1024 nt
    buffer_load_dwordx4 v[168:171], v238, s[12:15], s31 offen offset:2048 nt
    buffer_load_dwordx4 v[172:175], v239, s[12:15], s31 offen offset:3072 nt
    ds_read_b128 v[116:119], v244 offset:0
    ds_read_b64_tr_b16 v[200:201], v233 offset:16384
    ds_read_b64_tr_b16 v[202:203], v233 offset:17408
    s_waitcnt lgkmcnt(10)
    v_mfma_f32_32x32x16_bf16 v[0:15], v[208:211], v[140:143], v[0:15]
    s_add_u32 m0, s29, 0
    s_add_u32 s31, s26, 3145728
    buffer_load_dwordx4 v224, s[8:11], s31 offen offset:0 lds
    buffer_load_dwordx4 v225, s[8:11], s31 offen offset:1024 lds
    ds_read_b128 v[120:123], v245 offset:0
    ds_read_b64_tr_b16 v[204:205], v234 offset:16384
    ds_read_b64_tr_b16 v[206:207], v234 offset:17408
    v_mfma_f32_32x32x16_bf16 v[16:31], v[212:215], v[140:143], v[16:31]
    s_add_u32 m0, s29, 0
    s_add_u32 s31, s26, 3145728
    buffer_load_dwordx4 v226, s[8:11], s31 offen offset:2048 lds
    buffer_load_dwordx4 v227, s[8:11], s31 offen offset:3072 lds
    ds_read_b128 v[124:127], v246 offset:0
    ds_read_b64_tr_b16 v[208:209], v235 offset:16384
    ds_read_b64_tr_b16 v[210:211], v235 offset:17408
    s_waitcnt lgkmcnt(12)
    v_mfma_f32_32x32x16_bf16 v[32:47], v[216:219], v[140:143], v[32:47]
    ds_read_b64_tr_b16 v[212:213], v232 offset:20480
    ds_read_b64_tr_b16 v[214:215], v232 offset:21504
    v_mfma_f32_32x32x16_bf16 v[48:63], v[192:195], v[140:143], v[48:63]
    ds_read_b64_tr_b16 v[216:217], v233 offset:20480
    ds_read_b64_tr_b16 v[218:219], v233 offset:21504
    s_waitcnt lgkmcnt(10)
    v_mfma_f32_32x32x16_bf16 v[0:15], v[196:199], v[112:115], v[0:15]
    ds_read_b64_tr_b16 v[192:193], v234 offset:20480
    ds_read_b64_tr_b16 v[194:195], v234 offset:21504
    v_mfma_f32_32x32x16_bf16 v[16:31], v[200:203], v[112:115], v[16:31]
    ds_read_b64_tr_b16 v[196:197], v235 offset:20480
    ds_read_b64_tr_b16 v[198:199], v235 offset:21504
    s_waitcnt lgkmcnt(8)
    v_mfma_f32_32x32x16_bf16 v[32:47], v[204:207], v[112:115], v[32:47]
    ds_read_b64_tr_b16 v[200:201], v232 offset:24576
    ds_read_b64_tr_b16 v[202:203], v232 offset:25600
    v_mfma_f32_32x32x16_bf16 v[48:63], v[208:211], v[112:115], v[48:63]
    s_waitcnt lgkmcnt(12)
    s_add_u32 m0, s29, 49152
    s_add_u32 s37, s25, 768
    buffer_load_dwordx4 v228, s[4:7], s37 offen offset:0 lds
    buffer_load_dwordx4 v229, s[4:7], s37 offen offset:1024 lds
    ds_read_b64_tr_b16 v[204:205], v233 offset:24576
    ds_read_b64_tr_b16 v[206:207], v233 offset:25600
    s_waitcnt lgkmcnt(8)
    v_mfma_f32_32x32x16_bf16 v[0:15], v[212:215], v[116:119], v[0:15]
    s_add_u32 m0, s29, 49152
    s_add_u32 s37, s25, 768
    s_mov_b64 exec, s[38:39]
    buffer_load_dwordx4 v230, s[4:7], s37 offen offset:2048 lds
    buffer_load_dwordx4 v231, s[4:7], s37 offen offset:3072 lds
    s_mov_b64 exec, -1
    ds_read_b64_tr_b16 v[208:209], v234 offset:24576
    ds_read_b64_tr_b16 v[210:211], v234 offset:25600
    v_mfma_f32_32x32x16_bf16 v[16:31], v[216:219], v[116:119], v[16:31]
    ds_read_b64_tr_b16 v[212:213], v235 offset:24576
    ds_read_b64_tr_b16 v[214:215], v235 offset:25600
    s_waitcnt lgkmcnt(8)
    v_mfma_f32_32x32x16_bf16 v[32:47], v[192:195], v[116:119], v[32:47]
    ds_read_b64_tr_b16 v[216:217], v232 offset:28672
    ds_read_b64_tr_b16 v[218:219], v232 offset:29696
    v_mfma_f32_32x32x16_bf16 v[48:63], v[196:199], v[116:119], v[48:63]
    ds_read_b64_tr_b16 v[192:193], v233 offset:28672
    ds_read_b64_tr_b16 v[194:195], v233 offset:29696
    s_waitcnt lgkmcnt(8)
    v_mfma_f32_32x32x16_bf16 v[0:15], v[200:203], v[120:123], v[0:15]
    ds_read_b64_tr_b16 v[196:197], v234 offset:28672
    ds_read_b64_tr_b16 v[198:199], v234 offset:29696
    v_mfma_f32_32x32x16_bf16 v[16:31], v[204:207], v[120:123], v[16:31]
    ds_read_b64_tr_b16 v[200:201], v235 offset:28672
    ds_read_b64_tr_b16 v[202:203], v235 offset:29696
    s_waitcnt lgkmcnt(8)
    v_mfma_f32_32x32x16_bf16 v[32:47], v[208:211], v[120:123], v[32:47]
    s_waitcnt vmcnt(12) lgkmcnt(0)
    s_barrier
    ds_read_b128 v[128:131], v243 offset:16384
    ds_read_b64_tr_b16 v[204:205], v232 offset:32768
    ds_read_b64_tr_b16 v[206:207], v232 offset:33792
    v_mfma_f32_32x32x16_bf16 v[48:63], v[212:215], v[120:123], v[48:63]
    s_add_u32 m0, s29, 16384
    s_add_u32 s31, s26, 3670016
    buffer_load_dwordx4 v224, s[8:11], s31 offen offset:0 lds
    buffer_load_dwordx4 v225, s[8:11], s31 offen offset:1024 lds
    ds_read_b128 v[132:135], v244 offset:16384
    ds_read_b64_tr_b16 v[208:209], v233 offset:32768
    ds_read_b64_tr_b16 v[210:211], v233 offset:33792
    s_waitcnt lgkmcnt(10)
    v_mfma_f32_32x32x16_bf16 v[0:15], v[216:219], v[124:127], v[0:15]
    s_add_u32 m0, s29, 16384
    s_add_u32 s31, s26, 3670016
    buffer_load_dwordx4 v226, s[8:11], s31 offen offset:2048 lds
    buffer_load_dwordx4 v227, s[8:11], s31 offen offset:3072 lds
    ds_read_b128 v[136:139], v245 offset:16384
    ds_read_b64_tr_b16 v[212:213], v234 offset:32768
    ds_read_b64_tr_b16 v[214:215], v234 offset:33792
    v_mfma_f32_32x32x16_bf16 v[16:31], v[192:195], v[124:127], v[16:31]
    ds_read_b128 v[140:143], v246 offset:16384
    ds_read_b64_tr_b16 v[216:217], v235 offset:32768
    ds_read_b64_tr_b16 v[218:219], v235 offset:33792
    s_waitcnt lgkmcnt(12)
    v_mfma_f32_32x32x16_bf16 v[32:47], v[196:199], v[124:127], v[32:47]
    ds_read_b64_tr_b16 v[192:193], v232 offset:36864
    ds_read_b64_tr_b16 v[194:195], v232 offset:37888
    v_mfma_f32_32x32x16_bf16 v[48:63], v[200:203], v[124:127], v[48:63]
    ds_read_b64_tr_b16 v[196:197], v233 offset:36864
    ds_read_b64_tr_b16 v[198:199], v233 offset:37888
    s_waitcnt lgkmcnt(10)
    v_mfma_f32_32x32x16_bf16 v[0:15], v[204:207], v[128:131], v[0:15]
    ds_read_b64_tr_b16 v[200:201], v234 offset:36864
    ds_read_b64_tr_b16 v[202:203], v234 offset:37888
    v_mfma_f32_32x32x16_bf16 v[16:31], v[208:211], v[128:131], v[16:31]
    ds_read_b64_tr_b16 v[204:205], v235 offset:36864
    ds_read_b64_tr_b16 v[206:207], v235 offset:37888
    s_waitcnt lgkmcnt(8)
    v_mfma_f32_32x32x16_bf16 v[32:47], v[212:215], v[128:131], v[32:47]
    ds_read_b64_tr_b16 v[208:209], v232 offset:40960
    ds_read_b64_tr_b16 v[210:211], v232 offset:41984
    v_mfma_f32_32x32x16_bf16 v[48:63], v[216:219], v[128:131], v[48:63]
    s_waitcnt lgkmcnt(12)
    s_add_u32 m0, s29, 65536
    s_add_u32 s37, s25, 896
    buffer_load_dwordx4 v228, s[4:7], s37 offen offset:0 lds
    buffer_load_dwordx4 v229, s[4:7], s37 offen offset:1024 lds
    ds_read_b64_tr_b16 v[212:213], v233 offset:40960
    ds_read_b64_tr_b16 v[214:215], v233 offset:41984
    s_waitcnt lgkmcnt(8)
    v_mfma_f32_32x32x16_bf16 v[0:15], v[192:195], v[132:135], v[0:15]
    s_add_u32 m0, s29, 65536
    s_add_u32 s37, s25, 896
    s_mov_b64 exec, s[38:39]
    buffer_load_dwordx4 v230, s[4:7], s37 offen offset:2048 lds
    buffer_load_dwordx4 v231, s[4:7], s37 offen offset:3072 lds
    s_mov_b64 exec, -1
    ds_read_b64_tr_b16 v[216:217], v234 offset:40960
    ds_read_b64_tr_b16 v[218:219], v234 offset:41984
    v_mfma_f32_32x32x16_bf16 v[16:31], v[196:199], v[132:135], v[16:31]
    ds_read_b64_tr_b16 v[192:193], v235 offset:40960
    ds_read_b64_tr_b16 v[194:195], v235 offset:41984
    s_waitcnt lgkmcnt(8)
    v_mfma_f32_32x32x16_bf16 v[32:47], v[200:203], v[132:135], v[32:47]
    ds_read_b64_tr_b16 v[196:197], v232 offset:45056
    ds_read_b64_tr_b16 v[198:199], v232 offset:46080
    v_mfma_f32_32x32x16_bf16 v[48:63], v[204:207], v[132:135], v[48:63]
    ds_read_b64_tr_b16 v[200:201], v233 offset:45056
    ds_read_b64_tr_b16 v[202:203], v233 offset:46080
    s_waitcnt lgkmcnt(8)
    v_mfma_f32_32x32x16_bf16 v[0:15], v[208:211], v[136:139], v[0:15]
    ds_read_b64_tr_b16 v[204:205], v234 offset:45056
    ds_read_b64_tr_b16 v[206:207], v234 offset:46080
    v_mfma_f32_32x32x16_bf16 v[16:31], v[212:215], v[136:139], v[16:31]
    ds_read_b64_tr_b16 v[208:209], v235 offset:45056
    ds_read_b64_tr_b16 v[210:211], v235 offset:46080
    s_waitcnt lgkmcnt(8)
    v_mfma_f32_32x32x16_bf16 v[32:47], v[216:219], v[136:139], v[32:47]
    s_waitcnt vmcnt(8) lgkmcnt(0)
    s_barrier
    ds_read_b128 v[112:115], v243 offset:0
    ds_read_b64_tr_b16 v[212:213], v232 offset:0
    ds_read_b64_tr_b16 v[214:215], v232 offset:1024
    v_mfma_f32_32x32x16_bf16 v[48:63], v[192:195], v[136:139], v[48:63]
    s_add_u32 s31, s27, 0
    buffer_load_dwordx4 v[176:179], v240, s[16:19], s31 offen offset:0 nt
    buffer_load_dwordx4 v[180:183], v240, s[16:19], s31 offen offset:1024 nt
    buffer_load_dwordx4 v[184:187], v240, s[16:19], s31 offen offset:2048 nt
    buffer_load_dwordx4 v[188:191], v240, s[16:19], s31 offen offset:3072 nt
    ds_read_b128 v[116:119], v244 offset:0
    ds_read_b64_tr_b16 v[216:217], v233 offset:0
    ds_read_b64_tr_b16 v[218:219], v233 offset:1024
    s_waitcnt lgkmcnt(10)
    v_mfma_f32_32x32x16_bf16 v[0:15], v[196:199], v[140:143], v[0:15]
    s_add_u32 m0, s29, 32768
    s_add_u32 s31, s26, 4194304
    buffer_load_dwordx4 v224, s[8:11], s31 offen offset:0 lds
    buffer_load_dwordx4 v225, s[8:11], s31 offen offset:1024 lds
    ds_read_b128 v[120:123], v245 offset:0
    ds_read_b64_tr_b16 v[192:193], v234 offset:0
    ds_read_b64_tr_b16 v[194:195], v234 offset:1024
    v_mfma_f32_32x32x16_bf16 v[16:31], v[200:203], v[140:143], v[16:31]
    s_add_u32 m0, s29, 32768
    s_add_u32 s31, s26, 4194304
    buffer_load_dwordx4 v226, s[8:11], s31 offen offset:2048 lds
    buffer_load_dwordx4 v227, s[8:11], s31 offen offset:3072 lds
    ds_read_b128 v[124:127], v246 offset:0
    ds_read_b64_tr_b16 v[196:197], v235 offset:0
    ds_read_b64_tr_b16 v[198:199], v235 offset:1024
    s_waitcnt lgkmcnt(12)
    v_mfma_f32_32x32x16_bf16 v[32:47], v[204:207], v[140:143], v[32:47]
    ds_read_b64_tr_b16 v[200:201], v232 offset:4096
    ds_read_b64_tr_b16 v[202:203], v232 offset:5120
    v_mfma_f32_32x32x16_bf16 v[48:63], v[208:211], v[140:143], v[48:63]
    ds_read_b64_tr_b16 v[204:205], v233 offset:4096
    ds_read_b64_tr_b16 v[206:207], v233 offset:5120
    s_waitcnt lgkmcnt(10)
    v_mfma_f32_32x32x16_bf16 v[0:15], v[212:215], v[112:115], v[0:15]
    ds_read_b64_tr_b16 v[208:209], v234 offset:4096
    ds_read_b64_tr_b16 v[210:211], v234 offset:5120
    v_mfma_f32_32x32x16_bf16 v[16:31], v[216:219], v[112:115], v[16:31]
    ds_read_b64_tr_b16 v[212:213], v235 offset:4096
    ds_read_b64_tr_b16 v[214:215], v235 offset:5120
    s_waitcnt lgkmcnt(8)
    v_mfma_f32_32x32x16_bf16 v[32:47], v[192:195], v[112:115], v[32:47]
    ds_read_b64_tr_b16 v[216:217], v232 offset:8192
    ds_read_b64_tr_b16 v[218:219], v232 offset:9216
    v_mfma_f32_32x32x16_bf16 v[48:63], v[196:199], v[112:115], v[48:63]
    s_waitcnt lgkmcnt(12)
    s_add_u32 m0, s29, 49152
    s_add_u32 s37, s25, 1024
    buffer_load_dwordx4 v228, s[4:7], s37 offen offset:0 lds
    buffer_load_dwordx4 v229, s[4:7], s37 offen offset:1024 lds
    ds_read_b64_tr_b16 v[192:193], v233 offset:8192
    ds_read_b64_tr_b16 v[194:195], v233 offset:9216
    s_waitcnt lgkmcnt(8)
    v_mfma_f32_32x32x16_bf16 v[0:15], v[200:203], v[116:119], v[0:15]
    s_add_u32 m0, s29, 49152
    s_add_u32 s37, s25, 1024
    s_mov_b64 exec, s[38:39]
    buffer_load_dwordx4 v230, s[4:7], s37 offen offset:2048 lds
    buffer_load_dwordx4 v231, s[4:7], s37 offen offset:3072 lds
    s_mov_b64 exec, -1
    ds_read_b64_tr_b16 v[196:197], v234 offset:8192
    ds_read_b64_tr_b16 v[198:199], v234 offset:9216
    v_mfma_f32_32x32x16_bf16 v[16:31], v[204:207], v[116:119], v[16:31]
    ds_read_b64_tr_b16 v[200:201], v235 offset:8192
    ds_read_b64_tr_b16 v[202:203], v235 offset:9216
    s_waitcnt lgkmcnt(8)
    v_mfma_f32_32x32x16_bf16 v[32:47], v[208:211], v[116:119], v[32:47]
    ds_read_b64_tr_b16 v[204:205], v232 offset:12288
    ds_read_b64_tr_b16 v[206:207], v232 offset:13312
    v_mfma_f32_32x32x16_bf16 v[48:63], v[212:215], v[116:119], v[48:63]
    ds_read_b64_tr_b16 v[208:209], v233 offset:12288
    ds_read_b64_tr_b16 v[210:211], v233 offset:13312
    s_waitcnt lgkmcnt(8)
    v_mfma_f32_32x32x16_bf16 v[0:15], v[216:219], v[120:123], v[0:15]
    ds_read_b64_tr_b16 v[212:213], v234 offset:12288
    ds_read_b64_tr_b16 v[214:215], v234 offset:13312
    v_mfma_f32_32x32x16_bf16 v[16:31], v[192:195], v[120:123], v[16:31]
    ds_read_b64_tr_b16 v[216:217], v235 offset:12288
    ds_read_b64_tr_b16 v[218:219], v235 offset:13312
    s_waitcnt lgkmcnt(8)
    v_mfma_f32_32x32x16_bf16 v[32:47], v[196:199], v[120:123], v[32:47]
    s_waitcnt vmcnt(12) lgkmcnt(0)
    s_barrier
    ds_read_b128 v[128:131], v243 offset:16384
    ds_read_b64_tr_b16 v[192:193], v232 offset:16384
    ds_read_b64_tr_b16 v[194:195], v232 offset:17408
    v_mfma_f32_32x32x16_bf16 v[48:63], v[200:203], v[120:123], v[48:63]
    s_add_u32 m0, s29, 0
    s_add_u32 s31, s26, 4718592
    buffer_load_dwordx4 v224, s[8:11], s31 offen offset:0 lds
    buffer_load_dwordx4 v225, s[8:11], s31 offen offset:1024 lds
    ds_read_b128 v[132:135], v244 offset:16384
    ds_read_b64_tr_b16 v[196:197], v233 offset:16384
    ds_read_b64_tr_b16 v[198:199], v233 offset:17408
    s_waitcnt lgkmcnt(10)
    v_mfma_f32_32x32x16_bf16 v[0:15], v[204:207], v[124:127], v[0:15]
    s_add_u32 m0, s29, 0
    s_add_u32 s31, s26, 4718592
    buffer_load_dwordx4 v226, s[8:11], s31 offen offset:2048 lds
    buffer_load_dwordx4 v227, s[8:11], s31 offen offset:3072 lds
    ds_read_b128 v[136:139], v245 offset:16384
    ds_read_b64_tr_b16 v[200:201], v234 offset:16384
    ds_read_b64_tr_b16 v[202:203], v234 offset:17408
    v_mfma_f32_32x32x16_bf16 v[16:31], v[208:211], v[124:127], v[16:31]
    ds_read_b128 v[140:143], v246 offset:16384
    ds_read_b64_tr_b16 v[204:205], v235 offset:16384
    ds_read_b64_tr_b16 v[206:207], v235 offset:17408
    s_waitcnt lgkmcnt(12)
    v_mfma_f32_32x32x16_bf16 v[32:47], v[212:215], v[124:127], v[32:47]
    ds_read_b64_tr_b16 v[208:209], v232 offset:20480
    ds_read_b64_tr_b16 v[210:211], v232 offset:21504
    v_mfma_f32_32x32x16_bf16 v[48:63], v[216:219], v[124:127], v[48:63]
    ds_read_b64_tr_b16 v[212:213], v233 offset:20480
    ds_read_b64_tr_b16 v[214:215], v233 offset:21504
    s_waitcnt lgkmcnt(10)
    v_mfma_f32_32x32x16_bf16 v[0:15], v[192:195], v[128:131], v[0:15]
    ds_read_b64_tr_b16 v[216:217], v234 offset:20480
    ds_read_b64_tr_b16 v[218:219], v234 offset:21504
    v_mfma_f32_32x32x16_bf16 v[16:31], v[196:199], v[128:131], v[16:31]
    ds_read_b64_tr_b16 v[192:193], v235 offset:20480
    ds_read_b64_tr_b16 v[194:195], v235 offset:21504
    s_waitcnt lgkmcnt(8)
    v_mfma_f32_32x32x16_bf16 v[32:47], v[200:203], v[128:131], v[32:47]
    ds_read_b64_tr_b16 v[196:197], v232 offset:24576
    ds_read_b64_tr_b16 v[198:199], v232 offset:25600
    v_mfma_f32_32x32x16_bf16 v[48:63], v[204:207], v[128:131], v[48:63]
    s_waitcnt lgkmcnt(12)
    s_add_u32 m0, s29, 65536
    s_add_u32 s37, s25, 1152
    buffer_load_dwordx4 v228, s[4:7], s37 offen offset:0 lds
    buffer_load_dwordx4 v229, s[4:7], s37 offen offset:1024 lds
    ds_read_b64_tr_b16 v[200:201], v233 offset:24576
    ds_read_b64_tr_b16 v[202:203], v233 offset:25600
    s_waitcnt lgkmcnt(8)
    v_mfma_f32_32x32x16_bf16 v[0:15], v[208:211], v[132:135], v[0:15]
    s_add_u32 m0, s29, 65536
    s_add_u32 s37, s25, 1152
    s_mov_b64 exec, s[38:39]
    buffer_load_dwordx4 v230, s[4:7], s37 offen offset:2048 lds
    buffer_load_dwordx4 v231, s[4:7], s37 offen offset:3072 lds
    s_mov_b64 exec, -1
    ds_read_b64_tr_b16 v[204:205], v234 offset:24576
    ds_read_b64_tr_b16 v[206:207], v234 offset:25600
    v_mfma_f32_32x32x16_bf16 v[16:31], v[212:215], v[132:135], v[16:31]
    ds_read_b64_tr_b16 v[208:209], v235 offset:24576
    ds_read_b64_tr_b16 v[210:211], v235 offset:25600
    s_waitcnt lgkmcnt(8)
    v_mfma_f32_32x32x16_bf16 v[32:47], v[216:219], v[132:135], v[32:47]
    ds_read_b64_tr_b16 v[212:213], v232 offset:28672
    ds_read_b64_tr_b16 v[214:215], v232 offset:29696
    v_mfma_f32_32x32x16_bf16 v[48:63], v[192:195], v[132:135], v[48:63]
    ds_read_b64_tr_b16 v[216:217], v233 offset:28672
    ds_read_b64_tr_b16 v[218:219], v233 offset:29696
    s_waitcnt lgkmcnt(8)
    v_mfma_f32_32x32x16_bf16 v[0:15], v[196:199], v[136:139], v[0:15]
    ds_read_b64_tr_b16 v[192:193], v234 offset:28672
    ds_read_b64_tr_b16 v[194:195], v234 offset:29696
    v_mfma_f32_32x32x16_bf16 v[16:31], v[200:203], v[136:139], v[16:31]
    ds_read_b64_tr_b16 v[196:197], v235 offset:28672
    ds_read_b64_tr_b16 v[198:199], v235 offset:29696
    s_waitcnt lgkmcnt(8)
    v_mfma_f32_32x32x16_bf16 v[32:47], v[204:207], v[136:139], v[32:47]
    s_waitcnt vmcnt(8) lgkmcnt(0)
    s_barrier
    ds_read_b128 v[112:115], v243 offset:0
    ds_read_b64_tr_b16 v[200:201], v232 offset:32768
    ds_read_b64_tr_b16 v[202:203], v232 offset:33792
    v_mfma_f32_32x32x16_bf16 v[48:63], v[208:211], v[136:139], v[48:63]
    s_add_u32 m0, s29, 16384
    s_add_u32 s31, s26, 5242880
    buffer_load_dwordx4 v224, s[8:11], s31 offen offset:0 lds
    buffer_load_dwordx4 v225, s[8:11], s31 offen offset:1024 lds
    ds_read_b128 v[116:119], v244 offset:0
    ds_read_b64_tr_b16 v[204:205], v233 offset:32768
    ds_read_b64_tr_b16 v[206:207], v233 offset:33792
    s_waitcnt lgkmcnt(10)
    v_mfma_f32_32x32x16_bf16 v[0:15], v[212:215], v[140:143], v[0:15]
    s_add_u32 m0, s29, 16384
    s_add_u32 s31, s26, 5242880
    buffer_load_dwordx4 v226, s[8:11], s31 offen offset:2048 lds
    buffer_load_dwordx4 v227, s[8:11], s31 offen offset:3072 lds
    ds_read_b128 v[120:123], v245 offset:0
    ds_read_b64_tr_b16 v[208:209], v234 offset:32768
    ds_read_b64_tr_b16 v[210:211], v234 offset:33792
    v_mfma_f32_32x32x16_bf16 v[16:31], v[216:219], v[140:143], v[16:31]
    ds_read_b128 v[124:127], v246 offset:0
    ds_read_b64_tr_b16 v[212:213], v235 offset:32768
    ds_read_b64_tr_b16 v[214:215], v235 offset:33792
    s_waitcnt lgkmcnt(12)
    v_mfma_f32_32x32x16_bf16 v[32:47], v[192:195], v[140:143], v[32:47]
    ds_read_b64_tr_b16 v[216:217], v232 offset:36864
    ds_read_b64_tr_b16 v[218:219], v232 offset:37888
    v_mfma_f32_32x32x16_bf16 v[48:63], v[196:199], v[140:143], v[48:63]
    ds_read_b64_tr_b16 v[192:193], v233 offset:36864
    ds_read_b64_tr_b16 v[194:195], v233 offset:37888
    s_waitcnt lgkmcnt(10)
    v_mfma_f32_32x32x16_bf16 v[0:15], v[200:203], v[112:115], v[0:15]
    ds_read_b64_tr_b16 v[196:197], v234 offset:36864
    ds_read_b64_tr_b16 v[198:199], v234 offset:37888
    v_mfma_f32_32x32x16_bf16 v[16:31], v[204:207], v[112:115], v[16:31]
    ds_read_b64_tr_b16 v[200:201], v235 offset:36864
    ds_read_b64_tr_b16 v[202:203], v235 offset:37888
    s_waitcnt lgkmcnt(8)
    v_mfma_f32_32x32x16_bf16 v[32:47], v[208:211], v[112:115], v[32:47]
    ds_read_b64_tr_b16 v[204:205], v232 offset:40960
    ds_read_b64_tr_b16 v[206:207], v232 offset:41984
    v_mfma_f32_32x32x16_bf16 v[48:63], v[212:215], v[112:115], v[48:63]
    s_waitcnt lgkmcnt(12)
    s_add_u32 m0, s29, 49152
    s_add_u32 s37, s25, 1280
    buffer_load_dwordx4 v228, s[4:7], s37 offen offset:0 lds
    buffer_load_dwordx4 v229, s[4:7], s37 offen offset:1024 lds
    ds_read_b64_tr_b16 v[208:209], v233 offset:40960
    ds_read_b64_tr_b16 v[210:211], v233 offset:41984
    s_waitcnt lgkmcnt(8)
    v_mfma_f32_32x32x16_bf16 v[0:15], v[216:219], v[116:119], v[0:15]
    s_add_u32 m0, s29, 49152
    s_add_u32 s37, s25, 1280
    s_mov_b64 exec, s[38:39]
    buffer_load_dwordx4 v230, s[4:7], s37 offen offset:2048 lds
    buffer_load_dwordx4 v231, s[4:7], s37 offen offset:3072 lds
    s_mov_b64 exec, -1
    ds_read_b64_tr_b16 v[212:213], v234 offset:40960
    ds_read_b64_tr_b16 v[214:215], v234 offset:41984
    v_mfma_f32_32x32x16_bf16 v[16:31], v[192:195], v[116:119], v[16:31]
    ds_read_b64_tr_b16 v[216:217], v235 offset:40960
    ds_read_b64_tr_b16 v[218:219], v235 offset:41984
    s_waitcnt lgkmcnt(8)
    v_mfma_f32_32x32x16_bf16 v[32:47], v[196:199], v[116:119], v[32:47]
    ds_read_b64_tr_b16 v[192:193], v232 offset:45056
    ds_read_b64_tr_b16 v[194:195], v232 offset:46080
    v_mfma_f32_32x32x16_bf16 v[48:63], v[200:203], v[116:119], v[48:63]
    ds_read_b64_tr_b16 v[196:197], v233 offset:45056
    ds_read_b64_tr_b16 v[198:199], v233 offset:46080
    s_waitcnt lgkmcnt(8)
    v_mfma_f32_32x32x16_bf16 v[0:15], v[204:207], v[120:123], v[0:15]
    ds_read_b64_tr_b16 v[200:201], v234 offset:45056
    ds_read_b64_tr_b16 v[202:203], v234 offset:46080
    v_mfma_f32_32x32x16_bf16 v[16:31], v[208:211], v[120:123], v[16:31]
    ds_read_b64_tr_b16 v[204:205], v235 offset:45056
    ds_read_b64_tr_b16 v[206:207], v235 offset:46080
    s_waitcnt lgkmcnt(8)
    v_mfma_f32_32x32x16_bf16 v[32:47], v[212:215], v[120:123], v[32:47]
    s_waitcnt vmcnt(8) lgkmcnt(0)
    s_barrier
    ds_read_b128 v[128:131], v243 offset:16384
    ds_read_b64_tr_b16 v[208:209], v232 offset:0
    ds_read_b64_tr_b16 v[210:211], v232 offset:1024
    v_mfma_f32_32x32x16_bf16 v[48:63], v[216:219], v[120:123], v[48:63]
    s_add_u32 m0, s29, 32768
    s_add_u32 s31, s26, 5767168
    buffer_load_dwordx4 v224, s[8:11], s31 offen offset:0 lds
    buffer_load_dwordx4 v225, s[8:11], s31 offen offset:1024 lds
    ds_read_b128 v[132:135], v244 offset:16384
    ds_read_b64_tr_b16 v[212:213], v233 offset:0
    ds_read_b64_tr_b16 v[214:215], v233 offset:1024
    s_waitcnt lgkmcnt(10)
    v_mfma_f32_32x32x16_bf16 v[0:15], v[192:195], v[124:127], v[0:15]
    s_add_u32 m0, s29, 32768
    s_add_u32 s31, s26, 5767168
    buffer_load_dwordx4 v226, s[8:11], s31 offen offset:2048 lds
    buffer_load_dwordx4 v227, s[8:11], s31 offen offset:3072 lds
    ds_read_b128 v[136:139], v245 offset:16384
    ds_read_b64_tr_b16 v[216:217], v234 offset:0
    ds_read_b64_tr_b16 v[218:219], v234 offset:1024
    v_mfma_f32_32x32x16_bf16 v[16:31], v[196:199], v[124:127], v[16:31]
    ds_read_b128 v[140:143], v246 offset:16384
    ds_read_b64_tr_b16 v[192:193], v235 offset:0
    ds_read_b64_tr_b16 v[194:195], v235 offset:1024
    s_waitcnt lgkmcnt(12)
    v_mfma_f32_32x32x16_bf16 v[32:47], v[200:203], v[124:127], v[32:47]
    ds_read_b64_tr_b16 v[196:197], v232 offset:4096
    ds_read_b64_tr_b16 v[198:199], v232 offset:5120
    v_mfma_f32_32x32x16_bf16 v[48:63], v[204:207], v[124:127], v[48:63]
    ds_read_b64_tr_b16 v[200:201], v233 offset:4096
    ds_read_b64_tr_b16 v[202:203], v233 offset:5120
    s_waitcnt lgkmcnt(10)
    v_mfma_f32_32x32x16_bf16 v[0:15], v[208:211], v[128:131], v[0:15]
    ds_read_b64_tr_b16 v[204:205], v234 offset:4096
    ds_read_b64_tr_b16 v[206:207], v234 offset:5120
    v_mfma_f32_32x32x16_bf16 v[16:31], v[212:215], v[128:131], v[16:31]
    ds_read_b64_tr_b16 v[208:209], v235 offset:4096
    ds_read_b64_tr_b16 v[210:211], v235 offset:5120
    s_waitcnt lgkmcnt(8)
    v_mfma_f32_32x32x16_bf16 v[32:47], v[216:219], v[128:131], v[32:47]
    ds_read_b64_tr_b16 v[212:213], v232 offset:8192
    ds_read_b64_tr_b16 v[214:215], v232 offset:9216
    v_mfma_f32_32x32x16_bf16 v[48:63], v[192:195], v[128:131], v[48:63]
    s_waitcnt lgkmcnt(12)
    s_add_u32 m0, s29, 65536
    s_add_u32 s37, s25, 1408
    buffer_load_dwordx4 v228, s[4:7], s37 offen offset:0 lds
    buffer_load_dwordx4 v229, s[4:7], s37 offen offset:1024 lds
    ds_read_b64_tr_b16 v[216:217], v233 offset:8192
    ds_read_b64_tr_b16 v[218:219], v233 offset:9216
    s_waitcnt lgkmcnt(8)
    v_mfma_f32_32x32x16_bf16 v[0:15], v[196:199], v[132:135], v[0:15]
    s_add_u32 m0, s29, 65536
    s_add_u32 s37, s25, 1408
    s_mov_b64 exec, s[38:39]
    buffer_load_dwordx4 v230, s[4:7], s37 offen offset:2048 lds
    buffer_load_dwordx4 v231, s[4:7], s37 offen offset:3072 lds
    s_mov_b64 exec, -1
    ds_read_b64_tr_b16 v[192:193], v234 offset:8192
    ds_read_b64_tr_b16 v[194:195], v234 offset:9216
    v_mfma_f32_32x32x16_bf16 v[16:31], v[200:203], v[132:135], v[16:31]
    ds_read_b64_tr_b16 v[196:197], v235 offset:8192
    ds_read_b64_tr_b16 v[198:199], v235 offset:9216
    s_waitcnt lgkmcnt(8)
    v_mfma_f32_32x32x16_bf16 v[32:47], v[204:207], v[132:135], v[32:47]
    ds_read_b64_tr_b16 v[200:201], v232 offset:12288
    ds_read_b64_tr_b16 v[202:203], v232 offset:13312
    v_mfma_f32_32x32x16_bf16 v[48:63], v[208:211], v[132:135], v[48:63]
    ds_read_b64_tr_b16 v[204:205], v233 offset:12288
    ds_read_b64_tr_b16 v[206:207], v233 offset:13312
    s_waitcnt lgkmcnt(8)
    v_mfma_f32_32x32x16_bf16 v[0:15], v[212:215], v[136:139], v[0:15]
    ds_read_b64_tr_b16 v[208:209], v234 offset:12288
    ds_read_b64_tr_b16 v[210:211], v234 offset:13312
    v_mfma_f32_32x32x16_bf16 v[16:31], v[216:219], v[136:139], v[16:31]
    ds_read_b64_tr_b16 v[212:213], v235 offset:12288
    ds_read_b64_tr_b16 v[214:215], v235 offset:13312
    s_waitcnt lgkmcnt(8)
    v_mfma_f32_32x32x16_bf16 v[32:47], v[192:195], v[136:139], v[32:47]
    s_waitcnt vmcnt(8) lgkmcnt(0)
    s_barrier
    ds_read_b128 v[112:115], v243 offset:0
    ds_read_b64_tr_b16 v[216:217], v232 offset:16384
    ds_read_b64_tr_b16 v[218:219], v232 offset:17408
    v_mfma_f32_32x32x16_bf16 v[48:63], v[196:199], v[136:139], v[48:63]
    s_add_u32 m0, s29, 0
    s_add_u32 s31, s26, 6291456
    buffer_load_dwordx4 v224, s[8:11], s31 offen offset:0 lds
    buffer_load_dwordx4 v225, s[8:11], s31 offen offset:1024 lds
    ds_read_b128 v[116:119], v244 offset:0
    ds_read_b64_tr_b16 v[192:193], v233 offset:16384
    ds_read_b64_tr_b16 v[194:195], v233 offset:17408
    s_waitcnt lgkmcnt(10)
    v_mfma_f32_32x32x16_bf16 v[0:15], v[200:203], v[140:143], v[0:15]
    s_add_u32 m0, s29, 0
    s_add_u32 s31, s26, 6291456
    buffer_load_dwordx4 v226, s[8:11], s31 offen offset:2048 lds
    buffer_load_dwordx4 v227, s[8:11], s31 offen offset:3072 lds
    ds_read_b128 v[120:123], v245 offset:0
    ds_read_b64_tr_b16 v[196:197], v234 offset:16384
    ds_read_b64_tr_b16 v[198:199], v234 offset:17408
    v_mfma_f32_32x32x16_bf16 v[16:31], v[204:207], v[140:143], v[16:31]
    ds_read_b128 v[124:127], v246 offset:0
    ds_read_b64_tr_b16 v[200:201], v235 offset:16384
    ds_read_b64_tr_b16 v[202:203], v235 offset:17408
    s_waitcnt lgkmcnt(12)
    v_mfma_f32_32x32x16_bf16 v[32:47], v[208:211], v[140:143], v[32:47]
    ds_read_b64_tr_b16 v[204:205], v232 offset:20480
    ds_read_b64_tr_b16 v[206:207], v232 offset:21504
    v_mfma_f32_32x32x16_bf16 v[48:63], v[212:215], v[140:143], v[48:63]
    ds_read_b64_tr_b16 v[208:209], v233 offset:20480
    ds_read_b64_tr_b16 v[210:211], v233 offset:21504
    s_waitcnt lgkmcnt(10)
    v_mfma_f32_32x32x16_bf16 v[0:15], v[216:219], v[112:115], v[0:15]
    ds_read_b64_tr_b16 v[212:213], v234 offset:20480
    ds_read_b64_tr_b16 v[214:215], v234 offset:21504
    v_mfma_f32_32x32x16_bf16 v[16:31], v[192:195], v[112:115], v[16:31]
    ds_read_b64_tr_b16 v[216:217], v235 offset:20480
    ds_read_b64_tr_b16 v[218:219], v235 offset:21504
    s_waitcnt lgkmcnt(8)
    v_mfma_f32_32x32x16_bf16 v[32:47], v[196:199], v[112:115], v[32:47]
    ds_read_b64_tr_b16 v[192:193], v232 offset:24576
    ds_read_b64_tr_b16 v[194:195], v232 offset:25600
    v_mfma_f32_32x32x16_bf16 v[48:63], v[200:203], v[112:115], v[48:63]
    s_waitcnt lgkmcnt(12)
    s_add_u32 m0, s29, 49152
    s_add_u32 s37, s25, 1536
    buffer_load_dwordx4 v228, s[4:7], s37 offen offset:0 lds
    buffer_load_dwordx4 v229, s[4:7], s37 offen offset:1024 lds
    ds_read_b64_tr_b16 v[196:197], v233 offset:24576
    ds_read_b64_tr_b16 v[198:199], v233 offset:25600
    s_waitcnt lgkmcnt(8)
    v_mfma_f32_32x32x16_bf16 v[0:15], v[204:207], v[116:119], v[0:15]
    s_add_u32 m0, s29, 49152
    s_add_u32 s37, s25, 1536
    s_mov_b64 exec, s[38:39]
    buffer_load_dwordx4 v230, s[4:7], s37 offen offset:2048 lds
    buffer_load_dwordx4 v231, s[4:7], s37 offen offset:3072 lds
    s_mov_b64 exec, -1
    ds_read_b64_tr_b16 v[200:201], v234 offset:24576
    ds_read_b64_tr_b16 v[202:203], v234 offset:25600
    v_mfma_f32_32x32x16_bf16 v[16:31], v[208:211], v[116:119], v[16:31]
    ds_read_b64_tr_b16 v[204:205], v235 offset:24576
    ds_read_b64_tr_b16 v[206:207], v235 offset:25600
    s_waitcnt lgkmcnt(8)
    v_mfma_f32_32x32x16_bf16 v[32:47], v[212:215], v[116:119], v[32:47]
    ds_read_b64_tr_b16 v[208:209], v232 offset:28672
    ds_read_b64_tr_b16 v[210:211], v232 offset:29696
    v_mfma_f32_32x32x16_bf16 v[48:63], v[216:219], v[116:119], v[48:63]
    ds_read_b64_tr_b16 v[212:213], v233 offset:28672
    ds_read_b64_tr_b16 v[214:215], v233 offset:29696
    s_waitcnt lgkmcnt(8)
    v_mfma_f32_32x32x16_bf16 v[0:15], v[192:195], v[120:123], v[0:15]
    ds_read_b64_tr_b16 v[216:217], v234 offset:28672
    ds_read_b64_tr_b16 v[218:219], v234 offset:29696
    v_mfma_f32_32x32x16_bf16 v[16:31], v[196:199], v[120:123], v[16:31]
    ds_read_b64_tr_b16 v[192:193], v235 offset:28672
    ds_read_b64_tr_b16 v[194:195], v235 offset:29696
    s_waitcnt lgkmcnt(8)
    v_mfma_f32_32x32x16_bf16 v[32:47], v[200:203], v[120:123], v[32:47]
    s_waitcnt vmcnt(8) lgkmcnt(0)
    s_barrier
    ds_read_b128 v[128:131], v243 offset:16384
    ds_read_b64_tr_b16 v[196:197], v232 offset:32768
    ds_read_b64_tr_b16 v[198:199], v232 offset:33792
    v_mfma_f32_32x32x16_bf16 v[48:63], v[204:207], v[120:123], v[48:63]
    s_add_u32 m0, s29, 16384
    s_add_u32 s31, s26, 6815744
    buffer_load_dwordx4 v224, s[8:11], s31 offen offset:0 lds
    buffer_load_dwordx4 v225, s[8:11], s31 offen offset:1024 lds
    ds_read_b128 v[132:135], v244 offset:16384
    ds_read_b64_tr_b16 v[200:201], v233 offset:32768
    ds_read_b64_tr_b16 v[202:203], v233 offset:33792
    s_waitcnt lgkmcnt(10)
    v_mfma_f32_32x32x16_bf16 v[0:15], v[208:211], v[124:127], v[0:15]
    s_add_u32 m0, s29, 16384
    s_add_u32 s31, s26, 6815744
    buffer_load_dwordx4 v226, s[8:11], s31 offen offset:2048 lds
    buffer_load_dwordx4 v227, s[8:11], s31 offen offset:3072 lds
    ds_read_b128 v[136:139], v245 offset:16384
    ds_read_b64_tr_b16 v[204:205], v234 offset:32768
    ds_read_b64_tr_b16 v[206:207], v234 offset:33792
    v_mfma_f32_32x32x16_bf16 v[16:31], v[212:215], v[124:127], v[16:31]
    ds_read_b128 v[140:143], v246 offset:16384
    ds_read_b64_tr_b16 v[208:209], v235 offset:32768
    ds_read_b64_tr_b16 v[210:211], v235 offset:33792
    s_waitcnt lgkmcnt(12)
    v_mfma_f32_32x32x16_bf16 v[32:47], v[216:219], v[124:127], v[32:47]
    ds_read_b64_tr_b16 v[212:213], v232 offset:36864
    ds_read_b64_tr_b16 v[214:215], v232 offset:37888
    v_mfma_f32_32x32x16_bf16 v[48:63], v[192:195], v[124:127], v[48:63]
    ds_read_b64_tr_b16 v[216:217], v233 offset:36864
    ds_read_b64_tr_b16 v[218:219], v233 offset:37888
    s_waitcnt lgkmcnt(10)
    v_mfma_f32_32x32x16_bf16 v[0:15], v[196:199], v[128:131], v[0:15]
    ds_read_b64_tr_b16 v[192:193], v234 offset:36864
    ds_read_b64_tr_b16 v[194:195], v234 offset:37888
    v_mfma_f32_32x32x16_bf16 v[16:31], v[200:203], v[128:131], v[16:31]
    ds_read_b64_tr_b16 v[196:197], v235 offset:36864
    ds_read_b64_tr_b16 v[198:199], v235 offset:37888
    s_waitcnt lgkmcnt(8)
    v_mfma_f32_32x32x16_bf16 v[32:47], v[204:207], v[128:131], v[32:47]
    ds_read_b64_tr_b16 v[200:201], v232 offset:40960
    ds_read_b64_tr_b16 v[202:203], v232 offset:41984
    v_mfma_f32_32x32x16_bf16 v[48:63], v[208:211], v[128:131], v[48:63]
    s_waitcnt lgkmcnt(12)
    s_add_u32 m0, s29, 65536
    s_add_u32 s37, s25, 1664
    buffer_load_dwordx4 v228, s[4:7], s37 offen offset:0 lds
    buffer_load_dwordx4 v229, s[4:7], s37 offen offset:1024 lds
    ds_read_b64_tr_b16 v[204:205], v233 offset:40960
    ds_read_b64_tr_b16 v[206:207], v233 offset:41984
    s_waitcnt lgkmcnt(8)
    v_mfma_f32_32x32x16_bf16 v[0:15], v[212:215], v[132:135], v[0:15]
    s_add_u32 m0, s29, 65536
    s_add_u32 s37, s25, 1664
    s_mov_b64 exec, s[38:39]
    buffer_load_dwordx4 v230, s[4:7], s37 offen offset:2048 lds
    buffer_load_dwordx4 v231, s[4:7], s37 offen offset:3072 lds
    s_mov_b64 exec, -1
    ds_read_b64_tr_b16 v[208:209], v234 offset:40960
    ds_read_b64_tr_b16 v[210:211], v234 offset:41984
    v_mfma_f32_32x32x16_bf16 v[16:31], v[216:219], v[132:135], v[16:31]
    ds_read_b64_tr_b16 v[212:213], v235 offset:40960
    ds_read_b64_tr_b16 v[214:215], v235 offset:41984
    s_waitcnt lgkmcnt(8)
    v_mfma_f32_32x32x16_bf16 v[32:47], v[192:195], v[132:135], v[32:47]
    ds_read_b64_tr_b16 v[216:217], v232 offset:45056
    ds_read_b64_tr_b16 v[218:219], v232 offset:46080
    v_mfma_f32_32x32x16_bf16 v[48:63], v[196:199], v[132:135], v[48:63]
    ds_read_b64_tr_b16 v[192:193], v233 offset:45056
    ds_read_b64_tr_b16 v[194:195], v233 offset:46080
    s_waitcnt lgkmcnt(8)
    v_mfma_f32_32x32x16_bf16 v[0:15], v[200:203], v[136:139], v[0:15]
    ds_read_b64_tr_b16 v[196:197], v234 offset:45056
    ds_read_b64_tr_b16 v[198:199], v234 offset:46080
    v_mfma_f32_32x32x16_bf16 v[16:31], v[204:207], v[136:139], v[16:31]
    ds_read_b64_tr_b16 v[200:201], v235 offset:45056
    ds_read_b64_tr_b16 v[202:203], v235 offset:46080
    s_waitcnt lgkmcnt(8)
    v_mfma_f32_32x32x16_bf16 v[32:47], v[208:211], v[136:139], v[32:47]
    s_waitcnt vmcnt(8) lgkmcnt(0)
    s_barrier
    ds_read_b128 v[112:115], v243 offset:0
    ds_read_b64_tr_b16 v[204:205], v232 offset:0
    ds_read_b64_tr_b16 v[206:207], v232 offset:1024
    v_mfma_f32_32x32x16_bf16 v[48:63], v[212:215], v[136:139], v[48:63]
    s_add_u32 m0, s29, 32768
    s_add_u32 s31, s26, 7340032
    buffer_load_dwordx4 v224, s[8:11], s31 offen offset:0 lds
    buffer_load_dwordx4 v225, s[8:11], s31 offen offset:1024 lds
    ds_read_b128 v[116:119], v244 offset:0
    ds_read_b64_tr_b16 v[208:209], v233 offset:0
    ds_read_b64_tr_b16 v[210:211], v233 offset:1024
    s_waitcnt lgkmcnt(10)
    v_mfma_f32_32x32x16_bf16 v[0:15], v[216:219], v[140:143], v[0:15]
    s_add_u32 m0, s29, 32768
    s_add_u32 s31, s26, 7340032
    buffer_load_dwordx4 v226, s[8:11], s31 offen offset:2048 lds
    buffer_load_dwordx4 v227, s[8:11], s31 offen offset:3072 lds
    ds_read_b128 v[120:123], v245 offset:0
    ds_read_b64_tr_b16 v[212:213], v234 offset:0
    ds_read_b64_tr_b16 v[214:215], v234 offset:1024
    v_mfma_f32_32x32x16_bf16 v[16:31], v[192:195], v[140:143], v[16:31]
    ds_read_b128 v[124:127], v246 offset:0
    ds_read_b64_tr_b16 v[216:217], v235 offset:0
    ds_read_b64_tr_b16 v[218:219], v235 offset:1024
    s_waitcnt lgkmcnt(12)
    v_mfma_f32_32x32x16_bf16 v[32:47], v[196:199], v[140:143], v[32:47]
    ds_read_b64_tr_b16 v[192:193], v232 offset:4096
    ds_read_b64_tr_b16 v[194:195], v232 offset:5120
    v_mfma_f32_32x32x16_bf16 v[48:63], v[200:203], v[140:143], v[48:63]
    ds_read_b64_tr_b16 v[196:197], v233 offset:4096
    ds_read_b64_tr_b16 v[198:199], v233 offset:5120
    s_waitcnt lgkmcnt(10)
    v_mfma_f32_32x32x16_bf16 v[0:15], v[204:207], v[112:115], v[0:15]
    ds_read_b64_tr_b16 v[200:201], v234 offset:4096
    ds_read_b64_tr_b16 v[202:203], v234 offset:5120
    v_mfma_f32_32x32x16_bf16 v[16:31], v[208:211], v[112:115], v[16:31]
    ds_read_b64_tr_b16 v[204:205], v235 offset:4096
    ds_read_b64_tr_b16 v[206:207], v235 offset:5120
    s_waitcnt lgkmcnt(8)
    v_mfma_f32_32x32x16_bf16 v[32:47], v[212:215], v[112:115], v[32:47]
    ds_read_b64_tr_b16 v[208:209], v232 offset:8192
    ds_read_b64_tr_b16 v[210:211], v232 offset:9216
    v_mfma_f32_32x32x16_bf16 v[48:63], v[216:219], v[112:115], v[48:63]
    s_waitcnt lgkmcnt(12)
    s_add_u32 m0, s29, 49152
    s_add_u32 s37, s25, 1792
    buffer_load_dwordx4 v228, s[4:7], s37 offen offset:0 lds
    buffer_load_dwordx4 v229, s[4:7], s37 offen offset:1024 lds
    ds_read_b64_tr_b16 v[212:213], v233 offset:8192
    ds_read_b64_tr_b16 v[214:215], v233 offset:9216
    s_waitcnt lgkmcnt(8)
    v_mfma_f32_32x32x16_bf16 v[0:15], v[192:195], v[116:119], v[0:15]
    s_add_u32 m0, s29, 49152
    s_add_u32 s37, s25, 1792
    s_mov_b64 exec, s[38:39]
    buffer_load_dwordx4 v230, s[4:7], s37 offen offset:2048 lds
    buffer_load_dwordx4 v231, s[4:7], s37 offen offset:3072 lds
    s_mov_b64 exec, -1
    ds_read_b64_tr_b16 v[216:217], v234 offset:8192
    ds_read_b64_tr_b16 v[218:219], v234 offset:9216
    v_mfma_f32_32x32x16_bf16 v[16:31], v[196:199], v[116:119], v[16:31]
    ds_read_b64_tr_b16 v[192:193], v235 offset:8192
    ds_read_b64_tr_b16 v[194:195], v235 offset:9216
    s_waitcnt lgkmcnt(8)
    v_mfma_f32_32x32x16_bf16 v[32:47], v[200:203], v[116:119], v[32:47]
    ds_read_b64_tr_b16 v[196:197], v232 offset:12288
    ds_read_b64_tr_b16 v[198:199], v232 offset:13312
    v_mfma_f32_32x32x16_bf16 v[48:63], v[204:207], v[116:119], v[48:63]
    ds_read_b64_tr_b16 v[200:201], v233 offset:12288
    ds_read_b64_tr_b16 v[202:203], v233 offset:13312
    s_waitcnt lgkmcnt(8)
    v_mfma_f32_32x32x16_bf16 v[0:15], v[208:211], v[120:123], v[0:15]
    ds_read_b64_tr_b16 v[204:205], v234 offset:12288
    ds_read_b64_tr_b16 v[206:207], v234 offset:13312
    v_mfma_f32_32x32x16_bf16 v[16:31], v[212:215], v[120:123], v[16:31]
    ds_read_b64_tr_b16 v[208:209], v235 offset:12288
    ds_read_b64_tr_b16 v[210:211], v235 offset:13312
    s_waitcnt lgkmcnt(8)
    v_mfma_f32_32x32x16_bf16 v[32:47], v[216:219], v[120:123], v[32:47]
    s_waitcnt vmcnt(8) lgkmcnt(0)
    s_barrier
    ds_read_b128 v[128:131], v243 offset:16384
    ds_read_b64_tr_b16 v[212:213], v232 offset:16384
    ds_read_b64_tr_b16 v[214:215], v232 offset:17408
    v_mfma_f32_32x32x16_bf16 v[48:63], v[192:195], v[120:123], v[48:63]
    s_add_u32 m0, s29, 0
    s_add_u32 s31, s26, 7864320
    buffer_load_dwordx4 v224, s[8:11], s31 offen offset:0 lds
    buffer_load_dwordx4 v225, s[8:11], s31 offen offset:1024 lds
    ds_read_b128 v[132:135], v244 offset:16384
    ds_read_b64_tr_b16 v[216:217], v233 offset:16384
    ds_read_b64_tr_b16 v[218:219], v233 offset:17408
    s_waitcnt lgkmcnt(10)
    v_mfma_f32_32x32x16_bf16 v[0:15], v[196:199], v[124:127], v[0:15]
    s_add_u32 m0, s29, 0
    s_add_u32 s31, s26, 7864320
    buffer_load_dwordx4 v226, s[8:11], s31 offen offset:2048 lds
    buffer_load_dwordx4 v227, s[8:11], s31 offen offset:3072 lds
    ds_read_b128 v[136:139], v245 offset:16384
    ds_read_b64_tr_b16 v[192:193], v234 offset:16384
    ds_read_b64_tr_b16 v[194:195], v234 offset:17408
    v_mfma_f32_32x32x16_bf16 v[16:31], v[200:203], v[124:127], v[16:31]
    ds_read_b128 v[140:143], v246 offset:16384
    ds_read_b64_tr_b16 v[196:197], v235 offset:16384
    ds_read_b64_tr_b16 v[198:199], v235 offset:17408
    s_waitcnt lgkmcnt(12)
    v_mfma_f32_32x32x16_bf16 v[32:47], v[204:207], v[124:127], v[32:47]
    ds_read_b64_tr_b16 v[200:201], v232 offset:20480
    ds_read_b64_tr_b16 v[202:203], v232 offset:21504
    v_mfma_f32_32x32x16_bf16 v[48:63], v[208:211], v[124:127], v[48:63]
    ds_read_b64_tr_b16 v[204:205], v233 offset:20480
    ds_read_b64_tr_b16 v[206:207], v233 offset:21504
    s_waitcnt lgkmcnt(10)
    v_mfma_f32_32x32x16_bf16 v[0:15], v[212:215], v[128:131], v[0:15]
    ds_read_b64_tr_b16 v[208:209], v234 offset:20480
    ds_read_b64_tr_b16 v[210:211], v234 offset:21504
    v_mfma_f32_32x32x16_bf16 v[16:31], v[216:219], v[128:131], v[16:31]
    ds_read_b64_tr_b16 v[212:213], v235 offset:20480
    ds_read_b64_tr_b16 v[214:215], v235 offset:21504
    s_waitcnt lgkmcnt(8)
    v_mfma_f32_32x32x16_bf16 v[32:47], v[192:195], v[128:131], v[32:47]
    ds_read_b64_tr_b16 v[216:217], v232 offset:24576
    ds_read_b64_tr_b16 v[218:219], v232 offset:25600
    v_mfma_f32_32x32x16_bf16 v[48:63], v[196:199], v[128:131], v[48:63]
    s_waitcnt lgkmcnt(12)
    s_add_u32 m0, s29, 65536
    s_add_u32 s37, s25, 1920
    buffer_load_dwordx4 v228, s[4:7], s37 offen offset:0 lds
    buffer_load_dwordx4 v229, s[4:7], s37 offen offset:1024 lds
    ds_read_b64_tr_b16 v[192:193], v233 offset:24576
    ds_read_b64_tr_b16 v[194:195], v233 offset:25600
    s_waitcnt lgkmcnt(8)
    v_mfma_f32_32x32x16_bf16 v[0:15], v[200:203], v[132:135], v[0:15]
    s_add_u32 m0, s29, 65536
    s_add_u32 s37, s25, 1920
    s_mov_b64 exec, s[38:39]
    buffer_load_dwordx4 v230, s[4:7], s37 offen offset:2048 lds
    buffer_load_dwordx4 v231, s[4:7], s37 offen offset:3072 lds
    s_mov_b64 exec, -1
    ds_read_b64_tr_b16 v[196:197], v234 offset:24576
    ds_read_b64_tr_b16 v[198:199], v234 offset:25600
    v_mfma_f32_32x32x16_bf16 v[16:31], v[204:207], v[132:135], v[16:31]
    ds_read_b64_tr_b16 v[200:201], v235 offset:24576
    ds_read_b64_tr_b16 v[202:203], v235 offset:25600
    s_waitcnt lgkmcnt(8)
    v_mfma_f32_32x32x16_bf16 v[32:47], v[208:211], v[132:135], v[32:47]
    ds_read_b64_tr_b16 v[204:205], v232 offset:28672
    ds_read_b64_tr_b16 v[206:207], v232 offset:29696
    v_mfma_f32_32x32x16_bf16 v[48:63], v[212:215], v[132:135], v[48:63]
    ds_read_b64_tr_b16 v[208:209], v233 offset:28672
    ds_read_b64_tr_b16 v[210:211], v233 offset:29696
    s_waitcnt lgkmcnt(8)
    v_mfma_f32_32x32x16_bf16 v[0:15], v[216:219], v[136:139], v[0:15]
    ds_read_b64_tr_b16 v[212:213], v234 offset:28672
    ds_read_b64_tr_b16 v[214:215], v234 offset:29696
    v_mfma_f32_32x32x16_bf16 v[16:31], v[192:195], v[136:139], v[16:31]
    ds_read_b64_tr_b16 v[216:217], v235 offset:28672
    ds_read_b64_tr_b16 v[218:219], v235 offset:29696
    s_waitcnt lgkmcnt(8)
    v_mfma_f32_32x32x16_bf16 v[32:47], v[196:199], v[136:139], v[32:47]
    s_waitcnt vmcnt(8) lgkmcnt(0)
    s_barrier
    s_waitcnt vmcnt(63)
    ds_write_b128 v254, v[144:147] offset:16384
    ds_write_b128 v254, v[148:151] offset:17408
    ds_write_b128 v254, v[152:155] offset:18432
    ds_write_b128 v254, v[156:159] offset:19456
    ds_read_b128 v[112:115], v243 offset:0
    ds_read_b64_tr_b16 v[192:193], v232 offset:32768
    ds_read_b64_tr_b16 v[194:195], v232 offset:33792
    v_mfma_f32_32x32x16_bf16 v[48:63], v[200:203], v[136:139], v[48:63]
    ds_read_b128 v[116:119], v244 offset:0
    ds_read_b64_tr_b16 v[196:197], v233 offset:32768
    ds_read_b64_tr_b16 v[198:199], v233 offset:33792
    s_waitcnt lgkmcnt(14)
    v_mfma_f32_32x32x16_bf16 v[0:15], v[204:207], v[140:143], v[0:15]
    ds_read_b128 v[120:123], v245 offset:0
    ds_read_b64_tr_b16 v[200:201], v234 offset:32768
    ds_read_b64_tr_b16 v[202:203], v234 offset:33792
    v_mfma_f32_32x32x16_bf16 v[16:31], v[208:211], v[140:143], v[16:31]
    ds_read_b128 v[124:127], v246 offset:0
    ds_read_b64_tr_b16 v[204:205], v235 offset:32768
    ds_read_b64_tr_b16 v[206:207], v235 offset:33792
    s_waitcnt lgkmcnt(15)
    v_mfma_f32_32x32x16_bf16 v[32:47], v[212:215], v[140:143], v[32:47]
    ds_read_b64_tr_b16 v[208:209], v232 offset:36864
    ds_read_b64_tr_b16 v[210:211], v232 offset:37888
    v_mfma_f32_32x32x16_bf16 v[48:63], v[216:219], v[140:143], v[48:63]
    ds_read_b64_tr_b16 v[212:213], v233 offset:36864
    ds_read_b64_tr_b16 v[214:215], v233 offset:37888
    s_waitcnt lgkmcnt(10)
    v_mfma_f32_32x32x16_bf16 v[0:15], v[192:195], v[112:115], v[0:15]
    ds_read_b64_tr_b16 v[216:217], v234 offset:36864
    ds_read_b64_tr_b16 v[218:219], v234 offset:37888
    v_mfma_f32_32x32x16_bf16 v[16:31], v[196:199], v[112:115], v[16:31]
    ds_read_b64_tr_b16 v[192:193], v235 offset:36864
    ds_read_b64_tr_b16 v[194:195], v235 offset:37888
    s_waitcnt lgkmcnt(8)
    v_mfma_f32_32x32x16_bf16 v[32:47], v[200:203], v[112:115], v[32:47]
    ds_read_b64_tr_b16 v[196:197], v232 offset:40960
    ds_read_b64_tr_b16 v[198:199], v232 offset:41984
    v_mfma_f32_32x32x16_bf16 v[48:63], v[204:207], v[112:115], v[48:63]
    ds_read_b64_tr_b16 v[200:201], v233 offset:40960
    ds_read_b64_tr_b16 v[202:203], v233 offset:41984
    s_waitcnt lgkmcnt(8)
    v_mfma_f32_32x32x16_bf16 v[0:15], v[208:211], v[116:119], v[0:15]
    ds_read_b64_tr_b16 v[204:205], v234 offset:40960
    ds_read_b64_tr_b16 v[206:207], v234 offset:41984
    v_mfma_f32_32x32x16_bf16 v[16:31], v[212:215], v[116:119], v[16:31]
    ds_read_b64_tr_b16 v[208:209], v235 offset:40960
    ds_read_b64_tr_b16 v[210:211], v235 offset:41984
    s_waitcnt lgkmcnt(8)
    v_mfma_f32_32x32x16_bf16 v[32:47], v[216:219], v[116:119], v[32:47]
    ds_read_b64_tr_b16 v[212:213], v232 offset:45056
    ds_read_b64_tr_b16 v[214:215], v232 offset:46080
    v_mfma_f32_32x32x16_bf16 v[48:63], v[192:195], v[116:119], v[48:63]
    ds_read_b64_tr_b16 v[216:217], v233 offset:45056
    ds_read_b64_tr_b16 v[218:219], v233 offset:46080
    s_waitcnt lgkmcnt(8)
    v_mfma_f32_32x32x16_bf16 v[0:15], v[196:199], v[120:123], v[0:15]
    ds_read_b64_tr_b16 v[192:193], v234 offset:45056
    ds_read_b64_tr_b16 v[194:195], v234 offset:46080
    v_mfma_f32_32x32x16_bf16 v[16:31], v[200:203], v[120:123], v[16:31]
    ds_read_b64_tr_b16 v[196:197], v235 offset:45056
    ds_read_b64_tr_b16 v[198:199], v235 offset:46080
    s_waitcnt lgkmcnt(8)
    v_mfma_f32_32x32x16_bf16 v[32:47], v[204:207], v[120:123], v[32:47]
    s_waitcnt vmcnt(0) lgkmcnt(0)
    s_barrier
    s_waitcnt vmcnt(63)
    ds_write_b128 v254, v[160:163] offset:32768
    ds_write_b128 v254, v[164:167] offset:33792
    ds_write_b128 v254, v[168:171] offset:34816
    ds_write_b128 v254, v[172:175] offset:35840
    ds_read_b128 v[128:131], v243 offset:16384
    ds_read_b64_tr_b16 v[200:201], v232 offset:0
    ds_read_b64_tr_b16 v[202:203], v232 offset:1024
    v_mfma_f32_32x32x16_bf16 v[48:63], v[208:211], v[120:123], v[48:63]
    s_add_u32 m0, s29, 49152
    s_add_u32 s31, s27, 16384
    buffer_load_dwordx4 v240, s[16:19], s31 offen offset:0 nt lds
    buffer_load_dwordx4 v240, s[16:19], s31 offen offset:1024 nt lds
    ds_read_b128 v[132:135], v244 offset:16384
    ds_read_b64_tr_b16 v[204:205], v233 offset:0
    ds_read_b64_tr_b16 v[206:207], v233 offset:1024
    s_waitcnt lgkmcnt(14)
    v_mfma_f32_32x32x16_bf16 v[0:15], v[212:215], v[124:127], v[0:15]
    s_add_u32 m0, s29, 49152
    s_add_u32 s31, s27, 16384
    buffer_load_dwordx4 v240, s[16:19], s31 offen offset:2048 nt lds
    buffer_load_dwordx4 v240, s[16:19], s31 offen offset:3072 nt lds
    ds_read_b128 v[136:139], v245 offset:16384
    ds_read_b64_tr_b16 v[208:209], v234 offset:0
    ds_read_b64_tr_b16 v[210:211], v234 offset:1024
    v_mfma_f32_32x32x16_bf16 v[16:31], v[216:219], v[124:127], v[16:31]
    ds_read_b128 v[140:143], v246 offset:16384
    ds_read_b64_tr_b16 v[212:213], v235 offset:0
    ds_read_b64_tr_b16 v[214:215], v235 offset:1024
    s_waitcnt lgkmcnt(15)
    v_mfma_f32_32x32x16_bf16 v[32:47], v[192:195], v[124:127], v[32:47]
    ds_read_b64_tr_b16 v[216:217], v232 offset:4096
    ds_read_b64_tr_b16 v[218:219], v232 offset:5120
    v_mfma_f32_32x32x16_bf16 v[48:63], v[196:199], v[124:127], v[48:63]
    ds_read_b64_tr_b16 v[192:193], v233 offset:4096
    ds_read_b64_tr_b16 v[194:195], v233 offset:5120
    s_waitcnt lgkmcnt(10)
    v_mfma_f32_32x32x16_bf16 v[0:15], v[200:203], v[128:131], v[0:15]
    ds_read_b64_tr_b16 v[196:197], v234 offset:4096
    ds_read_b64_tr_b16 v[198:199], v234 offset:5120
    v_mfma_f32_32x32x16_bf16 v[16:31], v[204:207], v[128:131], v[16:31]
    ds_read_b64_tr_b16 v[200:201], v235 offset:4096
    ds_read_b64_tr_b16 v[202:203], v235 offset:5120
    s_waitcnt lgkmcnt(8)
    v_mfma_f32_32x32x16_bf16 v[32:47], v[208:211], v[128:131], v[32:47]
    ds_read_b64_tr_b16 v[204:205], v232 offset:8192
    ds_read_b64_tr_b16 v[206:207], v232 offset:9216
    v_mfma_f32_32x32x16_bf16 v[48:63], v[212:215], v[128:131], v[48:63]
    ds_read_b64_tr_b16 v[208:209], v233 offset:8192
    ds_read_b64_tr_b16 v[210:211], v233 offset:9216
    s_waitcnt lgkmcnt(8)
    v_mfma_f32_32x32x16_bf16 v[0:15], v[216:219], v[132:135], v[0:15]
    ds_read_b64_tr_b16 v[212:213], v234 offset:8192
    ds_read_b64_tr_b16 v[214:215], v234 offset:9216
    v_mfma_f32_32x32x16_bf16 v[16:31], v[192:195], v[132:135], v[16:31]
    ds_read_b64_tr_b16 v[216:217], v235 offset:8192
    ds_read_b64_tr_b16 v[218:219], v235 offset:9216
    s_waitcnt lgkmcnt(8)
    v_mfma_f32_32x32x16_bf16 v[32:47], v[196:199], v[132:135], v[32:47]
    ds_read_b64_tr_b16 v[192:193], v232 offset:12288
    ds_read_b64_tr_b16 v[194:195], v232 offset:13312
    v_mfma_f32_32x32x16_bf16 v[48:63], v[200:203], v[132:135], v[48:63]
    ds_read_b64_tr_b16 v[196:197], v233 offset:12288
    ds_read_b64_tr_b16 v[198:199], v233 offset:13312
    s_waitcnt lgkmcnt(8)
    v_mfma_f32_32x32x16_bf16 v[0:15], v[204:207], v[136:139], v[0:15]
    ds_read_b64_tr_b16 v[200:201], v234 offset:12288
    ds_read_b64_tr_b16 v[202:203], v234 offset:13312
    v_mfma_f32_32x32x16_bf16 v[16:31], v[208:211], v[136:139], v[16:31]
    ds_read_b64_tr_b16 v[204:205], v235 offset:12288
    ds_read_b64_tr_b16 v[206:207], v235 offset:13312
    s_waitcnt lgkmcnt(8)
    v_mfma_f32_32x32x16_bf16 v[32:47], v[212:215], v[136:139], v[32:47]
    s_waitcnt lgkmcnt(0)
    s_barrier
    s_waitcnt vmcnt(63)
    ds_write_b128 v254, v[176:179] offset:0
    ds_write_b128 v254, v[180:183] offset:1024
    ds_write_b128 v254, v[184:187] offset:2048
    ds_write_b128 v254, v[188:191] offset:3072
    s_add_u32 m0, s29, 65536
    s_add_u32 s31, s27, 32768
    buffer_load_dwordx4 v236, s[12:15], s31 offen offset:0 nt lds
    buffer_load_dwordx4 v237, s[12:15], s31 offen offset:1024 nt lds
    s_add_u32 m0, s29, 65536
    s_add_u32 s31, s27, 32768
    buffer_load_dwordx4 v238, s[12:15], s31 offen offset:2048 nt lds
    buffer_load_dwordx4 v239, s[12:15], s31 offen offset:3072 nt lds
    v_and_b32 v252, 31, v251
    v_lshrrev_b32 v253, 5, v251
    v_and_b32 v255, 15, v252
    v_xor_b32 v255, v255, v253
    v_lshlrev_b32 v255, 4, v255
    v_lshl_add_u32 v255, v252, 8, v255
    v_xor_b32 v224, 0, v255
    v_xor_b32 v225, 32, v255
    v_xor_b32 v226, 64, v255
    v_xor_b32 v227, 96, v255
    v_xor_b32 v228, 128, v255
    v_xor_b32 v229, 160, v255
    v_xor_b32 v230, 192, v255
    v_xor_b32 v231, 224, v255
    ds_read_b128 v[208:211], v224 offset:16384
    v_mfma_f32_32x32x16_bf16 v[48:63], v[216:219], v[136:139], v[48:63]
    ds_read_b128 v[212:215], v224 offset:24576
    s_waitcnt lgkmcnt(10)
    v_mfma_f32_32x32x16_bf16 v[0:15], v[192:195], v[140:143], v[0:15]
    ds_read_b128 v[216:219], v225 offset:16384
    v_mfma_f32_32x32x16_bf16 v[16:31], v[196:199], v[140:143], v[16:31]
    ds_read_b128 v[192:195], v225 offset:24576
    s_waitcnt lgkmcnt(8)
    v_mfma_f32_32x32x16_bf16 v[32:47], v[200:203], v[140:143], v[32:47]
    ds_read_b128 v[196:199], v226 offset:16384
    v_mfma_f32_32x32x16_bf16 v[48:63], v[204:207], v[140:143], v[48:63]
    ds_read_b128 v[200:203], v226 offset:24576
    s_nop 7
    s_nop 5
    v_cvt_pk_bf16_f32 v128, v0, v1
    v_cvt_pk_bf16_f32 v129, v2, v3
    v_cvt_pk_bf16_f32 v130, v4, v5
    v_cvt_pk_bf16_f32 v131, v6, v7
    v_cvt_pk_bf16_f32 v132, v8, v9
    v_cvt_pk_bf16_f32 v133, v10, v11
    v_cvt_pk_bf16_f32 v134, v12, v13
    v_cvt_pk_bf16_f32 v135, v14, v15
    v_cvt_pk_bf16_f32 v136, v16, v17
    v_cvt_pk_bf16_f32 v137, v18, v19
    v_cvt_pk_bf16_f32 v138, v20, v21
    v_cvt_pk_bf16_f32 v139, v22, v23
    v_cvt_pk_bf16_f32 v140, v24, v25
    v_cvt_pk_bf16_f32 v141, v26, v27
    v_cvt_pk_bf16_f32 v142, v28, v29
    v_cvt_pk_bf16_f32 v143, v30, v31
    v_cvt_pk_bf16_f32 v144, v32, v33
    v_cvt_pk_bf16_f32 v145, v34, v35
    v_cvt_pk_bf16_f32 v146, v36, v37
    v_cvt_pk_bf16_f32 v147, v38, v39
    v_cvt_pk_bf16_f32 v148, v40, v41
    v_cvt_pk_bf16_f32 v149, v42, v43
    v_cvt_pk_bf16_f32 v150, v44, v45
    v_cvt_pk_bf16_f32 v151, v46, v47
    v_cvt_pk_bf16_f32 v152, v48, v49
    v_cvt_pk_bf16_f32 v153, v50, v51
    v_cvt_pk_bf16_f32 v154, v52, v53
    v_cvt_pk_bf16_f32 v155, v54, v55
    v_cvt_pk_bf16_f32 v156, v56, v57
    v_cvt_pk_bf16_f32 v157, v58, v59
    v_cvt_pk_bf16_f32 v158, v60, v61
    v_cvt_pk_bf16_f32 v159, v62, v63
    s_nop 1
    s_waitcnt lgkmcnt(4)
    v_mfma_f32_32x32x16_bf16 v[64:79], v[208:211], v[128:131], 0
    ds_read_b128 v[204:207], v227 offset:16384
    v_mfma_f32_32x32x16_bf16 v[80:95], v[212:215], v[128:131], 0
    ds_read_b128 v[208:211], v227 offset:24576
    s_waitcnt lgkmcnt(4)
    v_mfma_f32_32x32x16_bf16 v[64:79], v[216:219], v[132:135], v[64:79]
    ds_read_b128 v[212:215], v228 offset:16384
    v_mfma_f32_32x32x16_bf16 v[80:95], v[192:195], v[132:135], v[80:95]
    ds_read_b128 v[216:219], v228 offset:24576
    s_waitcnt lgkmcnt(4)
    v_mfma_f32_32x32x16_bf16 v[64:79], v[196:199], v[136:139], v[64:79]
    ds_read_b128 v[192:195], v229 offset:16384
    v_mfma_f32_32x32x16_bf16 v[80:95], v[200:203], v[136:139], v[80:95]
    ds_read_b128 v[196:199], v229 offset:24576
    s_waitcnt lgkmcnt(4)
    v_mfma_f32_32x32x16_bf16 v[64:79], v[204:207], v[140:143], v[64:79]
    ds_read_b128 v[200:203], v230 offset:16384
    v_mfma_f32_32x32x16_bf16 v[80:95], v[208:211], v[140:143], v[80:95]
    ds_read_b128 v[204:207], v230 offset:24576
    s_waitcnt lgkmcnt(4)
    v_mfma_f32_32x32x16_bf16 v[64:79], v[212:215], v[144:147], v[64:79]
    ds_read_b128 v[208:211], v231 offset:16384
    v_mfma_f32_32x32x16_bf16 v[80:95], v[216:219], v[144:147], v[80:95]
    ds_read_b128 v[212:215], v231 offset:24576
    s_waitcnt lgkmcnt(4)
    v_mfma_f32_32x32x16_bf16 v[64:79], v[192:195], v[148:151], v[64:79]
    s_waitcnt lgkmcnt(15)
    s_barrier
    ds_read_b128 v[216:219], v224 offset:32768
    v_mfma_f32_32x32x16_bf16 v[80:95], v[196:199], v[148:151], v[80:95]
    ds_read_b128 v[192:195], v224 offset:40960
    s_waitcnt lgkmcnt(4)
    v_mfma_f32_32x32x16_bf16 v[64:79], v[200:203], v[152:155], v[64:79]
    ds_read_b128 v[196:199], v225 offset:32768
    v_mfma_f32_32x32x16_bf16 v[80:95], v[204:207], v[152:155], v[80:95]
    ds_read_b128 v[200:203], v225 offset:40960
    s_waitcnt lgkmcnt(4)
    v_mfma_f32_32x32x16_bf16 v[64:79], v[208:211], v[156:159], v[64:79]
    ds_read_b128 v[204:207], v226 offset:32768
    v_mfma_f32_32x32x16_bf16 v[80:95], v[212:215], v[156:159], v[80:95]
    ds_read_b128 v[208:211], v226 offset:40960
    s_waitcnt lgkmcnt(4)
    v_mfma_f32_32x32x16_bf16 v[96:111], v[216:219], v[128:131], 0
    ds_read_b128 v[212:215], v227 offset:32768
    v_mfma_f32_32x32x16_bf16 v[112:127], v[192:195], v[128:131], 0
    ds_read_b128 v[216:219], v227 offset:40960
    s_waitcnt lgkmcnt(4)
    v_mfma_f32_32x32x16_bf16 v[96:111], v[196:199], v[132:135], v[96:111]
    ds_read_b128 v[192:195], v228 offset:32768
    v_mfma_f32_32x32x16_bf16 v[112:127], v[200:203], v[132:135], v[112:127]
    ds_read_b128 v[196:199], v228 offset:40960
    s_waitcnt lgkmcnt(4)
    v_mfma_f32_32x32x16_bf16 v[96:111], v[204:207], v[136:139], v[96:111]
    ds_read_b128 v[200:203], v229 offset:32768
    v_mfma_f32_32x32x16_bf16 v[112:127], v[208:211], v[136:139], v[112:127]
    ds_read_b128 v[204:207], v229 offset:40960
    s_waitcnt lgkmcnt(4)
    v_mfma_f32_32x32x16_bf16 v[96:111], v[212:215], v[140:143], v[96:111]
    ds_read_b128 v[208:211], v230 offset:32768
    v_mfma_f32_32x32x16_bf16 v[112:127], v[216:219], v[140:143], v[112:127]
    ds_read_b128 v[212:215], v230 offset:40960
    s_waitcnt lgkmcnt(4)
    v_mfma_f32_32x32x16_bf16 v[96:111], v[192:195], v[144:147], v[96:111]
    ds_read_b128 v[216:219], v231 offset:32768
    v_mfma_f32_32x32x16_bf16 v[112:127], v[196:199], v[144:147], v[112:127]
    ds_read_b128 v[192:195], v231 offset:40960
    s_waitcnt lgkmcnt(4)
    v_mfma_f32_32x32x16_bf16 v[96:111], v[200:203], v[148:151], v[96:111]
    s_waitcnt lgkmcnt(15)
    s_barrier
    v_sub_u32 v232, v232, v241
    v_sub_u32 v233, v233, v241
    v_sub_u32 v234, v234, v241
    v_sub_u32 v235, v235, v241
    ds_read_b64_tr_b16 v[196:197], v232 offset:0
    ds_read_b64_tr_b16 v[198:199], v232 offset:2048
    v_mfma_f32_32x32x16_bf16 v[112:127], v[204:207], v[148:151], v[112:127]
    s_add_u32 m0, s29, 16384
    s_add_u32 s31, s27, 49152
    buffer_load_dwordx4 v236, s[12:15], s31 offen offset:0 nt lds
    buffer_load_dwordx4 v237, s[12:15], s31 offen offset:1024 nt lds
    ds_read_b64_tr_b16 v[200:201], v233 offset:0
    ds_read_b64_tr_b16 v[202:203], v233 offset:2048
    s_waitcnt lgkmcnt(6)
    v_mfma_f32_32x32x16_bf16 v[96:111], v[208:211], v[152:155], v[96:111]
    s_add_u32 m0, s29, 16384
    s_add_u32 s31, s27, 49152
    buffer_load_dwordx4 v238, s[12:15], s31 offen offset:2048 nt lds
    buffer_load_dwordx4 v239, s[12:15], s31 offen offset:3072 nt lds
    ds_read_b64_tr_b16 v[204:205], v234 offset:0
    ds_read_b64_tr_b16 v[206:207], v234 offset:2048
    v_mfma_f32_32x32x16_bf16 v[112:127], v[212:215], v[152:155], v[112:127]
    ds_read_b64_tr_b16 v[208:209], v235 offset:0
    ds_read_b64_tr_b16 v[210:211], v235 offset:2048
    s_waitcnt lgkmcnt(8)
    v_mfma_f32_32x32x16_bf16 v[96:111], v[216:219], v[156:159], v[96:111]
    ds_read_b64_tr_b16 v[212:213], v232 offset:4096
    ds_read_b64_tr_b16 v[214:215], v232 offset:6144
    v_mfma_f32_32x32x16_bf16 v[112:127], v[192:195], v[156:159], v[112:127]
    ds_read_b64_tr_b16 v[216:217], v233 offset:4096
    ds_read_b64_tr_b16 v[218:219], v233 offset:6144
    s_nop 7
    s_nop 5
    v_max3_f32 v245, v64, v65, v66
    v_max3_f32 v246, v80, v81, v82
    v_max3_f32 v247, v96, v97, v98
    v_max3_f32 v248, v112, v113, v114
    v_max3_f32 v245, v245, v67, v68
    v_max3_f32 v246, v246, v83, v84
    v_max3_f32 v247, v247, v99, v100
    v_max3_f32 v248, v248, v115, v116
    v_max3_f32 v245, v245, v69, v70
    v_max3_f32 v246, v246, v85, v86
    v_max3_f32 v247, v247, v101, v102
    v_max3_f32 v248, v248, v117, v118
    v_max3_f32 v245, v245, v71, v72
    v_max3_f32 v246, v246, v87, v88
    v_max3_f32 v247, v247, v103, v104
    v_max3_f32 v248, v248, v119, v120
    v_max3_f32 v245, v245, v73, v74
    v_max3_f32 v246, v246, v89, v90
    v_max3_f32 v247, v247, v105, v106
    v_max3_f32 v248, v248, v121, v122
    v_max3_f32 v245, v245, v75, v76
    v_max3_f32 v246, v246, v91, v92
    v_max3_f32 v247, v247, v107, v108
    v_max3_f32 v248, v248, v123, v124
    v_max3_f32 v245, v245, v77, v78
    v_max3_f32 v246, v246, v93, v94
    v_max3_f32 v247, v247, v109, v110
    v_max3_f32 v248, v248, v125, v126
    v_max_f32 v245, v245, v79
    v_max_f32 v246, v246, v95
    v_max_f32 v247, v247, v111
    v_max_f32 v248, v248, v127
    v_max3_f32 v245, v245, v246, v247
    v_max_f32 v245, v245, v248
    v_mov_b32 v246, v245
    s_nop 1
    v_permlane32_swap_b32 v245, v246
    s_nop 1
    v_max_f32 v243, v245, v246
    v_mul_f32 v245, s42, v243
    v_fma_f32 v64, v64, s42, -v245
    v_fma_f32 v65, v65, s42, -v245
    v_fma_f32 v66, v66, s42, -v245
    v_fma_f32 v67, v67, s42, -v245
    v_fma_f32 v68, v68, s42, -v245
    v_fma_f32 v69, v69, s42, -v245
    v_fma_f32 v70, v70, s42, -v245
    v_fma_f32 v71, v71, s42, -v245
    v_exp_f32 v64, v64
    v_exp_f32 v65, v65
    v_exp_f32 v66, v66
    v_exp_f32 v67, v67
    v_exp_f32 v68, v68
    v_exp_f32 v69, v69
    v_exp_f32 v70, v70
    v_exp_f32 v71, v71
    v_add_f32 v247, v64, v68
    v_add_f32 v248, v65, v69
    v_add_f32 v249, v66, v70
    v_add_f32 v250, v67, v71
    v_cvt_pk_bf16_f32 v160, v64, v65
    v_cvt_pk_bf16_f32 v161, v66, v67
    v_cvt_pk_bf16_f32 v162, v68, v69
    v_cvt_pk_bf16_f32 v163, v70, v71
    v_fma_f32 v72, v72, s42, -v245
    v_fma_f32 v73, v73, s42, -v245
    v_fma_f32 v74, v74, s42, -v245
    v_fma_f32 v75, v75, s42, -v245
    v_fma_f32 v76, v76, s42, -v245
    v_fma_f32 v77, v77, s42, -v245
    v_fma_f32 v78, v78, s42, -v245
    v_fma_f32 v79, v79, s42, -v245
    v_exp_f32 v72, v72
    v_exp_f32 v73, v73
    v_exp_f32 v74, v74
    v_exp_f32 v75, v75
    v_exp_f32 v76, v76
    v_exp_f32 v77, v77
    v_exp_f32 v78, v78
    v_exp_f32 v79, v79
    v_add_f32 v247, v247, v72
    v_add_f32 v248, v248, v73
    v_add_f32 v249, v249, v74
    v_add_f32 v250, v250, v75
    v_add_f32 v247, v247, v76
    v_add_f32 v248, v248, v77
    v_add_f32 v249, v249, v78
    v_add_f32 v250, v250, v79
    v_cvt_pk_bf16_f32 v164, v72, v73
    v_cvt_pk_bf16_f32 v165, v74, v75
    v_cvt_pk_bf16_f32 v166, v76, v77
    v_cvt_pk_bf16_f32 v167, v78, v79
    v_fma_f32 v80, v80, s42, -v245
    v_fma_f32 v81, v81, s42, -v245
    v_fma_f32 v82, v82, s42, -v245
    v_fma_f32 v83, v83, s42, -v245
    v_fma_f32 v84, v84, s42, -v245
    v_fma_f32 v85, v85, s42, -v245
    v_fma_f32 v86, v86, s42, -v245
    v_fma_f32 v87, v87, s42, -v245
    v_exp_f32 v80, v80
    v_exp_f32 v81, v81
    v_exp_f32 v82, v82
    v_exp_f32 v83, v83
    v_exp_f32 v84, v84
    v_exp_f32 v85, v85
    v_exp_f32 v86, v86
    v_exp_f32 v87, v87
    v_add_f32 v247, v247, v80
    v_add_f32 v248, v248, v81
    v_add_f32 v249, v249, v82
    v_add_f32 v250, v250, v83
    v_add_f32 v247, v247, v84
    v_add_f32 v248, v248, v85
    v_add_f32 v249, v249, v86
    v_add_f32 v250, v250, v87
    v_cvt_pk_bf16_f32 v168, v80, v81
    v_cvt_pk_bf16_f32 v169, v82, v83
    v_cvt_pk_bf16_f32 v170, v84, v85
    v_cvt_pk_bf16_f32 v171, v86, v87
    v_fma_f32 v88, v88, s42, -v245
    v_fma_f32 v89, v89, s42, -v245
    v_fma_f32 v90, v90, s42, -v245
    v_fma_f32 v91, v91, s42, -v245
    v_fma_f32 v92, v92, s42, -v245
    v_fma_f32 v93, v93, s42, -v245
    v_fma_f32 v94, v94, s42, -v245
    v_fma_f32 v95, v95, s42, -v245
    v_exp_f32 v88, v88
    v_exp_f32 v89, v89
    v_exp_f32 v90, v90
    v_exp_f32 v91, v91
    v_exp_f32 v92, v92
    v_exp_f32 v93, v93
    v_exp_f32 v94, v94
    v_exp_f32 v95, v95
    v_add_f32 v247, v247, v88
    v_add_f32 v248, v248, v89
    v_add_f32 v249, v249, v90
    v_add_f32 v250, v250, v91
    v_add_f32 v247, v247, v92
    v_add_f32 v248, v248, v93
    v_add_f32 v249, v249, v94
    v_add_f32 v250, v250, v95
    v_cvt_pk_bf16_f32 v172, v88, v89
    v_cvt_pk_bf16_f32 v173, v90, v91
    v_cvt_pk_bf16_f32 v174, v92, v93
    v_cvt_pk_bf16_f32 v175, v94, v95
    v_fma_f32 v96, v96, s42, -v245
    v_fma_f32 v97, v97, s42, -v245
    v_fma_f32 v98, v98, s42, -v245
    v_fma_f32 v99, v99, s42, -v245
    v_fma_f32 v100, v100, s42, -v245
    v_fma_f32 v101, v101, s42, -v245
    v_fma_f32 v102, v102, s42, -v245
    v_fma_f32 v103, v103, s42, -v245
    v_exp_f32 v96, v96
    v_exp_f32 v97, v97
    v_exp_f32 v98, v98
    v_exp_f32 v99, v99
    v_exp_f32 v100, v100
    v_exp_f32 v101, v101
    v_exp_f32 v102, v102
    v_exp_f32 v103, v103
    v_add_f32 v247, v247, v96
    v_add_f32 v248, v248, v97
    v_add_f32 v249, v249, v98
    v_add_f32 v250, v250, v99
    v_add_f32 v247, v247, v100
    v_add_f32 v248, v248, v101
    v_add_f32 v249, v249, v102
    v_add_f32 v250, v250, v103
    v_cvt_pk_bf16_f32 v176, v96, v97
    v_cvt_pk_bf16_f32 v177, v98, v99
    v_cvt_pk_bf16_f32 v178, v100, v101
    v_cvt_pk_bf16_f32 v179, v102, v103
    v_fma_f32 v104, v104, s42, -v245
    v_fma_f32 v105, v105, s42, -v245
    v_fma_f32 v106, v106, s42, -v245
    v_fma_f32 v107, v107, s42, -v245
    v_fma_f32 v108, v108, s42, -v245
    v_fma_f32 v109, v109, s42, -v245
    v_fma_f32 v110, v110, s42, -v245
    v_fma_f32 v111, v111, s42, -v245
    v_exp_f32 v104, v104
    v_exp_f32 v105, v105
    v_exp_f32 v106, v106
    v_exp_f32 v107, v107
    v_exp_f32 v108, v108
    v_exp_f32 v109, v109
    v_exp_f32 v110, v110
    v_exp_f32 v111, v111
    v_add_f32 v247, v247, v104
    v_add_f32 v248, v248, v105
    v_add_f32 v249, v249, v106
    v_add_f32 v250, v250, v107
    v_add_f32 v247, v247, v108
    v_add_f32 v248, v248, v109
    v_add_f32 v249, v249, v110
    v_add_f32 v250, v250, v111
    v_cvt_pk_bf16_f32 v180, v104, v105
    v_cvt_pk_bf16_f32 v181, v106, v107
    v_cvt_pk_bf16_f32 v182, v108, v109
    v_cvt_pk_bf16_f32 v183, v110, v111
    v_fma_f32 v112, v112, s42, -v245
    v_fma_f32 v113, v113, s42, -v245
    v_fma_f32 v114, v114, s42, -v245
    v_fma_f32 v115, v115, s42, -v245
    v_fma_f32 v116, v116, s42, -v245
    v_fma_f32 v117, v117, s42, -v245
    v_fma_f32 v118, v118, s42, -v245
    v_fma_f32 v119, v119, s42, -v245
    v_exp_f32 v112, v112
    v_exp_f32 v113, v113
    v_exp_f32 v114, v114
    v_exp_f32 v115, v115
    v_exp_f32 v116, v116
    v_exp_f32 v117, v117
    v_exp_f32 v118, v118
    v_exp_f32 v119, v119
    v_add_f32 v247, v247, v112
    v_add_f32 v248, v248, v113
    v_add_f32 v249, v249, v114
    v_add_f32 v250, v250, v115
    v_add_f32 v247, v247, v116
    v_add_f32 v248, v248, v117
    v_add_f32 v249, v249, v118
    v_add_f32 v250, v250, v119
    v_cvt_pk_bf16_f32 v184, v112, v113
    v_cvt_pk_bf16_f32 v185, v114, v115
    v_cvt_pk_bf16_f32 v186, v116, v117
    v_cvt_pk_bf16_f32 v187, v118, v119
    v_fma_f32 v120, v120, s42, -v245
    v_fma_f32 v121, v121, s42, -v245
    v_fma_f32 v122, v122, s42, -v245
    v_fma_f32 v123, v123, s42, -v245
    v_fma_f32 v124, v124, s42, -v245
    v_fma_f32 v125, v125, s42, -v245
    v_fma_f32 v126, v126, s42, -v245
    v_fma_f32 v127, v127, s42, -v245
    v_exp_f32 v120, v120
    v_exp_f32 v121, v121
    v_exp_f32 v122, v122
    v_exp_f32 v123, v123
    v_exp_f32 v124, v124
    v_exp_f32 v125, v125
    v_exp_f32 v126, v126
    v_exp_f32 v127, v127
    v_add_f32 v247, v247, v120
    v_add_f32 v248, v248, v121
    v_add_f32 v249, v249, v122
    v_add_f32 v250, v250, v123
    v_add_f32 v247, v247, v124
    v_add_f32 v248, v248, v125
    v_add_f32 v249, v249, v126
    v_add_f32 v250, v250, v127
    v_cvt_pk_bf16_f32 v188, v120, v121
    v_cvt_pk_bf16_f32 v189, v122, v123
    v_cvt_pk_bf16_f32 v190, v124, v125
    v_cvt_pk_bf16_f32 v191, v126, v127
    v_add_f32 v247, v247, v248
    v_add_f32 v249, v249, v250
    v_add_f32 v247, v247, v249
    v_mov_b32 v244, v247
    s_nop 1
    s_waitcnt lgkmcnt(8)
    v_mfma_f32_32x32x16_bf16 v[0:15], v[196:199], v[160:163], 0
    ds_read_b64_tr_b16 v[192:193], v234 offset:4096
    ds_read_b64_tr_b16 v[194:195], v234 offset:6144
    v_mfma_f32_32x32x16_bf16 v[16:31], v[200:203], v[160:163], 0
    ds_read_b64_tr_b16 v[196:197], v235 offset:4096
    ds_read_b64_tr_b16 v[198:199], v235 offset:6144
    s_waitcnt lgkmcnt(8)
    v_mfma_f32_32x32x16_bf16 v[32:47], v[204:207], v[160:163], 0
    ds_read_b64_tr_b16 v[200:201], v232 offset:8192
    ds_read_b64_tr_b16 v[202:203], v232 offset:10240
    v_mfma_f32_32x32x16_bf16 v[48:63], v[208:211], v[160:163], 0
    ds_read_b64_tr_b16 v[204:205], v233 offset:8192
    ds_read_b64_tr_b16 v[206:207], v233 offset:10240
    s_waitcnt lgkmcnt(8)
    v_mfma_f32_32x32x16_bf16 v[0:15], v[212:215], v[164:167], v[0:15]
    ds_read_b64_tr_b16 v[208:209], v234 offset:8192
    ds_read_b64_tr_b16 v[210:211], v234 offset:10240
    v_mfma_f32_32x32x16_bf16 v[16:31], v[216:219], v[164:167], v[16:31]
    ds_read_b64_tr_b16 v[212:213], v235 offset:8192
    ds_read_b64_tr_b16 v[214:215], v235 offset:10240
    s_waitcnt lgkmcnt(8)
    v_mfma_f32_32x32x16_bf16 v[32:47], v[192:195], v[164:167], v[32:47]
    ds_read_b64_tr_b16 v[216:217], v232 offset:12288
    ds_read_b64_tr_b16 v[218:219], v232 offset:14336
    v_mfma_f32_32x32x16_bf16 v[48:63], v[196:199], v[164:167], v[48:63]
    ds_read_b64_tr_b16 v[192:193], v233 offset:12288
    ds_read_b64_tr_b16 v[194:195], v233 offset:14336
    s_waitcnt lgkmcnt(8)
    v_mfma_f32_32x32x16_bf16 v[0:15], v[200:203], v[168:171], v[0:15]
    ds_read_b64_tr_b16 v[196:197], v234 offset:12288
    ds_read_b64_tr_b16 v[198:199], v234 offset:14336
    v_mfma_f32_32x32x16_bf16 v[16:31], v[204:207], v[168:171], v[16:31]
    ds_read_b64_tr_b16 v[200:201], v235 offset:12288
    ds_read_b64_tr_b16 v[202:203], v235 offset:14336
    s_waitcnt lgkmcnt(8)
    v_mfma_f32_32x32x16_bf16 v[32:47], v[208:211], v[168:171], v[32:47]
    s_waitcnt vmcnt(8)
    s_barrier
    ds_read_b64_tr_b16 v[204:205], v232 offset:49152
    ds_read_b64_tr_b16 v[206:207], v232 offset:51200
    v_mfma_f32_32x32x16_bf16 v[48:63], v[212:215], v[168:171], v[48:63]
    s_add_u32 m0, s29, 32768
    s_add_u32 s31, s27, 32768
    buffer_load_dwordx4 v240, s[16:19], s31 offen offset:0 nt lds
    buffer_load_dwordx4 v240, s[16:19], s31 offen offset:1024 nt lds
    ds_read_b64_tr_b16 v[208:209], v233 offset:49152
    ds_read_b64_tr_b16 v[210:211], v233 offset:51200
    s_waitcnt lgkmcnt(8)
    v_mfma_f32_32x32x16_bf16 v[0:15], v[216:219], v[172:175], v[0:15]
    s_add_u32 m0, s29, 32768
    s_add_u32 s31, s27, 32768
    buffer_load_dwordx4 v240, s[16:19], s31 offen offset:2048 nt lds
    buffer_load_dwordx4 v240, s[16:19], s31 offen offset:3072 nt lds
    ds_read_b64_tr_b16 v[212:213], v234 offset:49152
    ds_read_b64_tr_b16 v[214:215], v234 offset:51200
    v_mfma_f32_32x32x16_bf16 v[16:31], v[192:195], v[172:175], v[16:31]
    ds_read_b64_tr_b16 v[216:217], v235 offset:49152
    ds_read_b64_tr_b16 v[218:219], v235 offset:51200
    s_waitcnt lgkmcnt(8)
    v_mfma_f32_32x32x16_bf16 v[32:47], v[196:199], v[172:175], v[32:47]
    ds_read_b64_tr_b16 v[192:193], v232 offset:53248
    ds_read_b64_tr_b16 v[194:195], v232 offset:55296
    v_mfma_f32_32x32x16_bf16 v[48:63], v[200:203], v[172:175], v[48:63]
    ds_read_b64_tr_b16 v[196:197], v233 offset:53248
    ds_read_b64_tr_b16 v[198:199], v233 offset:55296
    s_nop 1
    s_waitcnt lgkmcnt(8)
    v_mfma_f32_32x32x16_bf16 v[0:15], v[204:207], v[176:179], v[0:15]
    ds_read_b64_tr_b16 v[200:201], v234 offset:53248
    ds_read_b64_tr_b16 v[202:203], v234 offset:55296
    v_mfma_f32_32x32x16_bf16 v[16:31], v[208:211], v[176:179], v[16:31]
    ds_read_b64_tr_b16 v[204:205], v235 offset:53248
    ds_read_b64_tr_b16 v[206:207], v235 offset:55296
    s_waitcnt lgkmcnt(8)
    v_mfma_f32_32x32x16_bf16 v[32:47], v[212:215], v[176:179], v[32:47]
    ds_read_b64_tr_b16 v[208:209], v232 offset:57344
    ds_read_b64_tr_b16 v[210:211], v232 offset:59392
    v_mfma_f32_32x32x16_bf16 v[48:63], v[216:219], v[176:179], v[48:63]
    ds_read_b64_tr_b16 v[212:213], v233 offset:57344
    ds_read_b64_tr_b16 v[214:215], v233 offset:59392
    s_waitcnt lgkmcnt(8)
    v_mfma_f32_32x32x16_bf16 v[0:15], v[192:195], v[180:183], v[0:15]
    ds_read_b64_tr_b16 v[216:217], v234 offset:57344
    ds_read_b64_tr_b16 v[218:219], v234 offset:59392
    v_mfma_f32_32x32x16_bf16 v[16:31], v[196:199], v[180:183], v[16:31]
    ds_read_b64_tr_b16 v[192:193], v235 offset:57344
    ds_read_b64_tr_b16 v[194:195], v235 offset:59392
    s_waitcnt lgkmcnt(8)
    v_mfma_f32_32x32x16_bf16 v[32:47], v[200:203], v[180:183], v[32:47]
    ds_read_b64_tr_b16 v[196:197], v232 offset:61440
    ds_read_b64_tr_b16 v[198:199], v232 offset:63488
    v_mfma_f32_32x32x16_bf16 v[48:63], v[204:207], v[180:183], v[48:63]
    ds_read_b64_tr_b16 v[200:201], v233 offset:61440
    ds_read_b64_tr_b16 v[202:203], v233 offset:63488
    s_waitcnt lgkmcnt(8)
    v_mfma_f32_32x32x16_bf16 v[0:15], v[208:211], v[184:187], v[0:15]
    ds_read_b64_tr_b16 v[204:205], v234 offset:61440
    ds_read_b64_tr_b16 v[206:207], v234 offset:63488
    v_mfma_f32_32x32x16_bf16 v[16:31], v[212:215], v[184:187], v[16:31]
    ds_read_b64_tr_b16 v[208:209], v235 offset:61440
    ds_read_b64_tr_b16 v[210:211], v235 offset:63488
    s_waitcnt lgkmcnt(8)
    v_mfma_f32_32x32x16_bf16 v[32:47], v[216:219], v[184:187], v[32:47]
    s_waitcnt vmcnt(8)
    s_barrier
    v_add_u32 v224, 0x10000, v224
    v_add_u32 v225, 0x10000, v225
    v_add_u32 v226, 0x10000, v226
    v_add_u32 v227, 0x10000, v227
    v_add_u32 v228, 0x10000, v228
    v_add_u32 v229, 0x10000, v229
    v_add_u32 v230, 0x10000, v230
    v_add_u32 v231, 0x10000, v231
    ds_read_b128 v[212:215], v224 offset:0
    v_mfma_f32_32x32x16_bf16 v[48:63], v[192:195], v[184:187], v[48:63]
    s_add_u32 m0, s29, 0
    s_add_u32 s31, s27, 49152
    buffer_load_dwordx4 v240, s[16:19], s31 offen offset:0 nt lds
    buffer_load_dwordx4 v240, s[16:19], s31 offen offset:1024 nt lds
    ds_read_b128 v[216:219], v224 offset:8192
    s_waitcnt lgkmcnt(6)
    v_mfma_f32_32x32x16_bf16 v[0:15], v[196:199], v[188:191], v[0:15]
    s_add_u32 m0, s29, 0
    s_add_u32 s31, s27, 49152
    buffer_load_dwordx4 v240, s[16:19], s31 offen offset:2048 nt lds
    buffer_load_dwordx4 v240, s[16:19], s31 offen offset:3072 nt lds
    ds_read_b128 v[192:195], v225 offset:0
    v_mfma_f32_32x32x16_bf16 v[16:31], v[200:203], v[188:191], v[16:31]
    ds_read_b128 v[196:199], v225 offset:8192
    s_waitcnt lgkmcnt(4)
    v_mfma_f32_32x32x16_bf16 v[32:47], v[204:207], v[188:191], v[32:47]
    ds_read_b128 v[200:203], v226 offset:0
    v_mfma_f32_32x32x16_bf16 v[48:63], v[208:211], v[188:191], v[48:63]
    ds_read_b128 v[204:207], v226 offset:8192
    s_waitcnt lgkmcnt(4)
    v_mfma_f32_32x32x16_bf16 v[64:79], v[212:215], v[128:131], 0
    ds_read_b128 v[208:211], v227 offset:0
    v_mfma_f32_32x32x16_bf16 v[80:95], v[216:219], v[128:131], 0
    ds_read_b128 v[212:215], v227 offset:8192
    s_waitcnt lgkmcnt(4)
    v_mfma_f32_32x32x16_bf16 v[64:79], v[192:195], v[132:135], v[64:79]
    ds_read_b128 v[216:219], v228 offset:0
    v_mfma_f32_32x32x16_bf16 v[80:95], v[196:199], v[132:135], v[80:95]
    ds_read_b128 v[192:195], v228 offset:8192
    s_waitcnt lgkmcnt(4)
    v_mfma_f32_32x32x16_bf16 v[64:79], v[200:203], v[136:139], v[64:79]
    ds_read_b128 v[196:199], v229 offset:0
    v_mfma_f32_32x32x16_bf16 v[80:95], v[204:207], v[136:139], v[80:95]
    ds_read_b128 v[200:203], v229 offset:8192
    s_waitcnt lgkmcnt(4)
    v_mfma_f32_32x32x16_bf16 v[64:79], v[208:211], v[140:143], v[64:79]
    ds_read_b128 v[204:207], v230 offset:0
    v_mfma_f32_32x32x16_bf16 v[80:95], v[212:215], v[140:143], v[80:95]
    ds_read_b128 v[208:211], v230 offset:8192
    s_waitcnt lgkmcnt(4)
    v_mfma_f32_32x32x16_bf16 v[64:79], v[216:219], v[144:147], v[64:79]
    ds_read_b128 v[212:215], v231 offset:0
    v_mfma_f32_32x32x16_bf16 v[80:95], v[192:195], v[144:147], v[80:95]
    ds_read_b128 v[216:219], v231 offset:8192
    s_waitcnt lgkmcnt(4)
    v_mfma_f32_32x32x16_bf16 v[64:79], v[196:199], v[148:151], v[64:79]
    s_waitcnt vmcnt(8)
    s_barrier
    v_add_u32 v224, 0xffff0000, v224
    v_add_u32 v225, 0xffff0000, v225
    v_add_u32 v226, 0xffff0000, v226
    v_add_u32 v227, 0xffff0000, v227
    v_add_u32 v228, 0xffff0000, v228
    v_add_u32 v229, 0xffff0000, v229
    v_add_u32 v230, 0xffff0000, v230
    v_add_u32 v231, 0xffff0000, v231
    ds_read_b128 v[192:195], v224 offset:16384
    v_mfma_f32_32x32x16_bf16 v[80:95], v[200:203], v[148:151], v[80:95]
    s_add_u32 m0, s29, 49152
    s_add_u32 s31, s27, 65536
    buffer_load_dwordx4 v236, s[12:15], s31 offen offset:0 nt lds
    buffer_load_dwordx4 v237, s[12:15], s31 offen offset:1024 nt lds
    ds_read_b128 v[196:199], v224 offset:24576
    s_waitcnt lgkmcnt(4)
    v_mfma_f32_32x32x16_bf16 v[64:79], v[204:207], v[152:155], v[64:79]
    s_add_u32 m0, s29, 49152
    s_add_u32 s31, s27, 65536
    buffer_load_dwordx4 v238, s[12:15], s31 offen offset:2048 nt lds
    buffer_load_dwordx4 v239, s[12:15], s31 offen offset:3072 nt lds
    ds_read_b128 v[200:203], v225 offset:16384
    v_mfma_f32_32x32x16_bf16 v[80:95], v[208:211], v[152:155], v[80:95]
    ds_read_b128 v[204:207], v225 offset:24576
    s_waitcnt lgkmcnt(4)
    v_mfma_f32_32x32x16_bf16 v[64:79], v[212:215], v[156:159], v[64:79]
    ds_read_b128 v[208:211], v226 offset:16384
    v_mfma_f32_32x32x16_bf16 v[80:95], v[216:219], v[156:159], v[80:95]
    ds_read_b128 v[212:215], v226 offset:24576
    s_waitcnt lgkmcnt(4)
    v_mfma_f32_32x32x16_bf16 v[96:111], v[192:195], v[128:131], 0
    ds_read_b128 v[216:219], v227 offset:16384
    v_mfma_f32_32x32x16_bf16 v[112:127], v[196:199], v[128:131], 0
    ds_read_b128 v[192:195], v227 offset:24576
    s_waitcnt lgkmcnt(4)
    v_mfma_f32_32x32x16_bf16 v[96:111], v[200:203], v[132:135], v[96:111]
    ds_read_b128 v[196:199], v228 offset:16384
    v_mfma_f32_32x32x16_bf16 v[112:127], v[204:207], v[132:135], v[112:127]
    ds_read_b128 v[200:203], v228 offset:24576
    s_waitcnt lgkmcnt(4)
    v_mfma_f32_32x32x16_bf16 v[96:111], v[208:211], v[136:139], v[96:111]
    ds_read_b128 v[204:207], v229 offset:16384
    v_mfma_f32_32x32x16_bf16 v[112:127], v[212:215], v[136:139], v[112:127]
    ds_read_b128 v[208:211], v229 offset:24576
    s_waitcnt lgkmcnt(4)
    v_mfma_f32_32x32x16_bf16 v[96:111], v[216:219], v[140:143], v[96:111]
    ds_read_b128 v[212:215], v230 offset:16384
    v_mfma_f32_32x32x16_bf16 v[112:127], v[192:195], v[140:143], v[112:127]
    ds_read_b128 v[216:219], v230 offset:24576
    s_waitcnt lgkmcnt(4)
    v_mfma_f32_32x32x16_bf16 v[96:111], v[196:199], v[144:147], v[96:111]
    ds_read_b128 v[192:195], v231 offset:16384
    v_mfma_f32_32x32x16_bf16 v[112:127], v[200:203], v[144:147], v[112:127]
    ds_read_b128 v[196:199], v231 offset:24576
    s_waitcnt lgkmcnt(4)
    v_mfma_f32_32x32x16_bf16 v[96:111], v[204:207], v[148:151], v[96:111]
    s_waitcnt vmcnt(8)
    s_barrier
    ds_read_b64_tr_b16 v[200:201], v232 offset:32768
    ds_read_b64_tr_b16 v[202:203], v232 offset:34816
    v_mfma_f32_32x32x16_bf16 v[112:127], v[208:211], v[148:151], v[112:127]
    s_add_u32 m0, s29, 65536
    s_add_u32 s31, s27, 81920
    buffer_load_dwordx4 v236, s[12:15], s31 offen offset:0 nt lds
    buffer_load_dwordx4 v237, s[12:15], s31 offen offset:1024 nt lds
    ds_read_b64_tr_b16 v[204:205], v233 offset:32768
    ds_read_b64_tr_b16 v[206:207], v233 offset:34816
    s_waitcnt lgkmcnt(6)
    v_mfma_f32_32x32x16_bf16 v[96:111], v[212:215], v[152:155], v[96:111]
    s_add_u32 m0, s29, 65536
    s_add_u32 s31, s27, 81920
    buffer_load_dwordx4 v238, s[12:15], s31 offen offset:2048 nt lds
    buffer_load_dwordx4 v239, s[12:15], s31 offen offset:3072 nt lds
    ds_read_b64_tr_b16 v[208:209], v234 offset:32768
    ds_read_b64_tr_b16 v[210:211], v234 offset:34816
    v_mfma_f32_32x32x16_bf16 v[112:127], v[216:219], v[152:155], v[112:127]
    ds_read_b64_tr_b16 v[212:213], v235 offset:32768
    ds_read_b64_tr_b16 v[214:215], v235 offset:34816
    s_waitcnt lgkmcnt(8)
    v_mfma_f32_32x32x16_bf16 v[96:111], v[192:195], v[156:159], v[96:111]
    ds_read_b64_tr_b16 v[216:217], v232 offset:36864
    ds_read_b64_tr_b16 v[218:219], v232 offset:38912
    v_mfma_f32_32x32x16_bf16 v[112:127], v[196:199], v[156:159], v[112:127]
    ds_read_b64_tr_b16 v[192:193], v233 offset:36864
    ds_read_b64_tr_b16 v[194:195], v233 offset:38912
    s_nop 7
    s_nop 5
    v_max3_f32 v245, v64, v65, v66
    v_max3_f32 v246, v80, v81, v82
    v_max3_f32 v247, v96, v97, v98
    v_max3_f32 v248, v112, v113, v114
    v_max3_f32 v245, v245, v67, v68
    v_max3_f32 v246, v246, v83, v84
    v_max3_f32 v247, v247, v99, v100
    v_max3_f32 v248, v248, v115, v116
    v_max3_f32 v245, v245, v69, v70
    v_max3_f32 v246, v246, v85, v86
    v_max3_f32 v247, v247, v101, v102
    v_max3_f32 v248, v248, v117, v118
    v_max3_f32 v245, v245, v71, v72
    v_max3_f32 v246, v246, v87, v88
    v_max3_f32 v247, v247, v103, v104
    v_max3_f32 v248, v248, v119, v120
    v_max3_f32 v245, v245, v73, v74
    v_max3_f32 v246, v246, v89, v90
    v_max3_f32 v247, v247, v105, v106
    v_max3_f32 v248, v248, v121, v122
    v_max3_f32 v245, v245, v75, v76
    v_max3_f32 v246, v246, v91, v92
    v_max3_f32 v247, v247, v107, v108
    v_max3_f32 v248, v248, v123, v124
    v_max3_f32 v245, v245, v77, v78
    v_max3_f32 v246, v246, v93, v94
    v_max3_f32 v247, v247, v109, v110
    v_max3_f32 v248, v248, v125, v126
    v_max_f32 v245, v245, v79
    v_max_f32 v246, v246, v95
    v_max_f32 v247, v247, v111
    v_max_f32 v248, v248, v127
    v_max3_f32 v245, v245, v246, v247
    v_max_f32 v245, v245, v248
    v_mov_b32 v246, v245
    s_nop 1
    v_permlane32_swap_b32 v245, v246
    s_nop 1
    v_max3_f32 v245, v245, v246, v243
    v_sub_f32 v246, v243, v245
    v_mul_f32 v246, s42, v246
    v_exp_f32 v246, v246
    v_mov_b32 v243, v245
    v_mul_f32 v244, v244, v246
    v_mul_f32 v0, v0, v246
    v_mul_f32 v1, v1, v246
    v_mul_f32 v2, v2, v246
    v_mul_f32 v3, v3, v246
    v_mul_f32 v4, v4, v246
    v_mul_f32 v5, v5, v246
    v_mul_f32 v6, v6, v246
    v_mul_f32 v7, v7, v246
    v_mul_f32 v8, v8, v246
    v_mul_f32 v9, v9, v246
    v_mul_f32 v10, v10, v246
    v_mul_f32 v11, v11, v246
    v_mul_f32 v12, v12, v246
    v_mul_f32 v13, v13, v246
    v_mul_f32 v14, v14, v246
    v_mul_f32 v15, v15, v246
    v_mul_f32 v16, v16, v246
    v_mul_f32 v17, v17, v246
    v_mul_f32 v18, v18, v246
    v_mul_f32 v19, v19, v246
    v_mul_f32 v20, v20, v246
    v_mul_f32 v21, v21, v246
    v_mul_f32 v22, v22, v246
    v_mul_f32 v23, v23, v246
    v_mul_f32 v24, v24, v246
    v_mul_f32 v25, v25, v246
    v_mul_f32 v26, v26, v246
    v_mul_f32 v27, v27, v246
    v_mul_f32 v28, v28, v246
    v_mul_f32 v29, v29, v246
    v_mul_f32 v30, v30, v246
    v_mul_f32 v31, v31, v246
    v_mul_f32 v32, v32, v246
    v_mul_f32 v33, v33, v246
    v_mul_f32 v34, v34, v246
    v_mul_f32 v35, v35, v246
    v_mul_f32 v36, v36, v246
    v_mul_f32 v37, v37, v246
    v_mul_f32 v38, v38, v246
    v_mul_f32 v39, v39, v246
    v_mul_f32 v40, v40, v246
    v_mul_f32 v41, v41, v246
    v_mul_f32 v42, v42, v246
    v_mul_f32 v43, v43, v246
    v_mul_f32 v44, v44, v246
    v_mul_f32 v45, v45, v246
    v_mul_f32 v46, v46, v246
    v_mul_f32 v47, v47, v246
    v_mul_f32 v48, v48, v246
    v_mul_f32 v49, v49, v246
    v_mul_f32 v50, v50, v246
    v_mul_f32 v51, v51, v246
    v_mul_f32 v52, v52, v246
    v_mul_f32 v53, v53, v246
    v_mul_f32 v54, v54, v246
    v_mul_f32 v55, v55, v246
    v_mul_f32 v56, v56, v246
    v_mul_f32 v57, v57, v246
    v_mul_f32 v58, v58, v246
    v_mul_f32 v59, v59, v246
    v_mul_f32 v60, v60, v246
    v_mul_f32 v61, v61, v246
    v_mul_f32 v62, v62, v246
    v_mul_f32 v63, v63, v246
    v_mul_f32 v245, s42, v243
    v_fma_f32 v64, v64, s42, -v245
    v_fma_f32 v65, v65, s42, -v245
    v_fma_f32 v66, v66, s42, -v245
    v_fma_f32 v67, v67, s42, -v245
    v_fma_f32 v68, v68, s42, -v245
    v_fma_f32 v69, v69, s42, -v245
    v_fma_f32 v70, v70, s42, -v245
    v_fma_f32 v71, v71, s42, -v245
    v_exp_f32 v64, v64
    v_exp_f32 v65, v65
    v_exp_f32 v66, v66
    v_exp_f32 v67, v67
    v_exp_f32 v68, v68
    v_exp_f32 v69, v69
    v_exp_f32 v70, v70
    v_exp_f32 v71, v71
    v_add_f32 v247, v64, v68
    v_add_f32 v248, v65, v69
    v_add_f32 v249, v66, v70
    v_add_f32 v250, v67, v71
    v_cvt_pk_bf16_f32 v160, v64, v65
    v_cvt_pk_bf16_f32 v161, v66, v67
    v_cvt_pk_bf16_f32 v162, v68, v69
    v_cvt_pk_bf16_f32 v163, v70, v71
    v_fma_f32 v72, v72, s42, -v245
    v_fma_f32 v73, v73, s42, -v245
    v_fma_f32 v74, v74, s42, -v245
    v_fma_f32 v75, v75, s42, -v245
    v_fma_f32 v76, v76, s42, -v245
    v_fma_f32 v77, v77, s42, -v245
    v_fma_f32 v78, v78, s42, -v245
    v_fma_f32 v79, v79, s42, -v245
    v_exp_f32 v72, v72
    v_exp_f32 v73, v73
    v_exp_f32 v74, v74
    v_exp_f32 v75, v75
    v_exp_f32 v76, v76
    v_exp_f32 v77, v77
    v_exp_f32 v78, v78
    v_exp_f32 v79, v79
    v_add_f32 v247, v247, v72
    v_add_f32 v248, v248, v73
    v_add_f32 v249, v249, v74
    v_add_f32 v250, v250, v75
    v_add_f32 v247, v247, v76
    v_add_f32 v248, v248, v77
    v_add_f32 v249, v249, v78
    v_add_f32 v250, v250, v79
    v_cvt_pk_bf16_f32 v164, v72, v73
    v_cvt_pk_bf16_f32 v165, v74, v75
    v_cvt_pk_bf16_f32 v166, v76, v77
    v_cvt_pk_bf16_f32 v167, v78, v79
    v_fma_f32 v80, v80, s42, -v245
    v_fma_f32 v81, v81, s42, -v245
    v_fma_f32 v82, v82, s42, -v245
    v_fma_f32 v83, v83, s42, -v245
    v_fma_f32 v84, v84, s42, -v245
    v_fma_f32 v85, v85, s42, -v245
    v_fma_f32 v86, v86, s42, -v245
    v_fma_f32 v87, v87, s42, -v245
    v_exp_f32 v80, v80
    v_exp_f32 v81, v81
    v_exp_f32 v82, v82
    v_exp_f32 v83, v83
    v_exp_f32 v84, v84
    v_exp_f32 v85, v85
    v_exp_f32 v86, v86
    v_exp_f32 v87, v87
    v_add_f32 v247, v247, v80
    v_add_f32 v248, v248, v81
    v_add_f32 v249, v249, v82
    v_add_f32 v250, v250, v83
    v_add_f32 v247, v247, v84
    v_add_f32 v248, v248, v85
    v_add_f32 v249, v249, v86
    v_add_f32 v250, v250, v87
    v_cvt_pk_bf16_f32 v168, v80, v81
    v_cvt_pk_bf16_f32 v169, v82, v83
    v_cvt_pk_bf16_f32 v170, v84, v85
    v_cvt_pk_bf16_f32 v171, v86, v87
    v_fma_f32 v88, v88, s42, -v245
    v_fma_f32 v89, v89, s42, -v245
    v_fma_f32 v90, v90, s42, -v245
    v_fma_f32 v91, v91, s42, -v245
    v_fma_f32 v92, v92, s42, -v245
    v_fma_f32 v93, v93, s42, -v245
    v_fma_f32 v94, v94, s42, -v245
    v_fma_f32 v95, v95, s42, -v245
    v_exp_f32 v88, v88
    v_exp_f32 v89, v89
    v_exp_f32 v90, v90
    v_exp_f32 v91, v91
    v_exp_f32 v92, v92
    v_exp_f32 v93, v93
    v_exp_f32 v94, v94
    v_exp_f32 v95, v95
    v_add_f32 v247, v247, v88
    v_add_f32 v248, v248, v89
    v_add_f32 v249, v249, v90
    v_add_f32 v250, v250, v91
    v_add_f32 v247, v247, v92
    v_add_f32 v248, v248, v93
    v_add_f32 v249, v249, v94
    v_add_f32 v250, v250, v95
    v_cvt_pk_bf16_f32 v172, v88, v89
    v_cvt_pk_bf16_f32 v173, v90, v91
    v_cvt_pk_bf16_f32 v174, v92, v93
    v_cvt_pk_bf16_f32 v175, v94, v95
    v_fma_f32 v96, v96, s42, -v245
    v_fma_f32 v97, v97, s42, -v245
    v_fma_f32 v98, v98, s42, -v245
    v_fma_f32 v99, v99, s42, -v245
    v_fma_f32 v100, v100, s42, -v245
    v_fma_f32 v101, v101, s42, -v245
    v_fma_f32 v102, v102, s42, -v245
    v_fma_f32 v103, v103, s42, -v245
    v_exp_f32 v96, v96
    v_exp_f32 v97, v97
    v_exp_f32 v98, v98
    v_exp_f32 v99, v99
    v_exp_f32 v100, v100
    v_exp_f32 v101, v101
    v_exp_f32 v102, v102
    v_exp_f32 v103, v103
    v_add_f32 v247, v247, v96
    v_add_f32 v248, v248, v97
    v_add_f32 v249, v249, v98
    v_add_f32 v250, v250, v99
    v_add_f32 v247, v247, v100
    v_add_f32 v248, v248, v101
    v_add_f32 v249, v249, v102
    v_add_f32 v250, v250, v103
    v_cvt_pk_bf16_f32 v176, v96, v97
    v_cvt_pk_bf16_f32 v177, v98, v99
    v_cvt_pk_bf16_f32 v178, v100, v101
    v_cvt_pk_bf16_f32 v179, v102, v103
    v_fma_f32 v104, v104, s42, -v245
    v_fma_f32 v105, v105, s42, -v245
    v_fma_f32 v106, v106, s42, -v245
    v_fma_f32 v107, v107, s42, -v245
    v_fma_f32 v108, v108, s42, -v245
    v_fma_f32 v109, v109, s42, -v245
    v_fma_f32 v110, v110, s42, -v245
    v_fma_f32 v111, v111, s42, -v245
    v_exp_f32 v104, v104
    v_exp_f32 v105, v105
    v_exp_f32 v106, v106
    v_exp_f32 v107, v107
    v_exp_f32 v108, v108
    v_exp_f32 v109, v109
    v_exp_f32 v110, v110
    v_exp_f32 v111, v111
    v_add_f32 v247, v247, v104
    v_add_f32 v248, v248, v105
    v_add_f32 v249, v249, v106
    v_add_f32 v250, v250, v107
    v_add_f32 v247, v247, v108
    v_add_f32 v248, v248, v109
    v_add_f32 v249, v249, v110
    v_add_f32 v250, v250, v111
    v_cvt_pk_bf16_f32 v180, v104, v105
    v_cvt_pk_bf16_f32 v181, v106, v107
    v_cvt_pk_bf16_f32 v182, v108, v109
    v_cvt_pk_bf16_f32 v183, v110, v111
    v_fma_f32 v112, v112, s42, -v245
    v_fma_f32 v113, v113, s42, -v245
    v_fma_f32 v114, v114, s42, -v245
    v_fma_f32 v115, v115, s42, -v245
    v_fma_f32 v116, v116, s42, -v245
    v_fma_f32 v117, v117, s42, -v245
    v_fma_f32 v118, v118, s42, -v245
    v_fma_f32 v119, v119, s42, -v245
    v_exp_f32 v112, v112
    v_exp_f32 v113, v113
    v_exp_f32 v114, v114
    v_exp_f32 v115, v115
    v_exp_f32 v116, v116
    v_exp_f32 v117, v117
    v_exp_f32 v118, v118
    v_exp_f32 v119, v119
    v_add_f32 v247, v247, v112
    v_add_f32 v248, v248, v113
    v_add_f32 v249, v249, v114
    v_add_f32 v250, v250, v115
    v_add_f32 v247, v247, v116
    v_add_f32 v248, v248, v117
    v_add_f32 v249, v249, v118
    v_add_f32 v250, v250, v119
    v_cvt_pk_bf16_f32 v184, v112, v113
    v_cvt_pk_bf16_f32 v185, v114, v115
    v_cvt_pk_bf16_f32 v186, v116, v117
    v_cvt_pk_bf16_f32 v187, v118, v119
    v_fma_f32 v120, v120, s42, -v245
    v_fma_f32 v121, v121, s42, -v245
    v_fma_f32 v122, v122, s42, -v245
    v_fma_f32 v123, v123, s42, -v245
    v_fma_f32 v124, v124, s42, -v245
    v_fma_f32 v125, v125, s42, -v245
    v_fma_f32 v126, v126, s42, -v245
    v_fma_f32 v127, v127, s42, -v245
    v_exp_f32 v120, v120
    v_exp_f32 v121, v121
    v_exp_f32 v122, v122
    v_exp_f32 v123, v123
    v_exp_f32 v124, v124
    v_exp_f32 v125, v125
    v_exp_f32 v126, v126
    v_exp_f32 v127, v127
    v_add_f32 v247, v247, v120
    v_add_f32 v248, v248, v121
    v_add_f32 v249, v249, v122
    v_add_f32 v250, v250, v123
    v_add_f32 v247, v247, v124
    v_add_f32 v248, v248, v125
    v_add_f32 v249, v249, v126
    v_add_f32 v250, v250, v127
    v_cvt_pk_bf16_f32 v188, v120, v121
    v_cvt_pk_bf16_f32 v189, v122, v123
    v_cvt_pk_bf16_f32 v190, v124, v125
    v_cvt_pk_bf16_f32 v191, v126, v127
    v_add_f32 v247, v247, v248
    v_add_f32 v249, v249, v250
    v_add_f32 v247, v247, v249
    v_add_f32 v244, v244, v247
    s_nop 1
    s_waitcnt lgkmcnt(8)
    v_mfma_f32_32x32x16_bf16 v[0:15], v[200:203], v[160:163], v[0:15]
    ds_read_b64_tr_b16 v[196:197], v234 offset:36864
    ds_read_b64_tr_b16 v[198:199], v234 offset:38912
    v_mfma_f32_32x32x16_bf16 v[16:31], v[204:207], v[160:163], v[16:31]
    ds_read_b64_tr_b16 v[200:201], v235 offset:36864
    ds_read_b64_tr_b16 v[202:203], v235 offset:38912
    s_waitcnt lgkmcnt(8)
    v_mfma_f32_32x32x16_bf16 v[32:47], v[208:211], v[160:163], v[32:47]
    ds_read_b64_tr_b16 v[204:205], v232 offset:40960
    ds_read_b64_tr_b16 v[206:207], v232 offset:43008
    v_mfma_f32_32x32x16_bf16 v[48:63], v[212:215], v[160:163], v[48:63]
    ds_read_b64_tr_b16 v[208:209], v233 offset:40960
    ds_read_b64_tr_b16 v[210:211], v233 offset:43008
    s_waitcnt lgkmcnt(8)
    v_mfma_f32_32x32x16_bf16 v[0:15], v[216:219], v[164:167], v[0:15]
    ds_read_b64_tr_b16 v[212:213], v234 offset:40960
    ds_read_b64_tr_b16 v[214:215], v234 offset:43008
    v_mfma_f32_32x32x16_bf16 v[16:31], v[192:195], v[164:167], v[16:31]
    ds_read_b64_tr_b16 v[216:217], v235 offset:40960
    ds_read_b64_tr_b16 v[218:219], v235 offset:43008
    s_waitcnt lgkmcnt(8)
    v_mfma_f32_32x32x16_bf16 v[32:47], v[196:199], v[164:167], v[32:47]
    ds_read_b64_tr_b16 v[192:193], v232 offset:45056
    ds_read_b64_tr_b16 v[194:195], v232 offset:47104
    v_mfma_f32_32x32x16_bf16 v[48:63], v[200:203], v[164:167], v[48:63]
    ds_read_b64_tr_b16 v[196:197], v233 offset:45056
    ds_read_b64_tr_b16 v[198:199], v233 offset:47104
    s_waitcnt lgkmcnt(8)
    v_mfma_f32_32x32x16_bf16 v[0:15], v[204:207], v[168:171], v[0:15]
    ds_read_b64_tr_b16 v[200:201], v234 offset:45056
    ds_read_b64_tr_b16 v[202:203], v234 offset:47104
    v_mfma_f32_32x32x16_bf16 v[16:31], v[208:211], v[168:171], v[16:31]
    ds_read_b64_tr_b16 v[204:205], v235 offset:45056
    ds_read_b64_tr_b16 v[206:207], v235 offset:47104
    s_waitcnt lgkmcnt(8)
    v_mfma_f32_32x32x16_bf16 v[32:47], v[212:215], v[168:171], v[32:47]
    s_waitcnt vmcnt(8)
    s_barrier
    ds_read_b64_tr_b16 v[208:209], v232 offset:0
    ds_read_b64_tr_b16 v[210:211], v232 offset:2048
    v_mfma_f32_32x32x16_bf16 v[48:63], v[216:219], v[168:171], v[48:63]
    s_add_u32 m0, s29, 16384
    s_add_u32 s31, s27, 65536
    buffer_load_dwordx4 v240, s[16:19], s31 offen offset:0 nt lds
    buffer_load_dwordx4 v240, s[16:19], s31 offen offset:1024 nt lds
    ds_read_b64_tr_b16 v[212:213], v233 offset:0
    ds_read_b64_tr_b16 v[214:215], v233 offset:2048
    s_waitcnt lgkmcnt(8)
    v_mfma_f32_32x32x16_bf16 v[0:15], v[192:195], v[172:175], v[0:15]
    s_add_u32 m0, s29, 16384
    s_add_u32 s31, s27, 65536
    buffer_load_dwordx4 v240, s[16:19], s31 offen offset:2048 nt lds
    buffer_load_dwordx4 v240, s[16:19], s31 offen offset:3072 nt lds
    ds_read_b64_tr_b16 v[216:217], v234 offset:0
    ds_read_b64_tr_b16 v[218:219], v234 offset:2048
    v_mfma_f32_32x32x16_bf16 v[16:31], v[196:199], v[172:175], v[16:31]
    ds_read_b64_tr_b16 v[192:193], v235 offset:0
    ds_read_b64_tr_b16 v[194:195], v235 offset:2048
    s_waitcnt lgkmcnt(8)
    v_mfma_f32_32x32x16_bf16 v[32:47], v[200:203], v[172:175], v[32:47]
    ds_read_b64_tr_b16 v[196:197], v232 offset:4096
    ds_read_b64_tr_b16 v[198:199], v232 offset:6144
    v_mfma_f32_32x32x16_bf16 v[48:63], v[204:207], v[172:175], v[48:63]
    ds_read_b64_tr_b16 v[200:201], v233 offset:4096
    ds_read_b64_tr_b16 v[202:203], v233 offset:6144
    s_nop 1
    s_waitcnt lgkmcnt(8)
    v_mfma_f32_32x32x16_bf16 v[0:15], v[208:211], v[176:179], v[0:15]
    ds_read_b64_tr_b16 v[204:205], v234 offset:4096
    ds_read_b64_tr_b16 v[206:207], v234 offset:6144
    v_mfma_f32_32x32x16_bf16 v[16:31], v[212:215], v[176:179], v[16:31]
    ds_read_b64_tr_b16 v[208:209], v235 offset:4096
    ds_read_b64_tr_b16 v[210:211], v235 offset:6144
    s_waitcnt lgkmcnt(8)
    v_mfma_f32_32x32x16_bf16 v[32:47], v[216:219], v[176:179], v[32:47]
    ds_read_b64_tr_b16 v[212:213], v232 offset:8192
    ds_read_b64_tr_b16 v[214:215], v232 offset:10240
    v_mfma_f32_32x32x16_bf16 v[48:63], v[192:195], v[176:179], v[48:63]
    ds_read_b64_tr_b16 v[216:217], v233 offset:8192
    ds_read_b64_tr_b16 v[218:219], v233 offset:10240
    s_waitcnt lgkmcnt(8)
    v_mfma_f32_32x32x16_bf16 v[0:15], v[196:199], v[180:183], v[0:15]
    ds_read_b64_tr_b16 v[192:193], v234 offset:8192
    ds_read_b64_tr_b16 v[194:195], v234 offset:10240
    v_mfma_f32_32x32x16_bf16 v[16:31], v[200:203], v[180:183], v[16:31]
    ds_read_b64_tr_b16 v[196:197], v235 offset:8192
    ds_read_b64_tr_b16 v[198:199], v235 offset:10240
    s_waitcnt lgkmcnt(8)
    v_mfma_f32_32x32x16_bf16 v[32:47], v[204:207], v[180:183], v[32:47]
    ds_read_b64_tr_b16 v[200:201], v232 offset:12288
    ds_read_b64_tr_b16 v[202:203], v232 offset:14336
    v_mfma_f32_32x32x16_bf16 v[48:63], v[208:211], v[180:183], v[48:63]
    ds_read_b64_tr_b16 v[204:205], v233 offset:12288
    ds_read_b64_tr_b16 v[206:207], v233 offset:14336
    s_waitcnt lgkmcnt(8)
    v_mfma_f32_32x32x16_bf16 v[0:15], v[212:215], v[184:187], v[0:15]
    ds_read_b64_tr_b16 v[208:209], v234 offset:12288
    ds_read_b64_tr_b16 v[210:211], v234 offset:14336
    v_mfma_f32_32x32x16_bf16 v[16:31], v[216:219], v[184:187], v[16:31]
    ds_read_b64_tr_b16 v[212:213], v235 offset:12288
    ds_read_b64_tr_b16 v[214:215], v235 offset:14336
    s_waitcnt lgkmcnt(8)
    v_mfma_f32_32x32x16_bf16 v[32:47], v[192:195], v[184:187], v[32:47]
    s_waitcnt vmcnt(8)
    s_barrier
    ds_read_b128 v[216:219], v224 offset:49152
    v_mfma_f32_32x32x16_bf16 v[48:63], v[196:199], v[184:187], v[48:63]
    s_add_u32 m0, s29, 32768
    s_add_u32 s31, s27, 81920
    buffer_load_dwordx4 v240, s[16:19], s31 offen offset:0 nt lds
    buffer_load_dwordx4 v240, s[16:19], s31 offen offset:1024 nt lds
    ds_read_b128 v[192:195], v224 offset:57344
    s_waitcnt lgkmcnt(6)
    v_mfma_f32_32x32x16_bf16 v[0:15], v[200:203], v[188:191], v[0:15]
    s_add_u32 m0, s29, 32768
    s_add_u32 s31, s27, 81920
    buffer_load_dwordx4 v240, s[16:19], s31 offen offset:2048 nt lds
    buffer_load_dwordx4 v240, s[16:19], s31 offen offset:3072 nt lds
    ds_read_b128 v[196:199], v225 offset:49152
    v_mfma_f32_32x32x16_bf16 v[16:31], v[204:207], v[188:191], v[16:31]
    ds_read_b128 v[200:203], v225 offset:57344
    s_waitcnt lgkmcnt(4)
    v_mfma_f32_32x32x16_bf16 v[32:47], v[208:211], v[188:191], v[32:47]
    ds_read_b128 v[204:207], v226 offset:49152
    v_mfma_f32_32x32x16_bf16 v[48:63], v[212:215], v[188:191], v[48:63]
    ds_read_b128 v[208:211], v226 offset:57344
    s_waitcnt lgkmcnt(4)
    v_mfma_f32_32x32x16_bf16 v[64:79], v[216:219], v[128:131], 0
    ds_read_b128 v[212:215], v227 offset:49152
    v_mfma_f32_32x32x16_bf16 v[80:95], v[192:195], v[128:131], 0
    ds_read_b128 v[216:219], v227 offset:57344
    s_waitcnt lgkmcnt(4)
    v_mfma_f32_32x32x16_bf16 v[64:79], v[196:199], v[132:135], v[64:79]
    ds_read_b128 v[192:195], v228 offset:49152
    v_mfma_f32_32x32x16_bf16 v[80:95], v[200:203], v[132:135], v[80:95]
    ds_read_b128 v[196:199], v228 offset:57344
    s_waitcnt lgkmcnt(4)
    v_mfma_f32_32x32x16_bf16 v[64:79], v[204:207], v[136:139], v[64:79]
    ds_read_b128 v[200:203], v229 offset:49152
    v_mfma_f32_32x32x16_bf16 v[80:95], v[208:211], v[136:139], v[80:95]
    ds_read_b128 v[204:207], v229 offset:57344
    s_waitcnt lgkmcnt(4)
    v_mfma_f32_32x32x16_bf16 v[64:79], v[212:215], v[140:143], v[64:79]
    ds_read_b128 v[208:211], v230 offset:49152
    v_mfma_f32_32x32x16_bf16 v[80:95], v[216:219], v[140:143], v[80:95]
    ds_read_b128 v[212:215], v230 offset:57344
    s_waitcnt lgkmcnt(4)
    v_mfma_f32_32x32x16_bf16 v[64:79], v[192:195], v[144:147], v[64:79]
    ds_read_b128 v[216:219], v231 offset:49152
    v_mfma_f32_32x32x16_bf16 v[80:95], v[196:199], v[144:147], v[80:95]
    ds_read_b128 v[192:195], v231 offset:57344
    s_waitcnt lgkmcnt(4)
    v_mfma_f32_32x32x16_bf16 v[64:79], v[200:203], v[148:151], v[64:79]
    s_waitcnt vmcnt(8)
    s_barrier
    v_add_u32 v224, 0x10000, v224
    v_add_u32 v225, 0x10000, v225
    v_add_u32 v226, 0x10000, v226
    v_add_u32 v227, 0x10000, v227
    v_add_u32 v228, 0x10000, v228
    v_add_u32 v229, 0x10000, v229
    v_add_u32 v230, 0x10000, v230
    v_add_u32 v231, 0x10000, v231
    ds_read_b128 v[196:199], v224 offset:0
    v_mfma_f32_32x32x16_bf16 v[80:95], v[204:207], v[148:151], v[80:95]
    s_add_u32 m0, s29, 0
    s_add_u32 s31, s27, 98304
    buffer_load_dwordx4 v236, s[12:15], s31 offen offset:0 nt lds
    buffer_load_dwordx4 v237, s[12:15], s31 offen offset:1024 nt lds
    ds_read_b128 v[200:203], v224 offset:8192
    s_waitcnt lgkmcnt(4)
    v_mfma_f32_32x32x16_bf16 v[64:79], v[208:211], v[152:155], v[64:79]
    s_add_u32 m0, s29, 0
    s_add_u32 s31, s27, 98304
    buffer_load_dwordx4 v238, s[12:15], s31 offen offset:2048 nt lds
    buffer_load_dwordx4 v239, s[12:15], s31 offen offset:3072 nt lds
    ds_read_b128 v[204:207], v225 offset:0
    v_mfma_f32_32x32x16_bf16 v[80:95], v[212:215], v[152:155], v[80:95]
    ds_read_b128 v[208:211], v225 offset:8192
    s_waitcnt lgkmcnt(4)
    v_mfma_f32_32x32x16_bf16 v[64:79], v[216:219], v[156:159], v[64:79]
    ds_read_b128 v[212:215], v226 offset:0
    v_mfma_f32_32x32x16_bf16 v[80:95], v[192:195], v[156:159], v[80:95]
    ds_read_b128 v[216:219], v226 offset:8192
    s_waitcnt lgkmcnt(4)
    v_mfma_f32_32x32x16_bf16 v[96:111], v[196:199], v[128:131], 0
    ds_read_b128 v[192:195], v227 offset:0
    v_mfma_f32_32x32x16_bf16 v[112:127], v[200:203], v[128:131], 0
    ds_read_b128 v[196:199], v227 offset:8192
    s_waitcnt lgkmcnt(4)
    v_mfma_f32_32x32x16_bf16 v[96:111], v[204:207], v[132:135], v[96:111]
    ds_read_b128 v[200:203], v228 offset:0
    v_mfma_f32_32x32x16_bf16 v[112:127], v[208:211], v[132:135], v[112:127]
    ds_read_b128 v[204:207], v228 offset:8192
    s_waitcnt lgkmcnt(4)
    v_mfma_f32_32x32x16_bf16 v[96:111], v[212:215], v[136:139], v[96:111]
    ds_read_b128 v[208:211], v229 offset:0
    v_mfma_f32_32x32x16_bf16 v[112:127], v[216:219], v[136:139], v[112:127]
    ds_read_b128 v[212:215], v229 offset:8192
    s_waitcnt lgkmcnt(4)
    v_mfma_f32_32x32x16_bf16 v[96:111], v[192:195], v[140:143], v[96:111]
    ds_read_b128 v[216:219], v230 offset:0
    v_mfma_f32_32x32x16_bf16 v[112:127], v[196:199], v[140:143], v[112:127]
    ds_read_b128 v[192:195], v230 offset:8192
    s_waitcnt lgkmcnt(4)
    v_mfma_f32_32x32x16_bf16 v[96:111], v[200:203], v[144:147], v[96:111]
    ds_read_b128 v[196:199], v231 offset:0
    v_mfma_f32_32x32x16_bf16 v[112:127], v[204:207], v[144:147], v[112:127]
    ds_read_b128 v[200:203], v231 offset:8192
    s_waitcnt lgkmcnt(4)
    v_mfma_f32_32x32x16_bf16 v[96:111], v[208:211], v[148:151], v[96:111]
    s_waitcnt vmcnt(8)
    s_barrier
    ds_read_b64_tr_b16 v[204:205], v232 offset:16384
    ds_read_b64_tr_b16 v[206:207], v232 offset:18432
    v_mfma_f32_32x32x16_bf16 v[112:127], v[212:215], v[148:151], v[112:127]
    s_add_u32 m0, s29, 49152
    s_add_u32 s31, s27, 114688
    buffer_load_dwordx4 v236, s[12:15], s31 offen offset:0 nt lds
    buffer_load_dwordx4 v237, s[12:15], s31 offen offset:1024 nt lds
    ds_read_b64_tr_b16 v[208:209], v233 offset:16384
    ds_read_b64_tr_b16 v[210:211], v233 offset:18432
    s_waitcnt lgkmcnt(6)
    v_mfma_f32_32x32x16_bf16 v[96:111], v[216:219], v[152:155], v[96:111]
    s_add_u32 m0, s29, 49152
    s_add_u32 s31, s27, 114688
    buffer_load_dwordx4 v238, s[12:15], s31 offen offset:2048 nt lds
    buffer_load_dwordx4 v239, s[12:15], s31 offen offset:3072 nt lds
    ds_read_b64_tr_b16 v[212:213], v234 offset:16384
    ds_read_b64_tr_b16 v[214:215], v234 offset:18432
    v_mfma_f32_32x32x16_bf16 v[112:127], v[192:195], v[152:155], v[112:127]
    ds_read_b64_tr_b16 v[216:217], v235 offset:16384
    ds_read_b64_tr_b16 v[218:219], v235 offset:18432
    s_waitcnt lgkmcnt(8)
    v_mfma_f32_32x32x16_bf16 v[96:111], v[196:199], v[156:159], v[96:111]
    ds_read_b64_tr_b16 v[192:193], v232 offset:20480
    ds_read_b64_tr_b16 v[194:195], v232 offset:22528
    v_mfma_f32_32x32x16_bf16 v[112:127], v[200:203], v[156:159], v[112:127]
    ds_read_b64_tr_b16 v[196:197], v233 offset:20480
    ds_read_b64_tr_b16 v[198:199], v233 offset:22528
    s_nop 7
    s_nop 5
    v_max3_f32 v245, v64, v65, v66
    v_max3_f32 v246, v80, v81, v82
    v_max3_f32 v247, v96, v97, v98
    v_max3_f32 v248, v112, v113, v114
    v_max3_f32 v245, v245, v67, v68
    v_max3_f32 v246, v246, v83, v84
    v_max3_f32 v247, v247, v99, v100
    v_max3_f32 v248, v248, v115, v116
    v_max3_f32 v245, v245, v69, v70
    v_max3_f32 v246, v246, v85, v86
    v_max3_f32 v247, v247, v101, v102
    v_max3_f32 v248, v248, v117, v118
    v_max3_f32 v245, v245, v71, v72
    v_max3_f32 v246, v246, v87, v88
    v_max3_f32 v247, v247, v103, v104
    v_max3_f32 v248, v248, v119, v120
    v_max3_f32 v245, v245, v73, v74
    v_max3_f32 v246, v246, v89, v90
    v_max3_f32 v247, v247, v105, v106
    v_max3_f32 v248, v248, v121, v122
    v_max3_f32 v245, v245, v75, v76
    v_max3_f32 v246, v246, v91, v92
    v_max3_f32 v247, v247, v107, v108
    v_max3_f32 v248, v248, v123, v124
    v_max3_f32 v245, v245, v77, v78
    v_max3_f32 v246, v246, v93, v94
    v_max3_f32 v247, v247, v109, v110
    v_max3_f32 v248, v248, v125, v126
    v_max_f32 v245, v245, v79
    v_max_f32 v246, v246, v95
    v_max_f32 v247, v247, v111
    v_max_f32 v248, v248, v127
    v_max3_f32 v245, v245, v246, v247
    v_max_f32 v245, v245, v248
    v_mov_b32 v246, v245
    s_nop 1
    v_permlane32_swap_b32 v245, v246
    s_nop 1
    v_max3_f32 v245, v245, v246, v243
    v_sub_f32 v246, v243, v245
    v_mul_f32 v246, s42, v246
    v_exp_f32 v246, v246
    v_mov_b32 v243, v245
    v_mul_f32 v244, v244, v246
    v_mul_f32 v0, v0, v246
    v_mul_f32 v1, v1, v246
    v_mul_f32 v2, v2, v246
    v_mul_f32 v3, v3, v246
    v_mul_f32 v4, v4, v246
    v_mul_f32 v5, v5, v246
    v_mul_f32 v6, v6, v246
    v_mul_f32 v7, v7, v246
    v_mul_f32 v8, v8, v246
    v_mul_f32 v9, v9, v246
    v_mul_f32 v10, v10, v246
    v_mul_f32 v11, v11, v246
    v_mul_f32 v12, v12, v246
    v_mul_f32 v13, v13, v246
    v_mul_f32 v14, v14, v246
    v_mul_f32 v15, v15, v246
    v_mul_f32 v16, v16, v246
    v_mul_f32 v17, v17, v246
    v_mul_f32 v18, v18, v246
    v_mul_f32 v19, v19, v246
    v_mul_f32 v20, v20, v246
    v_mul_f32 v21, v21, v246
    v_mul_f32 v22, v22, v246
    v_mul_f32 v23, v23, v246
    v_mul_f32 v24, v24, v246
    v_mul_f32 v25, v25, v246
    v_mul_f32 v26, v26, v246
    v_mul_f32 v27, v27, v246
    v_mul_f32 v28, v28, v246
    v_mul_f32 v29, v29, v246
    v_mul_f32 v30, v30, v246
    v_mul_f32 v31, v31, v246
    v_mul_f32 v32, v32, v246
    v_mul_f32 v33, v33, v246
    v_mul_f32 v34, v34, v246
    v_mul_f32 v35, v35, v246
    v_mul_f32 v36, v36, v246
    v_mul_f32 v37, v37, v246
    v_mul_f32 v38, v38, v246
    v_mul_f32 v39, v39, v246
    v_mul_f32 v40, v40, v246
    v_mul_f32 v41, v41, v246
    v_mul_f32 v42, v42, v246
    v_mul_f32 v43, v43, v246
    v_mul_f32 v44, v44, v246
    v_mul_f32 v45, v45, v246
    v_mul_f32 v46, v46, v246
    v_mul_f32 v47, v47, v246
    v_mul_f32 v48, v48, v246
    v_mul_f32 v49, v49, v246
    v_mul_f32 v50, v50, v246
    v_mul_f32 v51, v51, v246
    v_mul_f32 v52, v52, v246
    v_mul_f32 v53, v53, v246
    v_mul_f32 v54, v54, v246
    v_mul_f32 v55, v55, v246
    v_mul_f32 v56, v56, v246
    v_mul_f32 v57, v57, v246
    v_mul_f32 v58, v58, v246
    v_mul_f32 v59, v59, v246
    v_mul_f32 v60, v60, v246
    v_mul_f32 v61, v61, v246
    v_mul_f32 v62, v62, v246
    v_mul_f32 v63, v63, v246
    v_mul_f32 v245, s42, v243
    v_fma_f32 v64, v64, s42, -v245
    v_fma_f32 v65, v65, s42, -v245
    v_fma_f32 v66, v66, s42, -v245
    v_fma_f32 v67, v67, s42, -v245
    v_fma_f32 v68, v68, s42, -v245
    v_fma_f32 v69, v69, s42, -v245
    v_fma_f32 v70, v70, s42, -v245
    v_fma_f32 v71, v71, s42, -v245
    v_exp_f32 v64, v64
    v_exp_f32 v65, v65
    v_exp_f32 v66, v66
    v_exp_f32 v67, v67
    v_exp_f32 v68, v68
    v_exp_f32 v69, v69
    v_exp_f32 v70, v70
    v_exp_f32 v71, v71
    v_add_f32 v247, v64, v68
    v_add_f32 v248, v65, v69
    v_add_f32 v249, v66, v70
    v_add_f32 v250, v67, v71
    v_cvt_pk_bf16_f32 v160, v64, v65
    v_cvt_pk_bf16_f32 v161, v66, v67
    v_cvt_pk_bf16_f32 v162, v68, v69
    v_cvt_pk_bf16_f32 v163, v70, v71
    v_fma_f32 v72, v72, s42, -v245
    v_fma_f32 v73, v73, s42, -v245
    v_fma_f32 v74, v74, s42, -v245
    v_fma_f32 v75, v75, s42, -v245
    v_fma_f32 v76, v76, s42, -v245
    v_fma_f32 v77, v77, s42, -v245
    v_fma_f32 v78, v78, s42, -v245
    v_fma_f32 v79, v79, s42, -v245
    v_exp_f32 v72, v72
    v_exp_f32 v73, v73
    v_exp_f32 v74, v74
    v_exp_f32 v75, v75
    v_exp_f32 v76, v76
    v_exp_f32 v77, v77
    v_exp_f32 v78, v78
    v_exp_f32 v79, v79
    v_add_f32 v247, v247, v72
    v_add_f32 v248, v248, v73
    v_add_f32 v249, v249, v74
    v_add_f32 v250, v250, v75
    v_add_f32 v247, v247, v76
    v_add_f32 v248, v248, v77
    v_add_f32 v249, v249, v78
    v_add_f32 v250, v250, v79
    v_cvt_pk_bf16_f32 v164, v72, v73
    v_cvt_pk_bf16_f32 v165, v74, v75
    v_cvt_pk_bf16_f32 v166, v76, v77
    v_cvt_pk_bf16_f32 v167, v78, v79
    v_fma_f32 v80, v80, s42, -v245
    v_fma_f32 v81, v81, s42, -v245
    v_fma_f32 v82, v82, s42, -v245
    v_fma_f32 v83, v83, s42, -v245
    v_fma_f32 v84, v84, s42, -v245
    v_fma_f32 v85, v85, s42, -v245
    v_fma_f32 v86, v86, s42, -v245
    v_fma_f32 v87, v87, s42, -v245
    v_exp_f32 v80, v80
    v_exp_f32 v81, v81
    v_exp_f32 v82, v82
    v_exp_f32 v83, v83
    v_exp_f32 v84, v84
    v_exp_f32 v85, v85
    v_exp_f32 v86, v86
    v_exp_f32 v87, v87
    v_add_f32 v247, v247, v80
    v_add_f32 v248, v248, v81
    v_add_f32 v249, v249, v82
    v_add_f32 v250, v250, v83
    v_add_f32 v247, v247, v84
    v_add_f32 v248, v248, v85
    v_add_f32 v249, v249, v86
    v_add_f32 v250, v250, v87
    v_cvt_pk_bf16_f32 v168, v80, v81
    v_cvt_pk_bf16_f32 v169, v82, v83
    v_cvt_pk_bf16_f32 v170, v84, v85
    v_cvt_pk_bf16_f32 v171, v86, v87
    v_fma_f32 v88, v88, s42, -v245
    v_fma_f32 v89, v89, s42, -v245
    v_fma_f32 v90, v90, s42, -v245
    v_fma_f32 v91, v91, s42, -v245
    v_fma_f32 v92, v92, s42, -v245
    v_fma_f32 v93, v93, s42, -v245
    v_fma_f32 v94, v94, s42, -v245
    v_fma_f32 v95, v95, s42, -v245
    v_exp_f32 v88, v88
    v_exp_f32 v89, v89
    v_exp_f32 v90, v90
    v_exp_f32 v91, v91
    v_exp_f32 v92, v92
    v_exp_f32 v93, v93
    v_exp_f32 v94, v94
    v_exp_f32 v95, v95
    v_add_f32 v247, v247, v88
    v_add_f32 v248, v248, v89
    v_add_f32 v249, v249, v90
    v_add_f32 v250, v250, v91
    v_add_f32 v247, v247, v92
    v_add_f32 v248, v248, v93
    v_add_f32 v249, v249, v94
    v_add_f32 v250, v250, v95
    v_cvt_pk_bf16_f32 v172, v88, v89
    v_cvt_pk_bf16_f32 v173, v90, v91
    v_cvt_pk_bf16_f32 v174, v92, v93
    v_cvt_pk_bf16_f32 v175, v94, v95
    v_fma_f32 v96, v96, s42, -v245
    v_fma_f32 v97, v97, s42, -v245
    v_fma_f32 v98, v98, s42, -v245
    v_fma_f32 v99, v99, s42, -v245
    v_fma_f32 v100, v100, s42, -v245
    v_fma_f32 v101, v101, s42, -v245
    v_fma_f32 v102, v102, s42, -v245
    v_fma_f32 v103, v103, s42, -v245
    v_exp_f32 v96, v96
    v_exp_f32 v97, v97
    v_exp_f32 v98, v98
    v_exp_f32 v99, v99
    v_exp_f32 v100, v100
    v_exp_f32 v101, v101
    v_exp_f32 v102, v102
    v_exp_f32 v103, v103
    v_add_f32 v247, v247, v96
    v_add_f32 v248, v248, v97
    v_add_f32 v249, v249, v98
    v_add_f32 v250, v250, v99
    v_add_f32 v247, v247, v100
    v_add_f32 v248, v248, v101
    v_add_f32 v249, v249, v102
    v_add_f32 v250, v250, v103
    v_cvt_pk_bf16_f32 v176, v96, v97
    v_cvt_pk_bf16_f32 v177, v98, v99
    v_cvt_pk_bf16_f32 v178, v100, v101
    v_cvt_pk_bf16_f32 v179, v102, v103
    v_fma_f32 v104, v104, s42, -v245
    v_fma_f32 v105, v105, s42, -v245
    v_fma_f32 v106, v106, s42, -v245
    v_fma_f32 v107, v107, s42, -v245
    v_fma_f32 v108, v108, s42, -v245
    v_fma_f32 v109, v109, s42, -v245
    v_fma_f32 v110, v110, s42, -v245
    v_fma_f32 v111, v111, s42, -v245
    v_exp_f32 v104, v104
    v_exp_f32 v105, v105
    v_exp_f32 v106, v106
    v_exp_f32 v107, v107
    v_exp_f32 v108, v108
    v_exp_f32 v109, v109
    v_exp_f32 v110, v110
    v_exp_f32 v111, v111
    v_add_f32 v247, v247, v104
    v_add_f32 v248, v248, v105
    v_add_f32 v249, v249, v106
    v_add_f32 v250, v250, v107
    v_add_f32 v247, v247, v108
    v_add_f32 v248, v248, v109
    v_add_f32 v249, v249, v110
    v_add_f32 v250, v250, v111
    v_cvt_pk_bf16_f32 v180, v104, v105
    v_cvt_pk_bf16_f32 v181, v106, v107
    v_cvt_pk_bf16_f32 v182, v108, v109
    v_cvt_pk_bf16_f32 v183, v110, v111
    v_fma_f32 v112, v112, s42, -v245
    v_fma_f32 v113, v113, s42, -v245
    v_fma_f32 v114, v114, s42, -v245
    v_fma_f32 v115, v115, s42, -v245
    v_fma_f32 v116, v116, s42, -v245
    v_fma_f32 v117, v117, s42, -v245
    v_fma_f32 v118, v118, s42, -v245
    v_fma_f32 v119, v119, s42, -v245
    v_exp_f32 v112, v112
    v_exp_f32 v113, v113
    v_exp_f32 v114, v114
    v_exp_f32 v115, v115
    v_exp_f32 v116, v116
    v_exp_f32 v117, v117
    v_exp_f32 v118, v118
    v_exp_f32 v119, v119
    v_add_f32 v247, v247, v112
    v_add_f32 v248, v248, v113
    v_add_f32 v249, v249, v114
    v_add_f32 v250, v250, v115
    v_add_f32 v247, v247, v116
    v_add_f32 v248, v248, v117
    v_add_f32 v249, v249, v118
    v_add_f32 v250, v250, v119
    v_cvt_pk_bf16_f32 v184, v112, v113
    v_cvt_pk_bf16_f32 v185, v114, v115
    v_cvt_pk_bf16_f32 v186, v116, v117
    v_cvt_pk_bf16_f32 v187, v118, v119
    v_fma_f32 v120, v120, s42, -v245
    v_fma_f32 v121, v121, s42, -v245
    v_fma_f32 v122, v122, s42, -v245
    v_fma_f32 v123, v123, s42, -v245
    v_fma_f32 v124, v124, s42, -v245
    v_fma_f32 v125, v125, s42, -v245
    v_fma_f32 v126, v126, s42, -v245
    v_fma_f32 v127, v127, s42, -v245
    v_exp_f32 v120, v120
    v_exp_f32 v121, v121
    v_exp_f32 v122, v122
    v_exp_f32 v123, v123
    v_exp_f32 v124, v124
    v_exp_f32 v125, v125
    v_exp_f32 v126, v126
    v_exp_f32 v127, v127
    v_add_f32 v247, v247, v120
    v_add_f32 v248, v248, v121
    v_add_f32 v249, v249, v122
    v_add_f32 v250, v250, v123
    v_add_f32 v247, v247, v124
    v_add_f32 v248, v248, v125
    v_add_f32 v249, v249, v126
    v_add_f32 v250, v250, v127
    v_cvt_pk_bf16_f32 v188, v120, v121
    v_cvt_pk_bf16_f32 v189, v122, v123
    v_cvt_pk_bf16_f32 v190, v124, v125
    v_cvt_pk_bf16_f32 v191, v126, v127
    v_add_f32 v247, v247, v248
    v_add_f32 v249, v249, v250
    v_add_f32 v247, v247, v249
    v_add_f32 v244, v244, v247
    s_nop 1
    s_waitcnt lgkmcnt(8)
    v_mfma_f32_32x32x16_bf16 v[0:15], v[204:207], v[160:163], v[0:15]
    ds_read_b64_tr_b16 v[200:201], v234 offset:20480
    ds_read_b64_tr_b16 v[202:203], v234 offset:22528
    v_mfma_f32_32x32x16_bf16 v[16:31], v[208:211], v[160:163], v[16:31]
    ds_read_b64_tr_b16 v[204:205], v235 offset:20480
    ds_read_b64_tr_b16 v[206:207], v235 offset:22528
    s_waitcnt lgkmcnt(8)
    v_mfma_f32_32x32x16_bf16 v[32:47], v[212:215], v[160:163], v[32:47]
    ds_read_b64_tr_b16 v[208:209], v232 offset:24576
    ds_read_b64_tr_b16 v[210:211], v232 offset:26624
    v_mfma_f32_32x32x16_bf16 v[48:63], v[216:219], v[160:163], v[48:63]
    ds_read_b64_tr_b16 v[212:213], v233 offset:24576
    ds_read_b64_tr_b16 v[214:215], v233 offset:26624
    s_waitcnt lgkmcnt(8)
    v_mfma_f32_32x32x16_bf16 v[0:15], v[192:195], v[164:167], v[0:15]
    ds_read_b64_tr_b16 v[216:217], v234 offset:24576
    ds_read_b64_tr_b16 v[218:219], v234 offset:26624
    v_mfma_f32_32x32x16_bf16 v[16:31], v[196:199], v[164:167], v[16:31]
    ds_read_b64_tr_b16 v[192:193], v235 offset:24576
    ds_read_b64_tr_b16 v[194:195], v235 offset:26624
    s_waitcnt lgkmcnt(8)
    v_mfma_f32_32x32x16_bf16 v[32:47], v[200:203], v[164:167], v[32:47]
    ds_read_b64_tr_b16 v[196:197], v232 offset:28672
    ds_read_b64_tr_b16 v[198:199], v232 offset:30720
    v_mfma_f32_32x32x16_bf16 v[48:63], v[204:207], v[164:167], v[48:63]
    ds_read_b64_tr_b16 v[200:201], v233 offset:28672
    ds_read_b64_tr_b16 v[202:203], v233 offset:30720
    s_waitcnt lgkmcnt(8)
    v_mfma_f32_32x32x16_bf16 v[0:15], v[208:211], v[168:171], v[0:15]
    ds_read_b64_tr_b16 v[204:205], v234 offset:28672
    ds_read_b64_tr_b16 v[206:207], v234 offset:30720
    v_mfma_f32_32x32x16_bf16 v[16:31], v[212:215], v[168:171], v[16:31]
    ds_read_b64_tr_b16 v[208:209], v235 offset:28672
    ds_read_b64_tr_b16 v[210:211], v235 offset:30720
    s_waitcnt lgkmcnt(8)
    v_mfma_f32_32x32x16_bf16 v[32:47], v[216:219], v[168:171], v[32:47]
    s_waitcnt vmcnt(8)
    s_barrier
    ds_read_b64_tr_b16 v[212:213], v232 offset:32768
    ds_read_b64_tr_b16 v[214:215], v232 offset:34816
    v_mfma_f32_32x32x16_bf16 v[48:63], v[192:195], v[168:171], v[48:63]
    s_add_u32 m0, s29, 65536
    s_add_u32 s31, s27, 98304
    buffer_load_dwordx4 v240, s[16:19], s31 offen offset:0 nt lds
    buffer_load_dwordx4 v240, s[16:19], s31 offen offset:1024 nt lds
    ds_read_b64_tr_b16 v[216:217], v233 offset:32768
    ds_read_b64_tr_b16 v[218:219], v233 offset:34816
    s_waitcnt lgkmcnt(8)
    v_mfma_f32_32x32x16_bf16 v[0:15], v[196:199], v[172:175], v[0:15]
    s_add_u32 m0, s29, 65536
    s_add_u32 s31, s27, 98304
    buffer_load_dwordx4 v240, s[16:19], s31 offen offset:2048 nt lds
    buffer_load_dwordx4 v240, s[16:19], s31 offen offset:3072 nt lds
    ds_read_b64_tr_b16 v[192:193], v234 offset:32768
    ds_read_b64_tr_b16 v[194:195], v234 offset:34816
    v_mfma_f32_32x32x16_bf16 v[16:31], v[200:203], v[172:175], v[16:31]
    ds_read_b64_tr_b16 v[196:197], v235 offset:32768
    ds_read_b64_tr_b16 v[198:199], v235 offset:34816
    s_waitcnt lgkmcnt(8)
    v_mfma_f32_32x32x16_bf16 v[32:47], v[204:207], v[172:175], v[32:47]
    ds_read_b64_tr_b16 v[200:201], v232 offset:36864
    ds_read_b64_tr_b16 v[202:203], v232 offset:38912
    v_mfma_f32_32x32x16_bf16 v[48:63], v[208:211], v[172:175], v[48:63]
    ds_read_b64_tr_b16 v[204:205], v233 offset:36864
    ds_read_b64_tr_b16 v[206:207], v233 offset:38912
    s_nop 1
    s_waitcnt lgkmcnt(8)
    v_mfma_f32_32x32x16_bf16 v[0:15], v[212:215], v[176:179], v[0:15]
    ds_read_b64_tr_b16 v[208:209], v234 offset:36864
    ds_read_b64_tr_b16 v[210:211], v234 offset:38912
    v_mfma_f32_32x32x16_bf16 v[16:31], v[216:219], v[176:179], v[16:31]
    ds_read_b64_tr_b16 v[212:213], v235 offset:36864
    ds_read_b64_tr_b16 v[214:215], v235 offset:38912
    s_waitcnt lgkmcnt(8)
    v_mfma_f32_32x32x16_bf16 v[32:47], v[192:195], v[176:179], v[32:47]
    ds_read_b64_tr_b16 v[216:217], v232 offset:40960
    ds_read_b64_tr_b16 v[218:219], v232 offset:43008
    v_mfma_f32_32x32x16_bf16 v[48:63], v[196:199], v[176:179], v[48:63]
    ds_read_b64_tr_b16 v[192:193], v233 offset:40960
    ds_read_b64_tr_b16 v[194:195], v233 offset:43008
    s_waitcnt lgkmcnt(8)
    v_mfma_f32_32x32x16_bf16 v[0:15], v[200:203], v[180:183], v[0:15]
    ds_read_b64_tr_b16 v[196:197], v234 offset:40960
    ds_read_b64_tr_b16 v[198:199], v234 offset:43008
    v_mfma_f32_32x32x16_bf16 v[16:31], v[204:207], v[180:183], v[16:31]
    ds_read_b64_tr_b16 v[200:201], v235 offset:40960
    ds_read_b64_tr_b16 v[202:203], v235 offset:43008
    s_waitcnt lgkmcnt(8)
    v_mfma_f32_32x32x16_bf16 v[32:47], v[208:211], v[180:183], v[32:47]
    ds_read_b64_tr_b16 v[204:205], v232 offset:45056
    ds_read_b64_tr_b16 v[206:207], v232 offset:47104
    v_mfma_f32_32x32x16_bf16 v[48:63], v[212:215], v[180:183], v[48:63]
    ds_read_b64_tr_b16 v[208:209], v233 offset:45056
    ds_read_b64_tr_b16 v[210:211], v233 offset:47104
    s_waitcnt lgkmcnt(8)
    v_mfma_f32_32x32x16_bf16 v[0:15], v[216:219], v[184:187], v[0:15]
    ds_read_b64_tr_b16 v[212:213], v234 offset:45056
    ds_read_b64_tr_b16 v[214:215], v234 offset:47104
    v_mfma_f32_32x32x16_bf16 v[16:31], v[192:195], v[184:187], v[16:31]
    ds_read_b64_tr_b16 v[216:217], v235 offset:45056
    ds_read_b64_tr_b16 v[218:219], v235 offset:47104
    s_waitcnt lgkmcnt(8)
    v_mfma_f32_32x32x16_bf16 v[32:47], v[196:199], v[184:187], v[32:47]
    s_waitcnt vmcnt(8)
    s_barrier
    v_add_u32 v224, 0xffff0000, v224
    v_add_u32 v225, 0xffff0000, v225
    v_add_u32 v226, 0xffff0000, v226
    v_add_u32 v227, 0xffff0000, v227
    v_add_u32 v228, 0xffff0000, v228
    v_add_u32 v229, 0xffff0000, v229
    v_add_u32 v230, 0xffff0000, v230
    v_add_u32 v231, 0xffff0000, v231
    ds_read_b128 v[192:195], v224 offset:0
    v_mfma_f32_32x32x16_bf16 v[48:63], v[200:203], v[184:187], v[48:63]
    s_add_u32 m0, s29, 16384
    s_add_u32 s31, s27, 114688
    buffer_load_dwordx4 v240, s[16:19], s31 offen offset:0 nt lds
    buffer_load_dwordx4 v240, s[16:19], s31 offen offset:1024 nt lds
    ds_read_b128 v[196:199], v224 offset:8192
    s_waitcnt lgkmcnt(6)
    v_mfma_f32_32x32x16_bf16 v[0:15], v[204:207], v[188:191], v[0:15]
    s_add_u32 m0, s29, 16384
    s_add_u32 s31, s27, 114688
    buffer_load_dwordx4 v240, s[16:19], s31 offen offset:2048 nt lds
    buffer_load_dwordx4 v240, s[16:19], s31 offen offset:3072 nt lds
    ds_read_b128 v[200:203], v225 offset:0
    v_mfma_f32_32x32x16_bf16 v[16:31], v[208:211], v[188:191], v[16:31]
    ds_read_b128 v[204:207], v225 offset:8192
    s_waitcnt lgkmcnt(4)
    v_mfma_f32_32x32x16_bf16 v[32:47], v[212:215], v[188:191], v[32:47]
    ds_read_b128 v[208:211], v226 offset:0
    v_mfma_f32_32x32x16_bf16 v[48:63], v[216:219], v[188:191], v[48:63]
    ds_read_b128 v[212:215], v226 offset:8192
    s_waitcnt lgkmcnt(4)
    v_mfma_f32_32x32x16_bf16 v[64:79], v[192:195], v[128:131], 0
    ds_read_b128 v[216:219], v227 offset:0
    v_mfma_f32_32x32x16_bf16 v[80:95], v[196:199], v[128:131], 0
    ds_read_b128 v[192:195], v227 offset:8192
    s_waitcnt lgkmcnt(4)
    v_mfma_f32_32x32x16_bf16 v[64:79], v[200:203], v[132:135], v[64:79]
    ds_read_b128 v[196:199], v228 offset:0
    v_mfma_f32_32x32x16_bf16 v[80:95], v[204:207], v[132:135], v[80:95]
    ds_read_b128 v[200:203], v228 offset:8192
    s_waitcnt lgkmcnt(4)
    v_mfma_f32_32x32x16_bf16 v[64:79], v[208:211], v[136:139], v[64:79]
    ds_read_b128 v[204:207], v229 offset:0
    v_mfma_f32_32x32x16_bf16 v[80:95], v[212:215], v[136:139], v[80:95]
    ds_read_b128 v[208:211], v229 offset:8192
    s_waitcnt lgkmcnt(4)
    v_mfma_f32_32x32x16_bf16 v[64:79], v[216:219], v[140:143], v[64:79]
    ds_read_b128 v[212:215], v230 offset:0
    v_mfma_f32_32x32x16_bf16 v[80:95], v[192:195], v[140:143], v[80:95]
    ds_read_b128 v[216:219], v230 offset:8192
    s_waitcnt lgkmcnt(4)
    v_mfma_f32_32x32x16_bf16 v[64:79], v[196:199], v[144:147], v[64:79]
    ds_read_b128 v[192:195], v231 offset:0
    v_mfma_f32_32x32x16_bf16 v[80:95], v[200:203], v[144:147], v[80:95]
    ds_read_b128 v[196:199], v231 offset:8192
    s_waitcnt lgkmcnt(4)
    v_mfma_f32_32x32x16_bf16 v[64:79], v[204:207], v[148:151], v[64:79]
    s_waitcnt vmcnt(8)
    s_barrier
    ds_read_b128 v[200:203], v224 offset:49152
    v_mfma_f32_32x32x16_bf16 v[80:95], v[208:211], v[148:151], v[80:95]
    ds_read_b128 v[204:207], v224 offset:57344
    s_waitcnt lgkmcnt(4)
    v_mfma_f32_32x32x16_bf16 v[64:79], v[212:215], v[152:155], v[64:79]
    ds_read_b128 v[208:211], v225 offset:49152
    v_mfma_f32_32x32x16_bf16 v[80:95], v[216:219], v[152:155], v[80:95]
    ds_read_b128 v[212:215], v225 offset:57344
    s_waitcnt lgkmcnt(4)
    v_mfma_f32_32x32x16_bf16 v[64:79], v[192:195], v[156:159], v[64:79]
    ds_read_b128 v[216:219], v226 offset:49152
    v_mfma_f32_32x32x16_bf16 v[80:95], v[196:199], v[156:159], v[80:95]
    ds_read_b128 v[192:195], v226 offset:57344
    s_waitcnt lgkmcnt(4)
    v_mfma_f32_32x32x16_bf16 v[96:111], v[200:203], v[128:131], 0
    ds_read_b128 v[196:199], v227 offset:49152
    v_mfma_f32_32x32x16_bf16 v[112:127], v[204:207], v[128:131], 0
    ds_read_b128 v[200:203], v227 offset:57344
    s_waitcnt lgkmcnt(4)
    v_mfma_f32_32x32x16_bf16 v[96:111], v[208:211], v[132:135], v[96:111]
    ds_read_b128 v[204:207], v228 offset:49152
    v_mfma_f32_32x32x16_bf16 v[112:127], v[212:215], v[132:135], v[112:127]
    ds_read_b128 v[208:211], v228 offset:57344
    s_waitcnt lgkmcnt(4)
    v_mfma_f32_32x32x16_bf16 v[96:111], v[216:219], v[136:139], v[96:111]
    ds_read_b128 v[212:215], v229 offset:49152
    v_mfma_f32_32x32x16_bf16 v[112:127], v[192:195], v[136:139], v[112:127]
    ds_read_b128 v[216:219], v229 offset:57344
    s_waitcnt lgkmcnt(4)
    v_mfma_f32_32x32x16_bf16 v[96:111], v[196:199], v[140:143], v[96:111]
    ds_read_b128 v[192:195], v230 offset:49152
    v_mfma_f32_32x32x16_bf16 v[112:127], v[200:203], v[140:143], v[112:127]
    ds_read_b128 v[196:199], v230 offset:57344
    s_waitcnt lgkmcnt(4)
    v_mfma_f32_32x32x16_bf16 v[96:111], v[204:207], v[144:147], v[96:111]
    ds_read_b128 v[200:203], v231 offset:49152
    v_mfma_f32_32x32x16_bf16 v[112:127], v[208:211], v[144:147], v[112:127]
    ds_read_b128 v[204:207], v231 offset:57344
    s_waitcnt lgkmcnt(4)
    v_mfma_f32_32x32x16_bf16 v[96:111], v[212:215], v[148:151], v[96:111]
    s_waitcnt vmcnt(4)
    s_barrier
    v_add_u32 v232, 0x10000, v232
    v_add_u32 v233, 0x10000, v233
    v_add_u32 v234, 0x10000, v234
    v_add_u32 v235, 0x10000, v235
    ds_read_b64_tr_b16 v[208:209], v232 offset:0
    ds_read_b64_tr_b16 v[210:211], v232 offset:2048
    v_mfma_f32_32x32x16_bf16 v[112:127], v[216:219], v[148:151], v[112:127]
    ds_read_b64_tr_b16 v[212:213], v233 offset:0
    ds_read_b64_tr_b16 v[214:215], v233 offset:2048
    s_waitcnt lgkmcnt(6)
    v_mfma_f32_32x32x16_bf16 v[96:111], v[192:195], v[152:155], v[96:111]
    ds_read_b64_tr_b16 v[216:217], v234 offset:0
    ds_read_b64_tr_b16 v[218:219], v234 offset:2048
    v_mfma_f32_32x32x16_bf16 v[112:127], v[196:199], v[152:155], v[112:127]
    ds_read_b64_tr_b16 v[192:193], v235 offset:0
    ds_read_b64_tr_b16 v[194:195], v235 offset:2048
    s_waitcnt lgkmcnt(8)
    v_mfma_f32_32x32x16_bf16 v[96:111], v[200:203], v[156:159], v[96:111]
    ds_read_b64_tr_b16 v[196:197], v232 offset:4096
    ds_read_b64_tr_b16 v[198:199], v232 offset:6144
    v_mfma_f32_32x32x16_bf16 v[112:127], v[204:207], v[156:159], v[112:127]
    ds_read_b64_tr_b16 v[200:201], v233 offset:4096
    ds_read_b64_tr_b16 v[202:203], v233 offset:6144
    s_nop 7
    s_nop 5
    v_max3_f32 v245, v64, v65, v66
    v_max3_f32 v246, v80, v81, v82
    v_max3_f32 v247, v96, v97, v98
    v_max3_f32 v248, v112, v113, v114
    v_max3_f32 v245, v245, v67, v68
    v_max3_f32 v246, v246, v83, v84
    v_max3_f32 v247, v247, v99, v100
    v_max3_f32 v248, v248, v115, v116
    v_max3_f32 v245, v245, v69, v70
    v_max3_f32 v246, v246, v85, v86
    v_max3_f32 v247, v247, v101, v102
    v_max3_f32 v248, v248, v117, v118
    v_max3_f32 v245, v245, v71, v72
    v_max3_f32 v246, v246, v87, v88
    v_max3_f32 v247, v247, v103, v104
    v_max3_f32 v248, v248, v119, v120
    v_max3_f32 v245, v245, v73, v74
    v_max3_f32 v246, v246, v89, v90
    v_max3_f32 v247, v247, v105, v106
    v_max3_f32 v248, v248, v121, v122
    v_max3_f32 v245, v245, v75, v76
    v_max3_f32 v246, v246, v91, v92
    v_max3_f32 v247, v247, v107, v108
    v_max3_f32 v248, v248, v123, v124
    v_max3_f32 v245, v245, v77, v78
    v_max3_f32 v246, v246, v93, v94
    v_max3_f32 v247, v247, v109, v110
    v_max3_f32 v248, v248, v125, v126
    v_max_f32 v245, v245, v79
    v_max_f32 v246, v246, v95
    v_max_f32 v247, v247, v111
    v_max_f32 v248, v248, v127
    v_max3_f32 v245, v245, v246, v247
    v_max_f32 v245, v245, v248
    v_mov_b32 v246, v245
    s_nop 1
    v_permlane32_swap_b32 v245, v246
    s_nop 1
    v_max3_f32 v245, v245, v246, v243
    v_sub_f32 v246, v243, v245
    v_mul_f32 v246, s42, v246
    v_exp_f32 v246, v246
    v_mov_b32 v243, v245
    v_mul_f32 v244, v244, v246
    v_mul_f32 v0, v0, v246
    v_mul_f32 v1, v1, v246
    v_mul_f32 v2, v2, v246
    v_mul_f32 v3, v3, v246
    v_mul_f32 v4, v4, v246
    v_mul_f32 v5, v5, v246
    v_mul_f32 v6, v6, v246
    v_mul_f32 v7, v7, v246
    v_mul_f32 v8, v8, v246
    v_mul_f32 v9, v9, v246
    v_mul_f32 v10, v10, v246
    v_mul_f32 v11, v11, v246
    v_mul_f32 v12, v12, v246
    v_mul_f32 v13, v13, v246
    v_mul_f32 v14, v14, v246
    v_mul_f32 v15, v15, v246
    v_mul_f32 v16, v16, v246
    v_mul_f32 v17, v17, v246
    v_mul_f32 v18, v18, v246
    v_mul_f32 v19, v19, v246
    v_mul_f32 v20, v20, v246
    v_mul_f32 v21, v21, v246
    v_mul_f32 v22, v22, v246
    v_mul_f32 v23, v23, v246
    v_mul_f32 v24, v24, v246
    v_mul_f32 v25, v25, v246
    v_mul_f32 v26, v26, v246
    v_mul_f32 v27, v27, v246
    v_mul_f32 v28, v28, v246
    v_mul_f32 v29, v29, v246
    v_mul_f32 v30, v30, v246
    v_mul_f32 v31, v31, v246
    v_mul_f32 v32, v32, v246
    v_mul_f32 v33, v33, v246
    v_mul_f32 v34, v34, v246
    v_mul_f32 v35, v35, v246
    v_mul_f32 v36, v36, v246
    v_mul_f32 v37, v37, v246
    v_mul_f32 v38, v38, v246
    v_mul_f32 v39, v39, v246
    v_mul_f32 v40, v40, v246
    v_mul_f32 v41, v41, v246
    v_mul_f32 v42, v42, v246
    v_mul_f32 v43, v43, v246
    v_mul_f32 v44, v44, v246
    v_mul_f32 v45, v45, v246
    v_mul_f32 v46, v46, v246
    v_mul_f32 v47, v47, v246
    v_mul_f32 v48, v48, v246
    v_mul_f32 v49, v49, v246
    v_mul_f32 v50, v50, v246
    v_mul_f32 v51, v51, v246
    v_mul_f32 v52, v52, v246
    v_mul_f32 v53, v53, v246
    v_mul_f32 v54, v54, v246
    v_mul_f32 v55, v55, v246
    v_mul_f32 v56, v56, v246
    v_mul_f32 v57, v57, v246
    v_mul_f32 v58, v58, v246
    v_mul_f32 v59, v59, v246
    v_mul_f32 v60, v60, v246
    v_mul_f32 v61, v61, v246
    v_mul_f32 v62, v62, v246
    v_mul_f32 v63, v63, v246
    v_mul_f32 v245, s42, v243
    v_fma_f32 v64, v64, s42, -v245
    v_fma_f32 v65, v65, s42, -v245
    v_fma_f32 v66, v66, s42, -v245
    v_fma_f32 v67, v67, s42, -v245
    v_fma_f32 v68, v68, s42, -v245
    v_fma_f32 v69, v69, s42, -v245
    v_fma_f32 v70, v70, s42, -v245
    v_fma_f32 v71, v71, s42, -v245
    v_exp_f32 v64, v64
    v_exp_f32 v65, v65
    v_exp_f32 v66, v66
    v_exp_f32 v67, v67
    v_exp_f32 v68, v68
    v_exp_f32 v69, v69
    v_exp_f32 v70, v70
    v_exp_f32 v71, v71
    v_add_f32 v247, v64, v68
    v_add_f32 v248, v65, v69
    v_add_f32 v249, v66, v70
    v_add_f32 v250, v67, v71
    v_cvt_pk_bf16_f32 v160, v64, v65
    v_cvt_pk_bf16_f32 v161, v66, v67
    v_cvt_pk_bf16_f32 v162, v68, v69
    v_cvt_pk_bf16_f32 v163, v70, v71
    v_fma_f32 v72, v72, s42, -v245
    v_fma_f32 v73, v73, s42, -v245
    v_fma_f32 v74, v74, s42, -v245
    v_fma_f32 v75, v75, s42, -v245
    v_fma_f32 v76, v76, s42, -v245
    v_fma_f32 v77, v77, s42, -v245
    v_fma_f32 v78, v78, s42, -v245
    v_fma_f32 v79, v79, s42, -v245
    v_exp_f32 v72, v72
    v_exp_f32 v73, v73
    v_exp_f32 v74, v74
    v_exp_f32 v75, v75
    v_exp_f32 v76, v76
    v_exp_f32 v77, v77
    v_exp_f32 v78, v78
    v_exp_f32 v79, v79
    v_add_f32 v247, v247, v72
    v_add_f32 v248, v248, v73
    v_add_f32 v249, v249, v74
    v_add_f32 v250, v250, v75
    v_add_f32 v247, v247, v76
    v_add_f32 v248, v248, v77
    v_add_f32 v249, v249, v78
    v_add_f32 v250, v250, v79
    v_cvt_pk_bf16_f32 v164, v72, v73
    v_cvt_pk_bf16_f32 v165, v74, v75
    v_cvt_pk_bf16_f32 v166, v76, v77
    v_cvt_pk_bf16_f32 v167, v78, v79
    v_fma_f32 v80, v80, s42, -v245
    v_fma_f32 v81, v81, s42, -v245
    v_fma_f32 v82, v82, s42, -v245
    v_fma_f32 v83, v83, s42, -v245
    v_fma_f32 v84, v84, s42, -v245
    v_fma_f32 v85, v85, s42, -v245
    v_fma_f32 v86, v86, s42, -v245
    v_fma_f32 v87, v87, s42, -v245
    v_exp_f32 v80, v80
    v_exp_f32 v81, v81
    v_exp_f32 v82, v82
    v_exp_f32 v83, v83
    v_exp_f32 v84, v84
    v_exp_f32 v85, v85
    v_exp_f32 v86, v86
    v_exp_f32 v87, v87
    v_add_f32 v247, v247, v80
    v_add_f32 v248, v248, v81
    v_add_f32 v249, v249, v82
    v_add_f32 v250, v250, v83
    v_add_f32 v247, v247, v84
    v_add_f32 v248, v248, v85
    v_add_f32 v249, v249, v86
    v_add_f32 v250, v250, v87
    v_cvt_pk_bf16_f32 v168, v80, v81
    v_cvt_pk_bf16_f32 v169, v82, v83
    v_cvt_pk_bf16_f32 v170, v84, v85
    v_cvt_pk_bf16_f32 v171, v86, v87
    v_fma_f32 v88, v88, s42, -v245
    v_fma_f32 v89, v89, s42, -v245
    v_fma_f32 v90, v90, s42, -v245
    v_fma_f32 v91, v91, s42, -v245
    v_fma_f32 v92, v92, s42, -v245
    v_fma_f32 v93, v93, s42, -v245
    v_fma_f32 v94, v94, s42, -v245
    v_fma_f32 v95, v95, s42, -v245
    v_exp_f32 v88, v88
    v_exp_f32 v89, v89
    v_exp_f32 v90, v90
    v_exp_f32 v91, v91
    v_exp_f32 v92, v92
    v_exp_f32 v93, v93
    v_exp_f32 v94, v94
    v_exp_f32 v95, v95
    v_add_f32 v247, v247, v88
    v_add_f32 v248, v248, v89
    v_add_f32 v249, v249, v90
    v_add_f32 v250, v250, v91
    v_add_f32 v247, v247, v92
    v_add_f32 v248, v248, v93
    v_add_f32 v249, v249, v94
    v_add_f32 v250, v250, v95
    v_cvt_pk_bf16_f32 v172, v88, v89
    v_cvt_pk_bf16_f32 v173, v90, v91
    v_cvt_pk_bf16_f32 v174, v92, v93
    v_cvt_pk_bf16_f32 v175, v94, v95
    v_fma_f32 v96, v96, s42, -v245
    v_fma_f32 v97, v97, s42, -v245
    v_fma_f32 v98, v98, s42, -v245
    v_fma_f32 v99, v99, s42, -v245
    v_fma_f32 v100, v100, s42, -v245
    v_fma_f32 v101, v101, s42, -v245
    v_fma_f32 v102, v102, s42, -v245
    v_fma_f32 v103, v103, s42, -v245
    v_exp_f32 v96, v96
    v_exp_f32 v97, v97
    v_exp_f32 v98, v98
    v_exp_f32 v99, v99
    v_exp_f32 v100, v100
    v_exp_f32 v101, v101
    v_exp_f32 v102, v102
    v_exp_f32 v103, v103
    v_add_f32 v247, v247, v96
    v_add_f32 v248, v248, v97
    v_add_f32 v249, v249, v98
    v_add_f32 v250, v250, v99
    v_add_f32 v247, v247, v100
    v_add_f32 v248, v248, v101
    v_add_f32 v249, v249, v102
    v_add_f32 v250, v250, v103
    v_cvt_pk_bf16_f32 v176, v96, v97
    v_cvt_pk_bf16_f32 v177, v98, v99
    v_cvt_pk_bf16_f32 v178, v100, v101
    v_cvt_pk_bf16_f32 v179, v102, v103
    v_fma_f32 v104, v104, s42, -v245
    v_fma_f32 v105, v105, s42, -v245
    v_fma_f32 v106, v106, s42, -v245
    v_fma_f32 v107, v107, s42, -v245
    v_fma_f32 v108, v108, s42, -v245
    v_fma_f32 v109, v109, s42, -v245
    v_fma_f32 v110, v110, s42, -v245
    v_fma_f32 v111, v111, s42, -v245
    v_exp_f32 v104, v104
    v_exp_f32 v105, v105
    v_exp_f32 v106, v106
    v_exp_f32 v107, v107
    v_exp_f32 v108, v108
    v_exp_f32 v109, v109
    v_exp_f32 v110, v110
    v_exp_f32 v111, v111
    v_add_f32 v247, v247, v104
    v_add_f32 v248, v248, v105
    v_add_f32 v249, v249, v106
    v_add_f32 v250, v250, v107
    v_add_f32 v247, v247, v108
    v_add_f32 v248, v248, v109
    v_add_f32 v249, v249, v110
    v_add_f32 v250, v250, v111
    v_cvt_pk_bf16_f32 v180, v104, v105
    v_cvt_pk_bf16_f32 v181, v106, v107
    v_cvt_pk_bf16_f32 v182, v108, v109
    v_cvt_pk_bf16_f32 v183, v110, v111
    v_fma_f32 v112, v112, s42, -v245
    v_fma_f32 v113, v113, s42, -v245
    v_fma_f32 v114, v114, s42, -v245
    v_fma_f32 v115, v115, s42, -v245
    v_fma_f32 v116, v116, s42, -v245
    v_fma_f32 v117, v117, s42, -v245
    v_fma_f32 v118, v118, s42, -v245
    v_fma_f32 v119, v119, s42, -v245
    v_exp_f32 v112, v112
    v_exp_f32 v113, v113
    v_exp_f32 v114, v114
    v_exp_f32 v115, v115
    v_exp_f32 v116, v116
    v_exp_f32 v117, v117
    v_exp_f32 v118, v118
    v_exp_f32 v119, v119
    v_add_f32 v247, v247, v112
    v_add_f32 v248, v248, v113
    v_add_f32 v249, v249, v114
    v_add_f32 v250, v250, v115
    v_add_f32 v247, v247, v116
    v_add_f32 v248, v248, v117
    v_add_f32 v249, v249, v118
    v_add_f32 v250, v250, v119
    v_cvt_pk_bf16_f32 v184, v112, v113
    v_cvt_pk_bf16_f32 v185, v114, v115
    v_cvt_pk_bf16_f32 v186, v116, v117
    v_cvt_pk_bf16_f32 v187, v118, v119
    v_fma_f32 v120, v120, s42, -v245
    v_fma_f32 v121, v121, s42, -v245
    v_fma_f32 v122, v122, s42, -v245
    v_fma_f32 v123, v123, s42, -v245
    v_fma_f32 v124, v124, s42, -v245
    v_fma_f32 v125, v125, s42, -v245
    v_fma_f32 v126, v126, s42, -v245
    v_fma_f32 v127, v127, s42, -v245
    v_exp_f32 v120, v120
    v_exp_f32 v121, v121
    v_exp_f32 v122, v122
    v_exp_f32 v123, v123
    v_exp_f32 v124, v124
    v_exp_f32 v125, v125
    v_exp_f32 v126, v126
    v_exp_f32 v127, v127
    v_add_f32 v247, v247, v120
    v_add_f32 v248, v248, v121
    v_add_f32 v249, v249, v122
    v_add_f32 v250, v250, v123
    v_add_f32 v247, v247, v124
    v_add_f32 v248, v248, v125
    v_add_f32 v249, v249, v126
    v_add_f32 v250, v250, v127
    v_cvt_pk_bf16_f32 v188, v120, v121
    v_cvt_pk_bf16_f32 v189, v122, v123
    v_cvt_pk_bf16_f32 v190, v124, v125
    v_cvt_pk_bf16_f32 v191, v126, v127
    v_add_f32 v247, v247, v248
    v_add_f32 v249, v249, v250
    v_add_f32 v247, v247, v249
    v_add_f32 v244, v244, v247
    s_nop 1
    s_waitcnt lgkmcnt(8)
    v_mfma_f32_32x32x16_bf16 v[0:15], v[208:211], v[160:163], v[0:15]
    ds_read_b64_tr_b16 v[204:205], v234 offset:4096
    ds_read_b64_tr_b16 v[206:207], v234 offset:6144
    v_mfma_f32_32x32x16_bf16 v[16:31], v[212:215], v[160:163], v[16:31]
    ds_read_b64_tr_b16 v[208:209], v235 offset:4096
    ds_read_b64_tr_b16 v[210:211], v235 offset:6144
    s_waitcnt lgkmcnt(8)
    v_mfma_f32_32x32x16_bf16 v[32:47], v[216:219], v[160:163], v[32:47]
    ds_read_b64_tr_b16 v[212:213], v232 offset:8192
    ds_read_b64_tr_b16 v[214:215], v232 offset:10240
    v_mfma_f32_32x32x16_bf16 v[48:63], v[192:195], v[160:163], v[48:63]
    ds_read_b64_tr_b16 v[216:217], v233 offset:8192
    ds_read_b64_tr_b16 v[218:219], v233 offset:10240
    s_waitcnt lgkmcnt(8)
    v_mfma_f32_32x32x16_bf16 v[0:15], v[196:199], v[164:167], v[0:15]
    ds_read_b64_tr_b16 v[192:193], v234 offset:8192
    ds_read_b64_tr_b16 v[194:195], v234 offset:10240
    v_mfma_f32_32x32x16_bf16 v[16:31], v[200:203], v[164:167], v[16:31]
    ds_read_b64_tr_b16 v[196:197], v235 offset:8192
    ds_read_b64_tr_b16 v[198:199], v235 offset:10240
    s_waitcnt lgkmcnt(8)
    v_mfma_f32_32x32x16_bf16 v[32:47], v[204:207], v[164:167], v[32:47]
    ds_read_b64_tr_b16 v[200:201], v232 offset:12288
    ds_read_b64_tr_b16 v[202:203], v232 offset:14336
    v_mfma_f32_32x32x16_bf16 v[48:63], v[208:211], v[164:167], v[48:63]
    ds_read_b64_tr_b16 v[204:205], v233 offset:12288
    ds_read_b64_tr_b16 v[206:207], v233 offset:14336
    s_waitcnt lgkmcnt(8)
    v_mfma_f32_32x32x16_bf16 v[0:15], v[212:215], v[168:171], v[0:15]
    ds_read_b64_tr_b16 v[208:209], v234 offset:12288
    ds_read_b64_tr_b16 v[210:211], v234 offset:14336
    v_mfma_f32_32x32x16_bf16 v[16:31], v[216:219], v[168:171], v[16:31]
    ds_read_b64_tr_b16 v[212:213], v235 offset:12288
    ds_read_b64_tr_b16 v[214:215], v235 offset:14336
    s_waitcnt lgkmcnt(8)
    v_mfma_f32_32x32x16_bf16 v[32:47], v[192:195], v[168:171], v[32:47]
    s_waitcnt vmcnt(0)
    s_barrier
    v_add_u32 v232, 0xffff0000, v232
    v_add_u32 v233, 0xffff0000, v233
    v_add_u32 v234, 0xffff0000, v234
    v_add_u32 v235, 0xffff0000, v235
    ds_read_b64_tr_b16 v[216:217], v232 offset:16384
    ds_read_b64_tr_b16 v[218:219], v232 offset:18432
    v_mfma_f32_32x32x16_bf16 v[48:63], v[196:199], v[168:171], v[48:63]
    ds_read_b64_tr_b16 v[192:193], v233 offset:16384
    ds_read_b64_tr_b16 v[194:195], v233 offset:18432
    s_waitcnt lgkmcnt(8)
    v_mfma_f32_32x32x16_bf16 v[0:15], v[200:203], v[172:175], v[0:15]
    ds_read_b64_tr_b16 v[196:197], v234 offset:16384
    ds_read_b64_tr_b16 v[198:199], v234 offset:18432
    v_mfma_f32_32x32x16_bf16 v[16:31], v[204:207], v[172:175], v[16:31]
    ds_read_b64_tr_b16 v[200:201], v235 offset:16384
    ds_read_b64_tr_b16 v[202:203], v235 offset:18432
    s_waitcnt lgkmcnt(8)
    v_mfma_f32_32x32x16_bf16 v[32:47], v[208:211], v[172:175], v[32:47]
    ds_read_b64_tr_b16 v[204:205], v232 offset:20480
    ds_read_b64_tr_b16 v[206:207], v232 offset:22528
    v_mfma_f32_32x32x16_bf16 v[48:63], v[212:215], v[172:175], v[48:63]
    ds_read_b64_tr_b16 v[208:209], v233 offset:20480
    ds_read_b64_tr_b16 v[210:211], v233 offset:22528
    s_nop 1
    s_waitcnt lgkmcnt(8)
    v_mfma_f32_32x32x16_bf16 v[0:15], v[216:219], v[176:179], v[0:15]
    ds_read_b64_tr_b16 v[212:213], v234 offset:20480
    ds_read_b64_tr_b16 v[214:215], v234 offset:22528
    v_mfma_f32_32x32x16_bf16 v[16:31], v[192:195], v[176:179], v[16:31]
    ds_read_b64_tr_b16 v[216:217], v235 offset:20480
    ds_read_b64_tr_b16 v[218:219], v235 offset:22528
    s_waitcnt lgkmcnt(8)
    v_mfma_f32_32x32x16_bf16 v[32:47], v[196:199], v[176:179], v[32:47]
    ds_read_b64_tr_b16 v[192:193], v232 offset:24576
    ds_read_b64_tr_b16 v[194:195], v232 offset:26624
    v_mfma_f32_32x32x16_bf16 v[48:63], v[200:203], v[176:179], v[48:63]
    ds_read_b64_tr_b16 v[196:197], v233 offset:24576
    ds_read_b64_tr_b16 v[198:199], v233 offset:26624
    s_waitcnt lgkmcnt(8)
    v_mfma_f32_32x32x16_bf16 v[0:15], v[204:207], v[180:183], v[0:15]
    ds_read_b64_tr_b16 v[200:201], v234 offset:24576
    ds_read_b64_tr_b16 v[202:203], v234 offset:26624
    v_mfma_f32_32x32x16_bf16 v[16:31], v[208:211], v[180:183], v[16:31]
    ds_read_b64_tr_b16 v[204:205], v235 offset:24576
    ds_read_b64_tr_b16 v[206:207], v235 offset:26624
    s_waitcnt lgkmcnt(8)
    v_mfma_f32_32x32x16_bf16 v[32:47], v[212:215], v[180:183], v[32:47]
    ds_read_b64_tr_b16 v[208:209], v232 offset:28672
    ds_read_b64_tr_b16 v[210:211], v232 offset:30720
    v_mfma_f32_32x32x16_bf16 v[48:63], v[216:219], v[180:183], v[48:63]
    ds_read_b64_tr_b16 v[212:213], v233 offset:28672
    ds_read_b64_tr_b16 v[214:215], v233 offset:30720
    s_waitcnt lgkmcnt(8)
    v_mfma_f32_32x32x16_bf16 v[0:15], v[192:195], v[184:187], v[0:15]
    ds_read_b64_tr_b16 v[216:217], v234 offset:28672
    ds_read_b64_tr_b16 v[218:219], v234 offset:30720
    v_mfma_f32_32x32x16_bf16 v[16:31], v[196:199], v[184:187], v[16:31]
    ds_read_b64_tr_b16 v[192:193], v235 offset:28672
    ds_read_b64_tr_b16 v[194:195], v235 offset:30720
    s_waitcnt lgkmcnt(8)
    v_mfma_f32_32x32x16_bf16 v[32:47], v[200:203], v[184:187], v[32:47]
    v_mfma_f32_32x32x16_bf16 v[48:63], v[204:207], v[184:187], v[48:63]
    s_waitcnt lgkmcnt(4)
    v_mfma_f32_32x32x16_bf16 v[0:15], v[208:211], v[188:191], v[0:15]
    v_mfma_f32_32x32x16_bf16 v[16:31], v[212:215], v[188:191], v[16:31]
    s_waitcnt lgkmcnt(0)
    v_mfma_f32_32x32x16_bf16 v[32:47], v[216:219], v[188:191], v[32:47]
    v_mfma_f32_32x32x16_bf16 v[48:63], v[192:195], v[188:191], v[48:63]
    v_mov_b32 v246, v244
    s_nop 1
    v_permlane32_swap_b32 v244, v246
    s_nop 1
    v_add_f32 v244, v244, v246
    v_rcp_f32 v244, v244
    s_nop 7
    s_nop 3
    v_mul_f32 v0, v0, v244
    v_mul_f32 v1, v1, v244
    v_mul_f32 v2, v2, v244
    v_mul_f32 v3, v3, v244
    v_mul_f32 v4, v4, v244
    v_mul_f32 v5, v5, v244
    v_mul_f32 v6, v6, v244
    v_mul_f32 v7, v7, v244
    v_mul_f32 v8, v8, v244
    v_mul_f32 v9, v9, v244
    v_mul_f32 v10, v10, v244
    v_mul_f32 v11, v11, v244
    v_mul_f32 v12, v12, v244
    v_mul_f32 v13, v13, v244
    v_mul_f32 v14, v14, v244
    v_mul_f32 v15, v15, v244
    v_mul_f32 v16, v16, v244
    v_mul_f32 v17, v17, v244
    v_mul_f32 v18, v18, v244
    v_mul_f32 v19, v19, v244
    v_mul_f32 v20, v20, v244
    v_mul_f32 v21, v21, v244
    v_mul_f32 v22, v22, v244
    v_mul_f32 v23, v23, v244
    v_mul_f32 v24, v24, v244
    v_mul_f32 v25, v25, v244
    v_mul_f32 v26, v26, v244
    v_mul_f32 v27, v27, v244
    v_mul_f32 v28, v28, v244
    v_mul_f32 v29, v29, v244
    v_mul_f32 v30, v30, v244
    v_mul_f32 v31, v31, v244
    v_mul_f32 v32, v32, v244
    v_mul_f32 v33, v33, v244
    v_mul_f32 v34, v34, v244
    v_mul_f32 v35, v35, v244
    v_mul_f32 v36, v36, v244
    v_mul_f32 v37, v37, v244
    v_mul_f32 v38, v38, v244
    v_mul_f32 v39, v39, v244
    v_mul_f32 v40, v40, v244
    v_mul_f32 v41, v41, v244
    v_mul_f32 v42, v42, v244
    v_mul_f32 v43, v43, v244
    v_mul_f32 v44, v44, v244
    v_mul_f32 v45, v45, v244
    v_mul_f32 v46, v46, v244
    v_mul_f32 v47, v47, v244
    v_mul_f32 v48, v48, v244
    v_mul_f32 v49, v49, v244
    v_mul_f32 v50, v50, v244
    v_mul_f32 v51, v51, v244
    v_mul_f32 v52, v52, v244
    v_mul_f32 v53, v53, v244
    v_mul_f32 v54, v54, v244
    v_mul_f32 v55, v55, v244
    v_mul_f32 v56, v56, v244
    v_mul_f32 v57, v57, v244
    v_mul_f32 v58, v58, v244
    v_mul_f32 v59, v59, v244
    v_mul_f32 v60, v60, v244
    v_mul_f32 v61, v61, v244
    v_mul_f32 v62, v62, v244
    v_mul_f32 v63, v63, v244
    v_cvt_pk_bf16_f32 v64, v0, v1
    v_cvt_pk_bf16_f32 v65, v2, v3
    v_cvt_pk_bf16_f32 v66, v4, v5
    v_cvt_pk_bf16_f32 v67, v6, v7
    v_cvt_pk_bf16_f32 v68, v8, v9
    v_cvt_pk_bf16_f32 v69, v10, v11
    v_cvt_pk_bf16_f32 v70, v12, v13
    v_cvt_pk_bf16_f32 v71, v14, v15
    v_cvt_pk_bf16_f32 v72, v16, v17
    v_cvt_pk_bf16_f32 v73, v18, v19
    v_cvt_pk_bf16_f32 v74, v20, v21
    v_cvt_pk_bf16_f32 v75, v22, v23
    v_cvt_pk_bf16_f32 v76, v24, v25
    v_cvt_pk_bf16_f32 v77, v26, v27
    v_cvt_pk_bf16_f32 v78, v28, v29
    v_cvt_pk_bf16_f32 v79, v30, v31
    v_cvt_pk_bf16_f32 v80, v32, v33
    v_cvt_pk_bf16_f32 v81, v34, v35
    v_cvt_pk_bf16_f32 v82, v36, v37
    v_cvt_pk_bf16_f32 v83, v38, v39
    v_cvt_pk_bf16_f32 v84, v40, v41
    v_cvt_pk_bf16_f32 v85, v42, v43
    v_cvt_pk_bf16_f32 v86, v44, v45
    v_cvt_pk_bf16_f32 v87, v46, v47
    v_cvt_pk_bf16_f32 v88, v48, v49
    v_cvt_pk_bf16_f32 v89, v50, v51
    v_cvt_pk_bf16_f32 v90, v52, v53
    v_cvt_pk_bf16_f32 v91, v54, v55
    v_cvt_pk_bf16_f32 v92, v56, v57
    v_cvt_pk_bf16_f32 v93, v58, v59
    v_cvt_pk_bf16_f32 v94, v60, v61
    v_cvt_pk_bf16_f32 v95, v62, v63
    s_mov_b32 s82, -1
    s_mov_b32 s83, -1
    s_cmp_eq_u32 s24, 3
    s_cselect_b32 s82, 0xffff, s82
    s_cselect_b32 s83, 0xffff, s83
    s_mov_b64 exec, s[82:83]
    buffer_store_dwordx4 v[64:67], v242, s[20:23], s28 offen offset:0 sc0 sc1
    buffer_store_dwordx4 v[68:71], v242, s[20:23], s28 offen offset:1024 sc0 sc1
    buffer_store_dwordx4 v[72:75], v242, s[20:23], s28 offen offset:2048 sc0 sc1
    buffer_store_dwordx4 v[76:79], v242, s[20:23], s28 offen offset:3072 sc0 sc1
    s_add_u32 s28, s28, 4096
    buffer_store_dwordx4 v[80:83], v242, s[20:23], s28 offen offset:0 sc0 sc1
    buffer_store_dwordx4 v[84:87], v242, s[20:23], s28 offen offset:1024 sc0 sc1
    buffer_store_dwordx4 v[88:91], v242, s[20:23], s28 offen offset:2048 sc0 sc1
    buffer_store_dwordx4 v[92:95], v242, s[20:23], s28 offen offset:3072 sc0 sc1
    s_mov_b64 exec, -1
    s_cmp_lt_u32 s34, 4
    s_cbranch_scc1 L_attn_done
    s_and_b32 s34, s34, 3
    s_lshl_b32 s31, s33, 2
    s_add_u32 s31, s31, s34
    s_lshl_b32 s31, s31, 2
    s_add_u32 s31, s31, s24
    v_lshlrev_b32 v245, 3, v242
    s_lshl_b32 s31, s31, 14
    buffer_load_dword v246, v245, s[76:79], s31 offen
    s_add_u32 s31, s31, 8192
    buffer_load_dword v247, v245, s[76:79], s31 offen
L_attn_done:
    s_endpgm
.globl oproj_kernel
.p2align 8
.type oproj_kernel,@function
oproj_kernel:
    s_cmp_ge_u32 s2, 256
    s_cbranch_scc1 L_oproj_done
    s_load_dwordx2 s[44:45], s[0:1], 32
    s_load_dwordx2 s[46:47], s[0:1], 72
    s_load_dwordx2 s[48:49], s[0:1], 80
    s_load_dwordx2 s[50:51], s[0:1], 96
    v_lshrrev_b32 v73, 6, v0
    v_and_b32 v74, 63, v0
    s_nop 0
    v_readfirstlane_b32 s24, v73
    s_and_b32 s30, s2, 7
    s_lshr_b32 s31, s2, 3
    s_lshr_b32 s32, s30, 2
    s_bfe_u32 s33, s30, 0x10001
    s_lshl_b32 s33, s33, 2
    s_lshr_b32 s34, s31, 3
    s_add_u32 s33, s33, s34
    s_and_b32 s34, s30, 1
    s_lshl_b32 s34, s34, 3
    s_and_b32 s35, s31, 7
    s_add_u32 s34, s34, s35
    s_lshl_b32 s25, s32, 3
    s_add_u32 s25, s25, s33
    s_lshl_b32 s25, s25, 2
    s_add_u32 s25, s25, s24
    s_lshl_b32 s25, s25, 18
    s_lshl_b32 s26, s34, 7
    s_mul_i32 s28, s33, 458752
    s_lshl_b32 s35, s32, 11
    s_add_u32 s28, s28, s35
    s_add_u32 s28, s28, s26
    s_lshl_b32 s29, s24, 12
    s_add_u32 s54, s33, s34
    s_and_b32 s54, s54, 7
    s_mov_b32 s54, 0
    s_mov_b32 s38, -1
    s_mov_b32 s39, -1
    s_cmp_eq_u32 s24, 3
    s_cselect_b32 s38, 0xffff, s38
    s_cselect_b32 s39, 0xffff, s39
    s_waitcnt lgkmcnt(0)
    s_cmp_eq_u32 s32, 0
    s_cselect_b32 s8, s44, s46
    s_cselect_b32 s9, s45, s47
    s_mov_b32 s10, 0x800000
    s_mov_b32 s11, 0x00020000
    s_mov_b32 s4, s50
    s_mov_b32 s5, s51
    s_mov_b32 s6, 0x1000000
    s_mov_b32 s7, 0x00020000
    s_mov_b32 s20, s48
    s_mov_b32 s21, s49
    s_mov_b32 s22, 3670016
    s_mov_b32 s23, 0x00020000
    v_lshrrev_b32 v75, 3, v74
    v_and_b32 v76, 7, v74
    v_bfe_u32 v77, v74, 4, 1
    v_lshlrev_b32 v77, 2, v77
    v_xor_b32 v76, v76, v77
    s_lshl_b32 s30, s24, 16
    v_lshlrev_b32 v75, 11, v75
    v_add_u32 v75, s30, v75
    v_lshl_add_u32 v75, v76, 4, v75
    v_add_u32 v68, 0, v75
    v_add_u32 v69, 15360, v75
    v_add_u32 v70, 30720, v75
    v_add_u32 v71, 46080, v75
    v_lshrrev_b32 v75, 5, v74
    v_bfe_u32 v76, v74, 2, 2
    v_bfe_u32 v77, v74, 4, 1
    v_and_b32 v78, 1, v74
    v_lshl_add_u32 v77, v77, 1, v78
    v_bfe_u32 v78, v74, 3, 1
    v_lshl_add_u32 v77, v78, 2, v77
    v_lshlrev_b32 v77, 4, v77
    v_bfe_u32 v78, v74, 1, 1
    v_lshl_add_u32 v77, v78, 3, v77
    v_lshl_add_u32 v77, v76, 7, v77
    v_lshl_add_u32 v77, v75, 10, v77
    v_xor_b32 v64, 0, v77
    v_add_u32 v66, 0x10000, v64
    v_xor_b32 v65, 64, v77
    v_add_u32 v67, 0x10000, v65
    v_lshlrev_b32 v72, 4, v74
    v_and_b32 v76, 31, v74
    s_lshl_b32 s30, s24, 5
    v_add_u32 v76, s30, v76
    v_lshlrev_b32 v75, 4, v75
    v_lshl_add_u32 v78, v76, 12, v75
    v_cmp_gt_u32 vcc, 112, v76
    s_nop 1
    s_mov_b64 s[40:41], vcc
    s_add_u32 s30, s29, 0
    s_mov_b32 m0, s30
    s_add_u32 s31, s54, 0
    s_and_b32 s31, s31, 31
    s_lshl_b32 s31, s31, 18
    s_add_u32 s31, s31, s26
    buffer_load_dwordx4 v68, s[8:11], s31 offen offset:0 lds
    buffer_load_dwordx4 v69, s[8:11], s31 offen offset:1024 lds
    buffer_load_dwordx4 v70, s[8:11], s31 offen offset:2048 lds
    buffer_load_dwordx4 v71, s[8:11], s31 offen offset:3072 lds
    s_mov_b64 exec, s[38:39]
    s_add_u32 s31, s54, 0
    s_and_b32 s31, s31, 31
    s_lshl_b32 s31, s31, 13
    s_add_u32 s31, s31, s25
    s_add_u32 s31, s31, 0
    buffer_load_dwordx4 v[80:83], v72, s[4:7], s31 offen offset:0
    buffer_load_dwordx4 v[84:87], v72, s[4:7], s31 offen offset:1024
    buffer_load_dwordx4 v[88:91], v72, s[4:7], s31 offen offset:2048
    buffer_load_dwordx4 v[92:95], v72, s[4:7], s31 offen offset:3072
    s_add_u32 s31, s54, 0
    s_and_b32 s31, s31, 31
    s_lshl_b32 s31, s31, 13
    s_add_u32 s31, s31, s25
    s_add_u32 s31, s31, 4096
    buffer_load_dwordx4 v[96:99], v72, s[4:7], s31 offen offset:0
    buffer_load_dwordx4 v[100:103], v72, s[4:7], s31 offen offset:1024
    buffer_load_dwordx4 v[104:107], v72, s[4:7], s31 offen offset:2048
    buffer_load_dwordx4 v[108:111], v72, s[4:7], s31 offen offset:3072
    s_mov_b64 exec, -1
    s_add_u32 s30, s29, 16384
    s_mov_b32 m0, s30
    s_add_u32 s31, s54, 1
    s_and_b32 s31, s31, 31
    s_lshl_b32 s31, s31, 18
    s_add_u32 s31, s31, s26
    buffer_load_dwordx4 v68, s[8:11], s31 offen offset:0 lds
    buffer_load_dwordx4 v69, s[8:11], s31 offen offset:1024 lds
    buffer_load_dwordx4 v70, s[8:11], s31 offen offset:2048 lds
    buffer_load_dwordx4 v71, s[8:11], s31 offen offset:3072 lds
    s_mov_b64 exec, s[38:39]
    s_add_u32 s31, s54, 1
    s_and_b32 s31, s31, 31
    s_lshl_b32 s31, s31, 13
    s_add_u32 s31, s31, s25
    s_add_u32 s31, s31, 0
    buffer_load_dwordx4 v[112:115], v72, s[4:7], s31 offen offset:0
    buffer_load_dwordx4 v[116:119], v72, s[4:7], s31 offen offset:1024
    buffer_load_dwordx4 v[120:123], v72, s[4:7], s31 offen offset:2048
    buffer_load_dwordx4 v[124:127], v72, s[4:7], s31 offen offset:3072
    s_add_u32 s31, s54, 1
    s_and_b32 s31, s31, 31
    s_lshl_b32 s31, s31, 13
    s_add_u32 s31, s31, s25
    s_add_u32 s31, s31, 4096
    buffer_load_dwordx4 v[128:131], v72, s[4:7], s31 offen offset:0
    buffer_load_dwordx4 v[132:135], v72, s[4:7], s31 offen offset:1024
    buffer_load_dwordx4 v[136:139], v72, s[4:7], s31 offen offset:2048
    buffer_load_dwordx4 v[140:143], v72, s[4:7], s31 offen offset:3072
    s_mov_b64 exec, -1
    s_add_u32 s30, s29, 32768
    s_mov_b32 m0, s30
    s_add_u32 s31, s54, 2
    s_and_b32 s31, s31, 31
    s_lshl_b32 s31, s31, 18
    s_add_u32 s31, s31, s26
    buffer_load_dwordx4 v68, s[8:11], s31 offen offset:0 lds
    buffer_load_dwordx4 v69, s[8:11], s31 offen offset:1024 lds
    buffer_load_dwordx4 v70, s[8:11], s31 offen offset:2048 lds
    buffer_load_dwordx4 v71, s[8:11], s31 offen offset:3072 lds
    s_add_u32 s30, s29, 49152
    s_mov_b32 m0, s30
    s_add_u32 s31, s54, 3
    s_and_b32 s31, s31, 31
    s_lshl_b32 s31, s31, 18
    s_add_u32 s31, s31, s26
    buffer_load_dwordx4 v68, s[8:11], s31 offen offset:0 lds
    buffer_load_dwordx4 v69, s[8:11], s31 offen offset:1024 lds
    buffer_load_dwordx4 v70, s[8:11], s31 offen offset:2048 lds
    buffer_load_dwordx4 v71, s[8:11], s31 offen offset:3072 lds
    s_add_u32 s30, s29, 65536
    s_mov_b32 m0, s30
    s_add_u32 s31, s54, 4
    s_and_b32 s31, s31, 31
    s_lshl_b32 s31, s31, 18
    s_add_u32 s31, s31, s26
    buffer_load_dwordx4 v68, s[8:11], s31 offen offset:0 lds
    buffer_load_dwordx4 v69, s[8:11], s31 offen offset:1024 lds
    buffer_load_dwordx4 v70, s[8:11], s31 offen offset:2048 lds
    buffer_load_dwordx4 v71, s[8:11], s31 offen offset:3072 lds
    s_add_u32 s30, s29, 81920
    s_mov_b32 m0, s30
    s_add_u32 s31, s54, 5
    s_and_b32 s31, s31, 31
    s_lshl_b32 s31, s31, 18
    s_add_u32 s31, s31, s26
    buffer_load_dwordx4 v68, s[8:11], s31 offen offset:0 lds
    buffer_load_dwordx4 v69, s[8:11], s31 offen offset:1024 lds
    buffer_load_dwordx4 v70, s[8:11], s31 offen offset:2048 lds
    buffer_load_dwordx4 v71, s[8:11], s31 offen offset:3072 lds
    s_add_u32 s30, s29, 98304
    s_mov_b32 m0, s30
    s_add_u32 s31, s54, 6
    s_and_b32 s31, s31, 31
    s_lshl_b32 s31, s31, 18
    s_add_u32 s31, s31, s26
    buffer_load_dwordx4 v68, s[8:11], s31 offen offset:0 lds
    buffer_load_dwordx4 v69, s[8:11], s31 offen offset:1024 lds
    buffer_load_dwordx4 v70, s[8:11], s31 offen offset:2048 lds
    buffer_load_dwordx4 v71, s[8:11], s31 offen offset:3072 lds
    s_waitcnt vmcnt(40)
    s_barrier
    ds_read_b64_tr_b16 v[32:33], v64 offset:0
    ds_read_b64_tr_b16 v[34:35], v64 offset:512
    ds_read_b64_tr_b16 v[36:37], v65 offset:0
    ds_read_b64_tr_b16 v[38:39], v65 offset:512
    ds_read_b64_tr_b16 v[40:41], v64 offset:2048
    ds_read_b64_tr_b16 v[42:43], v64 offset:2560
    ds_read_b64_tr_b16 v[44:45], v65 offset:2048
    ds_read_b64_tr_b16 v[46:47], v65 offset:2560
    ds_read_b64_tr_b16 v[48:49], v64 offset:4096
    ds_read_b64_tr_b16 v[50:51], v64 offset:4608
    ds_read_b64_tr_b16 v[52:53], v65 offset:4096
    ds_read_b64_tr_b16 v[54:55], v65 offset:4608
    s_waitcnt vmcnt(32)
    s_waitcnt lgkmcnt(8)
    v_mfma_f32_32x32x16_bf16 v[0:15], v[32:35], v[80:83], 0
    s_add_u32 s37, s54, 2
    s_and_b32 s37, s37, 31
    s_lshl_b32 s37, s37, 13
    s_add_u32 s37, s37, s25
    s_add_u32 s37, s37, 0
    s_mov_b64 exec, s[38:39]
    buffer_load_dwordx4 v[144:147], v72, s[4:7], s37 offen offset:0
    s_mov_b64 exec, -1
    ds_read_b64_tr_b16 v[56:57], v64 offset:6144
    ds_read_b64_tr_b16 v[58:59], v64 offset:6656
    v_mfma_f32_32x32x16_bf16 v[16:31], v[36:39], v[80:83], 0
    s_mov_b64 exec, s[38:39]
    buffer_load_dwordx4 v[148:151], v72, s[4:7], s37 offen offset:1024
    s_mov_b64 exec, -1
    ds_read_b64_tr_b16 v[60:61], v65 offset:6144
    ds_read_b64_tr_b16 v[62:63], v65 offset:6656
    s_waitcnt lgkmcnt(8)
    v_mfma_f32_32x32x16_bf16 v[0:15], v[40:43], v[84:87], v[0:15]
    s_mov_b64 exec, s[38:39]
    buffer_load_dwordx4 v[152:155], v72, s[4:7], s37 offen offset:2048
    s_mov_b64 exec, -1
    ds_read_b64_tr_b16 v[32:33], v64 offset:8192
    ds_read_b64_tr_b16 v[34:35], v64 offset:8704
    v_mfma_f32_32x32x16_bf16 v[16:31], v[44:47], v[84:87], v[16:31]
    s_mov_b64 exec, s[38:39]
    buffer_load_dwordx4 v[156:159], v72, s[4:7], s37 offen offset:3072
    s_mov_b64 exec, -1
    ds_read_b64_tr_b16 v[36:37], v65 offset:8192
    ds_read_b64_tr_b16 v[38:39], v65 offset:8704
    s_waitcnt lgkmcnt(8)
    v_mfma_f32_32x32x16_bf16 v[0:15], v[48:51], v[88:91], v[0:15]
    s_add_u32 s37, s54, 2
    s_and_b32 s37, s37, 31
    s_lshl_b32 s37, s37, 13
    s_add_u32 s37, s37, s25
    s_add_u32 s37, s37, 4096
    s_mov_b64 exec, s[38:39]
    buffer_load_dwordx4 v[160:163], v72, s[4:7], s37 offen offset:0
    s_mov_b64 exec, -1
    ds_read_b64_tr_b16 v[40:41], v64 offset:10240
    ds_read_b64_tr_b16 v[42:43], v64 offset:10752
    v_mfma_f32_32x32x16_bf16 v[16:31], v[52:55], v[88:91], v[16:31]
    s_mov_b64 exec, s[38:39]
    buffer_load_dwordx4 v[164:167], v72, s[4:7], s37 offen offset:1024
    s_mov_b64 exec, -1
    ds_read_b64_tr_b16 v[44:45], v65 offset:10240
    ds_read_b64_tr_b16 v[46:47], v65 offset:10752
    s_waitcnt lgkmcnt(8)
    v_mfma_f32_32x32x16_bf16 v[0:15], v[56:59], v[92:95], v[0:15]
    s_mov_b64 exec, s[38:39]
    buffer_load_dwordx4 v[168:171], v72, s[4:7], s37 offen offset:2048
    s_mov_b64 exec, -1
    ds_read_b64_tr_b16 v[48:49], v64 offset:12288
    ds_read_b64_tr_b16 v[50:51], v64 offset:12800
    v_mfma_f32_32x32x16_bf16 v[16:31], v[60:63], v[92:95], v[16:31]
    s_mov_b64 exec, s[38:39]
    buffer_load_dwordx4 v[172:175], v72, s[4:7], s37 offen offset:3072
    s_mov_b64 exec, -1
    ds_read_b64_tr_b16 v[52:53], v65 offset:12288
    ds_read_b64_tr_b16 v[54:55], v65 offset:12800
    s_waitcnt lgkmcnt(8)
    v_mfma_f32_32x32x16_bf16 v[0:15], v[32:35], v[96:99], v[0:15]
    ds_read_b64_tr_b16 v[56:57], v64 offset:14336
    ds_read_b64_tr_b16 v[58:59], v64 offset:14848
    v_mfma_f32_32x32x16_bf16 v[16:31], v[36:39], v[96:99], v[16:31]
    ds_read_b64_tr_b16 v[60:61], v65 offset:14336
    ds_read_b64_tr_b16 v[62:63], v65 offset:14848
    s_waitcnt lgkmcnt(8)
    v_mfma_f32_32x32x16_bf16 v[0:15], v[40:43], v[100:103], v[0:15]
    s_waitcnt vmcnt(36)
    s_barrier
    ds_read_b64_tr_b16 v[32:33], v64 offset:16384
    ds_read_b64_tr_b16 v[34:35], v64 offset:16896
    v_mfma_f32_32x32x16_bf16 v[16:31], v[44:47], v[100:103], v[16:31]
    ds_read_b64_tr_b16 v[36:37], v65 offset:16384
    ds_read_b64_tr_b16 v[38:39], v65 offset:16896
    s_waitcnt lgkmcnt(8)
    v_mfma_f32_32x32x16_bf16 v[0:15], v[48:51], v[104:107], v[0:15]
    ds_read_b64_tr_b16 v[40:41], v64 offset:18432
    ds_read_b64_tr_b16 v[42:43], v64 offset:18944
    v_mfma_f32_32x32x16_bf16 v[16:31], v[52:55], v[104:107], v[16:31]
    ds_read_b64_tr_b16 v[44:45], v65 offset:18432
    ds_read_b64_tr_b16 v[46:47], v65 offset:18944
    s_waitcnt lgkmcnt(8)
    v_mfma_f32_32x32x16_bf16 v[0:15], v[56:59], v[108:111], v[0:15]
    ds_read_b64_tr_b16 v[48:49], v64 offset:20480
    ds_read_b64_tr_b16 v[50:51], v64 offset:20992
    v_mfma_f32_32x32x16_bf16 v[16:31], v[60:63], v[108:111], v[16:31]
    ds_read_b64_tr_b16 v[52:53], v65 offset:20480
    ds_read_b64_tr_b16 v[54:55], v65 offset:20992
    s_waitcnt vmcnt(28)
    s_waitcnt lgkmcnt(8)
    v_mfma_f32_32x32x16_bf16 v[0:15], v[32:35], v[112:115], v[0:15]
    s_add_u32 s37, s54, 3
    s_and_b32 s37, s37, 31
    s_lshl_b32 s37, s37, 13
    s_add_u32 s37, s37, s25
    s_add_u32 s37, s37, 0
    s_mov_b64 exec, s[38:39]
    buffer_load_dwordx4 v[80:83], v72, s[4:7], s37 offen offset:0
    s_mov_b64 exec, -1
    ds_read_b64_tr_b16 v[56:57], v64 offset:22528
    ds_read_b64_tr_b16 v[58:59], v64 offset:23040
    v_mfma_f32_32x32x16_bf16 v[16:31], v[36:39], v[112:115], v[16:31]
    s_mov_b64 exec, s[38:39]
    buffer_load_dwordx4 v[84:87], v72, s[4:7], s37 offen offset:1024
    s_mov_b64 exec, -1
    ds_read_b64_tr_b16 v[60:61], v65 offset:22528
    ds_read_b64_tr_b16 v[62:63], v65 offset:23040
    s_waitcnt lgkmcnt(8)
    v_mfma_f32_32x32x16_bf16 v[0:15], v[40:43], v[116:119], v[0:15]
    s_mov_b64 exec, s[38:39]
    buffer_load_dwordx4 v[88:91], v72, s[4:7], s37 offen offset:2048
    s_mov_b64 exec, -1
    ds_read_b64_tr_b16 v[32:33], v64 offset:24576
    ds_read_b64_tr_b16 v[34:35], v64 offset:25088
    v_mfma_f32_32x32x16_bf16 v[16:31], v[44:47], v[116:119], v[16:31]
    s_mov_b64 exec, s[38:39]
    buffer_load_dwordx4 v[92:95], v72, s[4:7], s37 offen offset:3072
    s_mov_b64 exec, -1
    ds_read_b64_tr_b16 v[36:37], v65 offset:24576
    ds_read_b64_tr_b16 v[38:39], v65 offset:25088
    s_waitcnt lgkmcnt(8)
    v_mfma_f32_32x32x16_bf16 v[0:15], v[48:51], v[120:123], v[0:15]
    s_add_u32 s37, s54, 3
    s_and_b32 s37, s37, 31
    s_lshl_b32 s37, s37, 13
    s_add_u32 s37, s37, s25
    s_add_u32 s37, s37, 4096
    s_mov_b64 exec, s[38:39]
    buffer_load_dwordx4 v[96:99], v72, s[4:7], s37 offen offset:0
    s_mov_b64 exec, -1
    ds_read_b64_tr_b16 v[40:41], v64 offset:26624
    ds_read_b64_tr_b16 v[42:43], v64 offset:27136
    v_mfma_f32_32x32x16_bf16 v[16:31], v[52:55], v[120:123], v[16:31]
    s_mov_b64 exec, s[38:39]
    buffer_load_dwordx4 v[100:103], v72, s[4:7], s37 offen offset:1024
    s_mov_b64 exec, -1
    ds_read_b64_tr_b16 v[44:45], v65 offset:26624
    ds_read_b64_tr_b16 v[46:47], v65 offset:27136
    s_waitcnt lgkmcnt(8)
    v_mfma_f32_32x32x16_bf16 v[0:15], v[56:59], v[124:127], v[0:15]
    s_mov_b64 exec, s[38:39]
    buffer_load_dwordx4 v[104:107], v72, s[4:7], s37 offen offset:2048
    s_mov_b64 exec, -1
    ds_read_b64_tr_b16 v[48:49], v64 offset:28672
    ds_read_b64_tr_b16 v[50:51], v64 offset:29184
    v_mfma_f32_32x32x16_bf16 v[16:31], v[60:63], v[124:127], v[16:31]
    s_mov_b64 exec, s[38:39]
    buffer_load_dwordx4 v[108:111], v72, s[4:7], s37 offen offset:3072
    s_mov_b64 exec, -1
    ds_read_b64_tr_b16 v[52:53], v65 offset:28672
    ds_read_b64_tr_b16 v[54:55], v65 offset:29184
    s_waitcnt lgkmcnt(8)
    v_mfma_f32_32x32x16_bf16 v[0:15], v[32:35], v[128:131], v[0:15]
    ds_read_b64_tr_b16 v[56:57], v64 offset:30720
    ds_read_b64_tr_b16 v[58:59], v64 offset:31232
    v_mfma_f32_32x32x16_bf16 v[16:31], v[36:39], v[128:131], v[16:31]
    ds_read_b64_tr_b16 v[60:61], v65 offset:30720
    ds_read_b64_tr_b16 v[62:63], v65 offset:31232
    s_waitcnt lgkmcnt(8)
    v_mfma_f32_32x32x16_bf16 v[0:15], v[40:43], v[132:135], v[0:15]
    s_waitcnt vmcnt(32)
    s_barrier
    ds_read_b64_tr_b16 v[32:33], v64 offset:32768
    ds_read_b64_tr_b16 v[34:35], v64 offset:33280
    v_mfma_f32_32x32x16_bf16 v[16:31], v[44:47], v[132:135], v[16:31]
    s_add_u32 s30, s29, 0
    s_mov_b32 m0, s30
    s_add_u32 s36, s54, 7
    s_and_b32 s36, s36, 31
    s_lshl_b32 s36, s36, 18
    s_add_u32 s36, s36, s26
    buffer_load_dwordx4 v68, s[8:11], s36 offen offset:0 lds
    ds_read_b64_tr_b16 v[36:37], v65 offset:32768
    ds_read_b64_tr_b16 v[38:39], v65 offset:33280
    s_waitcnt lgkmcnt(8)
    v_mfma_f32_32x32x16_bf16 v[0:15], v[48:51], v[136:139], v[0:15]
    buffer_load_dwordx4 v69, s[8:11], s36 offen offset:1024 lds
    ds_read_b64_tr_b16 v[40:41], v64 offset:34816
    ds_read_b64_tr_b16 v[42:43], v64 offset:35328
    v_mfma_f32_32x32x16_bf16 v[16:31], v[52:55], v[136:139], v[16:31]
    buffer_load_dwordx4 v70, s[8:11], s36 offen offset:2048 lds
    ds_read_b64_tr_b16 v[44:45], v65 offset:34816
    ds_read_b64_tr_b16 v[46:47], v65 offset:35328
    s_waitcnt lgkmcnt(8)
    v_mfma_f32_32x32x16_bf16 v[0:15], v[56:59], v[140:143], v[0:15]
    buffer_load_dwordx4 v71, s[8:11], s36 offen offset:3072 lds
    ds_read_b64_tr_b16 v[48:49], v64 offset:36864
    ds_read_b64_tr_b16 v[50:51], v64 offset:37376
    v_mfma_f32_32x32x16_bf16 v[16:31], v[60:63], v[140:143], v[16:31]
    ds_read_b64_tr_b16 v[52:53], v65 offset:36864
    ds_read_b64_tr_b16 v[54:55], v65 offset:37376
    s_waitcnt vmcnt(12)
    s_waitcnt lgkmcnt(8)
    v_mfma_f32_32x32x16_bf16 v[0:15], v[32:35], v[144:147], v[0:15]
    s_add_u32 s37, s54, 4
    s_and_b32 s37, s37, 31
    s_lshl_b32 s37, s37, 13
    s_add_u32 s37, s37, s25
    s_add_u32 s37, s37, 0
    s_mov_b64 exec, s[38:39]
    buffer_load_dwordx4 v[112:115], v72, s[4:7], s37 offen offset:0
    s_mov_b64 exec, -1
    ds_read_b64_tr_b16 v[56:57], v64 offset:38912
    ds_read_b64_tr_b16 v[58:59], v64 offset:39424
    v_mfma_f32_32x32x16_bf16 v[16:31], v[36:39], v[144:147], v[16:31]
    s_mov_b64 exec, s[38:39]
    buffer_load_dwordx4 v[116:119], v72, s[4:7], s37 offen offset:1024
    s_mov_b64 exec, -1
    ds_read_b64_tr_b16 v[60:61], v65 offset:38912
    ds_read_b64_tr_b16 v[62:63], v65 offset:39424
    s_waitcnt lgkmcnt(8)
    v_mfma_f32_32x32x16_bf16 v[0:15], v[40:43], v[148:151], v[0:15]
    s_mov_b64 exec, s[38:39]
    buffer_load_dwordx4 v[120:123], v72, s[4:7], s37 offen offset:2048
    s_mov_b64 exec, -1
    ds_read_b64_tr_b16 v[32:33], v64 offset:40960
    ds_read_b64_tr_b16 v[34:35], v64 offset:41472
    v_mfma_f32_32x32x16_bf16 v[16:31], v[44:47], v[148:151], v[16:31]
    s_mov_b64 exec, s[38:39]
    buffer_load_dwordx4 v[124:127], v72, s[4:7], s37 offen offset:3072
    s_mov_b64 exec, -1
    ds_read_b64_tr_b16 v[36:37], v65 offset:40960
    ds_read_b64_tr_b16 v[38:39], v65 offset:41472
    s_waitcnt lgkmcnt(8)
    v_mfma_f32_32x32x16_bf16 v[0:15], v[48:51], v[152:155], v[0:15]
    s_add_u32 s37, s54, 4
    s_and_b32 s37, s37, 31
    s_lshl_b32 s37, s37, 13
    s_add_u32 s37, s37, s25
    s_add_u32 s37, s37, 4096
    s_mov_b64 exec, s[38:39]
    buffer_load_dwordx4 v[128:131], v72, s[4:7], s37 offen offset:0
    s_mov_b64 exec, -1
    ds_read_b64_tr_b16 v[40:41], v64 offset:43008
    ds_read_b64_tr_b16 v[42:43], v64 offset:43520
    v_mfma_f32_32x32x16_bf16 v[16:31], v[52:55], v[152:155], v[16:31]
    s_mov_b64 exec, s[38:39]
    buffer_load_dwordx4 v[132:135], v72, s[4:7], s37 offen offset:1024
    s_mov_b64 exec, -1
    ds_read_b64_tr_b16 v[44:45], v65 offset:43008
    ds_read_b64_tr_b16 v[46:47], v65 offset:43520
    s_waitcnt lgkmcnt(8)
    v_mfma_f32_32x32x16_bf16 v[0:15], v[56:59], v[156:159], v[0:15]
    s_mov_b64 exec, s[38:39]
    buffer_load_dwordx4 v[136:139], v72, s[4:7], s37 offen offset:2048
    s_mov_b64 exec, -1
    ds_read_b64_tr_b16 v[48:49], v64 offset:45056
    ds_read_b64_tr_b16 v[50:51], v64 offset:45568
    v_mfma_f32_32x32x16_bf16 v[16:31], v[60:63], v[156:159], v[16:31]
    s_mov_b64 exec, s[38:39]
    buffer_load_dwordx4 v[140:143], v72, s[4:7], s37 offen offset:3072
    s_mov_b64 exec, -1
    ds_read_b64_tr_b16 v[52:53], v65 offset:45056
    ds_read_b64_tr_b16 v[54:55], v65 offset:45568
    s_waitcnt lgkmcnt(8)
    v_mfma_f32_32x32x16_bf16 v[0:15], v[32:35], v[160:163], v[0:15]
    ds_read_b64_tr_b16 v[56:57], v64 offset:47104
    ds_read_b64_tr_b16 v[58:59], v64 offset:47616
    v_mfma_f32_32x32x16_bf16 v[16:31], v[36:39], v[160:163], v[16:31]
    ds_read_b64_tr_b16 v[60:61], v65 offset:47104
    ds_read_b64_tr_b16 v[62:63], v65 offset:47616
    s_waitcnt lgkmcnt(8)
    v_mfma_f32_32x32x16_bf16 v[0:15], v[40:43], v[164:167], v[0:15]
    s_waitcnt vmcnt(40)
    s_barrier
    ds_read_b64_tr_b16 v[32:33], v64 offset:49152
    ds_read_b64_tr_b16 v[34:35], v64 offset:49664
    v_mfma_f32_32x32x16_bf16 v[16:31], v[44:47], v[164:167], v[16:31]
    s_add_u32 s30, s29, 16384
    s_mov_b32 m0, s30
    s_add_u32 s36, s54, 8
    s_and_b32 s36, s36, 31
    s_lshl_b32 s36, s36, 18
    s_add_u32 s36, s36, s26
    buffer_load_dwordx4 v68, s[8:11], s36 offen offset:0 lds
    ds_read_b64_tr_b16 v[36:37], v65 offset:49152
    ds_read_b64_tr_b16 v[38:39], v65 offset:49664
    s_waitcnt lgkmcnt(8)
    v_mfma_f32_32x32x16_bf16 v[0:15], v[48:51], v[168:171], v[0:15]
    buffer_load_dwordx4 v69, s[8:11], s36 offen offset:1024 lds
    ds_read_b64_tr_b16 v[40:41], v64 offset:51200
    ds_read_b64_tr_b16 v[42:43], v64 offset:51712
    v_mfma_f32_32x32x16_bf16 v[16:31], v[52:55], v[168:171], v[16:31]
    buffer_load_dwordx4 v70, s[8:11], s36 offen offset:2048 lds
    ds_read_b64_tr_b16 v[44:45], v65 offset:51200
    ds_read_b64_tr_b16 v[46:47], v65 offset:51712
    s_waitcnt lgkmcnt(8)
    v_mfma_f32_32x32x16_bf16 v[0:15], v[56:59], v[172:175], v[0:15]
    buffer_load_dwordx4 v71, s[8:11], s36 offen offset:3072 lds
    ds_read_b64_tr_b16 v[48:49], v64 offset:53248
    ds_read_b64_tr_b16 v[50:51], v64 offset:53760
    v_mfma_f32_32x32x16_bf16 v[16:31], v[60:63], v[172:175], v[16:31]
    ds_read_b64_tr_b16 v[52:53], v65 offset:53248
    ds_read_b64_tr_b16 v[54:55], v65 offset:53760
    s_waitcnt vmcnt(16)
    s_waitcnt lgkmcnt(8)
    v_mfma_f32_32x32x16_bf16 v[0:15], v[32:35], v[80:83], v[0:15]
    s_add_u32 s37, s54, 5
    s_and_b32 s37, s37, 31
    s_lshl_b32 s37, s37, 13
    s_add_u32 s37, s37, s25
    s_add_u32 s37, s37, 0
    s_mov_b64 exec, s[38:39]
    buffer_load_dwordx4 v[144:147], v72, s[4:7], s37 offen offset:0
    s_mov_b64 exec, -1
    ds_read_b64_tr_b16 v[56:57], v64 offset:55296
    ds_read_b64_tr_b16 v[58:59], v64 offset:55808
    v_mfma_f32_32x32x16_bf16 v[16:31], v[36:39], v[80:83], v[16:31]
    s_mov_b64 exec, s[38:39]
    buffer_load_dwordx4 v[148:151], v72, s[4:7], s37 offen offset:1024
    s_mov_b64 exec, -1
    ds_read_b64_tr_b16 v[60:61], v65 offset:55296
    ds_read_b64_tr_b16 v[62:63], v65 offset:55808
    s_waitcnt lgkmcnt(8)
    v_mfma_f32_32x32x16_bf16 v[0:15], v[40:43], v[84:87], v[0:15]
    s_mov_b64 exec, s[38:39]
    buffer_load_dwordx4 v[152:155], v72, s[4:7], s37 offen offset:2048
    s_mov_b64 exec, -1
    ds_read_b64_tr_b16 v[32:33], v64 offset:57344
    ds_read_b64_tr_b16 v[34:35], v64 offset:57856
    v_mfma_f32_32x32x16_bf16 v[16:31], v[44:47], v[84:87], v[16:31]
    s_mov_b64 exec, s[38:39]
    buffer_load_dwordx4 v[156:159], v72, s[4:7], s37 offen offset:3072
    s_mov_b64 exec, -1
    ds_read_b64_tr_b16 v[36:37], v65 offset:57344
    ds_read_b64_tr_b16 v[38:39], v65 offset:57856
    s_waitcnt lgkmcnt(8)
    v_mfma_f32_32x32x16_bf16 v[0:15], v[48:51], v[88:91], v[0:15]
    s_add_u32 s37, s54, 5
    s_and_b32 s37, s37, 31
    s_lshl_b32 s37, s37, 13
    s_add_u32 s37, s37, s25
    s_add_u32 s37, s37, 4096
    s_mov_b64 exec, s[38:39]
    buffer_load_dwordx4 v[160:163], v72, s[4:7], s37 offen offset:0
    s_mov_b64 exec, -1
    ds_read_b64_tr_b16 v[40:41], v64 offset:59392
    ds_read_b64_tr_b16 v[42:43], v64 offset:59904
    v_mfma_f32_32x32x16_bf16 v[16:31], v[52:55], v[88:91], v[16:31]
    s_mov_b64 exec, s[38:39]
    buffer_load_dwordx4 v[164:167], v72, s[4:7], s37 offen offset:1024
    s_mov_b64 exec, -1
    ds_read_b64_tr_b16 v[44:45], v65 offset:59392
    ds_read_b64_tr_b16 v[46:47], v65 offset:59904
    s_waitcnt lgkmcnt(8)
    v_mfma_f32_32x32x16_bf16 v[0:15], v[56:59], v[92:95], v[0:15]
    s_mov_b64 exec, s[38:39]
    buffer_load_dwordx4 v[168:171], v72, s[4:7], s37 offen offset:2048
    s_mov_b64 exec, -1
    ds_read_b64_tr_b16 v[48:49], v64 offset:61440
    ds_read_b64_tr_b16 v[50:51], v64 offset:61952
    v_mfma_f32_32x32x16_bf16 v[16:31], v[60:63], v[92:95], v[16:31]
    s_mov_b64 exec, s[38:39]
    buffer_load_dwordx4 v[172:175], v72, s[4:7], s37 offen offset:3072
    s_mov_b64 exec, -1
    ds_read_b64_tr_b16 v[52:53], v65 offset:61440
    ds_read_b64_tr_b16 v[54:55], v65 offset:61952
    s_waitcnt lgkmcnt(8)
    v_mfma_f32_32x32x16_bf16 v[0:15], v[32:35], v[96:99], v[0:15]
    ds_read_b64_tr_b16 v[56:57], v64 offset:63488
    ds_read_b64_tr_b16 v[58:59], v64 offset:64000
    v_mfma_f32_32x32x16_bf16 v[16:31], v[36:39], v[96:99], v[16:31]
    ds_read_b64_tr_b16 v[60:61], v65 offset:63488
    ds_read_b64_tr_b16 v[62:63], v65 offset:64000
    s_waitcnt lgkmcnt(8)
    v_mfma_f32_32x32x16_bf16 v[0:15], v[40:43], v[100:103], v[0:15]
    s_waitcnt vmcnt(48)
    s_barrier
    ds_read_b64_tr_b16 v[32:33], v66 offset:0
    ds_read_b64_tr_b16 v[34:35], v66 offset:512
    v_mfma_f32_32x32x16_bf16 v[16:31], v[44:47], v[100:103], v[16:31]
    s_add_u32 s30, s29, 32768
    s_mov_b32 m0, s30
    s_add_u32 s36, s54, 9
    s_and_b32 s36, s36, 31
    s_lshl_b32 s36, s36, 18
    s_add_u32 s36, s36, s26
    buffer_load_dwordx4 v68, s[8:11], s36 offen offset:0 lds
    ds_read_b64_tr_b16 v[36:37], v67 offset:0
    ds_read_b64_tr_b16 v[38:39], v67 offset:512
    s_waitcnt lgkmcnt(8)
    v_mfma_f32_32x32x16_bf16 v[0:15], v[48:51], v[104:107], v[0:15]
    buffer_load_dwordx4 v69, s[8:11], s36 offen offset:1024 lds
    ds_read_b64_tr_b16 v[40:41], v66 offset:2048
    ds_read_b64_tr_b16 v[42:43], v66 offset:2560
    v_mfma_f32_32x32x16_bf16 v[16:31], v[52:55], v[104:107], v[16:31]
    buffer_load_dwordx4 v70, s[8:11], s36 offen offset:2048 lds
    ds_read_b64_tr_b16 v[44:45], v67 offset:2048
    ds_read_b64_tr_b16 v[46:47], v67 offset:2560
    s_waitcnt lgkmcnt(8)
    v_mfma_f32_32x32x16_bf16 v[0:15], v[56:59], v[108:111], v[0:15]
    buffer_load_dwordx4 v71, s[8:11], s36 offen offset:3072 lds
    ds_read_b64_tr_b16 v[48:49], v66 offset:4096
    ds_read_b64_tr_b16 v[50:51], v66 offset:4608
    v_mfma_f32_32x32x16_bf16 v[16:31], v[60:63], v[108:111], v[16:31]
    ds_read_b64_tr_b16 v[52:53], v67 offset:4096
    ds_read_b64_tr_b16 v[54:55], v67 offset:4608
    s_waitcnt vmcnt(16)
    s_waitcnt lgkmcnt(8)
    v_mfma_f32_32x32x16_bf16 v[0:15], v[32:35], v[112:115], v[0:15]
    s_add_u32 s37, s54, 6
    s_and_b32 s37, s37, 31
    s_lshl_b32 s37, s37, 13
    s_add_u32 s37, s37, s25
    s_add_u32 s37, s37, 0
    s_mov_b64 exec, s[38:39]
    buffer_load_dwordx4 v[80:83], v72, s[4:7], s37 offen offset:0
    s_mov_b64 exec, -1
    ds_read_b64_tr_b16 v[56:57], v66 offset:6144
    ds_read_b64_tr_b16 v[58:59], v66 offset:6656
    v_mfma_f32_32x32x16_bf16 v[16:31], v[36:39], v[112:115], v[16:31]
    s_mov_b64 exec, s[38:39]
    buffer_load_dwordx4 v[84:87], v72, s[4:7], s37 offen offset:1024
    s_mov_b64 exec, -1
    ds_read_b64_tr_b16 v[60:61], v67 offset:6144
    ds_read_b64_tr_b16 v[62:63], v67 offset:6656
    s_waitcnt lgkmcnt(8)
    v_mfma_f32_32x32x16_bf16 v[0:15], v[40:43], v[116:119], v[0:15]
    s_mov_b64 exec, s[38:39]
    buffer_load_dwordx4 v[88:91], v72, s[4:7], s37 offen offset:2048
    s_mov_b64 exec, -1
    ds_read_b64_tr_b16 v[32:33], v66 offset:8192
    ds_read_b64_tr_b16 v[34:35], v66 offset:8704
    v_mfma_f32_32x32x16_bf16 v[16:31], v[44:47], v[116:119], v[16:31]
    s_mov_b64 exec, s[38:39]
    buffer_load_dwordx4 v[92:95], v72, s[4:7], s37 offen offset:3072
    s_mov_b64 exec, -1
    ds_read_b64_tr_b16 v[36:37], v67 offset:8192
    ds_read_b64_tr_b16 v[38:39], v67 offset:8704
    s_waitcnt lgkmcnt(8)
    v_mfma_f32_32x32x16_bf16 v[0:15], v[48:51], v[120:123], v[0:15]
    s_add_u32 s37, s54, 6
    s_and_b32 s37, s37, 31
    s_lshl_b32 s37, s37, 13
    s_add_u32 s37, s37, s25
    s_add_u32 s37, s37, 4096
    s_mov_b64 exec, s[38:39]
    buffer_load_dwordx4 v[96:99], v72, s[4:7], s37 offen offset:0
    s_mov_b64 exec, -1
    ds_read_b64_tr_b16 v[40:41], v66 offset:10240
    ds_read_b64_tr_b16 v[42:43], v66 offset:10752
    v_mfma_f32_32x32x16_bf16 v[16:31], v[52:55], v[120:123], v[16:31]
    s_mov_b64 exec, s[38:39]
    buffer_load_dwordx4 v[100:103], v72, s[4:7], s37 offen offset:1024
    s_mov_b64 exec, -1
    ds_read_b64_tr_b16 v[44:45], v67 offset:10240
    ds_read_b64_tr_b16 v[46:47], v67 offset:10752
    s_waitcnt lgkmcnt(8)
    v_mfma_f32_32x32x16_bf16 v[0:15], v[56:59], v[124:127], v[0:15]
    s_mov_b64 exec, s[38:39]
    buffer_load_dwordx4 v[104:107], v72, s[4:7], s37 offen offset:2048
    s_mov_b64 exec, -1
    ds_read_b64_tr_b16 v[48:49], v66 offset:12288
    ds_read_b64_tr_b16 v[50:51], v66 offset:12800
    v_mfma_f32_32x32x16_bf16 v[16:31], v[60:63], v[124:127], v[16:31]
    s_mov_b64 exec, s[38:39]
    buffer_load_dwordx4 v[108:111], v72, s[4:7], s37 offen offset:3072
    s_mov_b64 exec, -1
    ds_read_b64_tr_b16 v[52:53], v67 offset:12288
    ds_read_b64_tr_b16 v[54:55], v67 offset:12800
    s_waitcnt lgkmcnt(8)
    v_mfma_f32_32x32x16_bf16 v[0:15], v[32:35], v[128:131], v[0:15]
    ds_read_b64_tr_b16 v[56:57], v66 offset:14336
    ds_read_b64_tr_b16 v[58:59], v66 offset:14848
    v_mfma_f32_32x32x16_bf16 v[16:31], v[36:39], v[128:131], v[16:31]
    ds_read_b64_tr_b16 v[60:61], v67 offset:14336
    ds_read_b64_tr_b16 v[62:63], v67 offset:14848
    s_waitcnt lgkmcnt(8)
    v_mfma_f32_32x32x16_bf16 v[0:15], v[40:43], v[132:135], v[0:15]
    s_waitcnt vmcnt(56)
    s_barrier
    ds_read_b64_tr_b16 v[32:33], v66 offset:16384
    ds_read_b64_tr_b16 v[34:35], v66 offset:16896
    v_mfma_f32_32x32x16_bf16 v[16:31], v[44:47], v[132:135], v[16:31]
    s_add_u32 s30, s29, 49152
    s_mov_b32 m0, s30
    s_add_u32 s36, s54, 10
    s_and_b32 s36, s36, 31
    s_lshl_b32 s36, s36, 18
    s_add_u32 s36, s36, s26
    buffer_load_dwordx4 v68, s[8:11], s36 offen offset:0 lds
    ds_read_b64_tr_b16 v[36:37], v67 offset:16384
    ds_read_b64_tr_b16 v[38:39], v67 offset:16896
    s_waitcnt lgkmcnt(8)
    v_mfma_f32_32x32x16_bf16 v[0:15], v[48:51], v[136:139], v[0:15]
    buffer_load_dwordx4 v69, s[8:11], s36 offen offset:1024 lds
    ds_read_b64_tr_b16 v[40:41], v66 offset:18432
    ds_read_b64_tr_b16 v[42:43], v66 offset:18944
    v_mfma_f32_32x32x16_bf16 v[16:31], v[52:55], v[136:139], v[16:31]
    buffer_load_dwordx4 v70, s[8:11], s36 offen offset:2048 lds
    ds_read_b64_tr_b16 v[44:45], v67 offset:18432
    ds_read_b64_tr_b16 v[46:47], v67 offset:18944
    s_waitcnt lgkmcnt(8)
    v_mfma_f32_32x32x16_bf16 v[0:15], v[56:59], v[140:143], v[0:15]
    buffer_load_dwordx4 v71, s[8:11], s36 offen offset:3072 lds
    ds_read_b64_tr_b16 v[48:49], v66 offset:20480
    ds_read_b64_tr_b16 v[50:51], v66 offset:20992
    v_mfma_f32_32x32x16_bf16 v[16:31], v[60:63], v[140:143], v[16:31]
    ds_read_b64_tr_b16 v[52:53], v67 offset:20480
    ds_read_b64_tr_b16 v[54:55], v67 offset:20992
    s_waitcnt vmcnt(16)
    s_waitcnt lgkmcnt(8)
    v_mfma_f32_32x32x16_bf16 v[0:15], v[32:35], v[144:147], v[0:15]
    s_add_u32 s37, s54, 7
    s_and_b32 s37, s37, 31
    s_lshl_b32 s37, s37, 13
    s_add_u32 s37, s37, s25
    s_add_u32 s37, s37, 0
    s_mov_b64 exec, s[38:39]
    buffer_load_dwordx4 v[112:115], v72, s[4:7], s37 offen offset:0
    s_mov_b64 exec, -1
    ds_read_b64_tr_b16 v[56:57], v66 offset:22528
    ds_read_b64_tr_b16 v[58:59], v66 offset:23040
    v_mfma_f32_32x32x16_bf16 v[16:31], v[36:39], v[144:147], v[16:31]
    s_mov_b64 exec, s[38:39]
    buffer_load_dwordx4 v[116:119], v72, s[4:7], s37 offen offset:1024
    s_mov_b64 exec, -1
    ds_read_b64_tr_b16 v[60:61], v67 offset:22528
    ds_read_b64_tr_b16 v[62:63], v67 offset:23040
    s_waitcnt lgkmcnt(8)
    v_mfma_f32_32x32x16_bf16 v[0:15], v[40:43], v[148:151], v[0:15]
    s_mov_b64 exec, s[38:39]
    buffer_load_dwordx4 v[120:123], v72, s[4:7], s37 offen offset:2048
    s_mov_b64 exec, -1
    ds_read_b64_tr_b16 v[32:33], v66 offset:24576
    ds_read_b64_tr_b16 v[34:35], v66 offset:25088
    v_mfma_f32_32x32x16_bf16 v[16:31], v[44:47], v[148:151], v[16:31]
    s_mov_b64 exec, s[38:39]
    buffer_load_dwordx4 v[124:127], v72, s[4:7], s37 offen offset:3072
    s_mov_b64 exec, -1
    ds_read_b64_tr_b16 v[36:37], v67 offset:24576
    ds_read_b64_tr_b16 v[38:39], v67 offset:25088
    s_waitcnt lgkmcnt(8)
    v_mfma_f32_32x32x16_bf16 v[0:15], v[48:51], v[152:155], v[0:15]
    s_add_u32 s37, s54, 7
    s_and_b32 s37, s37, 31
    s_lshl_b32 s37, s37, 13
    s_add_u32 s37, s37, s25
    s_add_u32 s37, s37, 4096
    s_mov_b64 exec, s[38:39]
    buffer_load_dwordx4 v[128:131], v72, s[4:7], s37 offen offset:0
    s_mov_b64 exec, -1
    ds_read_b64_tr_b16 v[40:41], v66 offset:26624
    ds_read_b64_tr_b16 v[42:43], v66 offset:27136
    v_mfma_f32_32x32x16_bf16 v[16:31], v[52:55], v[152:155], v[16:31]
    s_mov_b64 exec, s[38:39]
    buffer_load_dwordx4 v[132:135], v72, s[4:7], s37 offen offset:1024
    s_mov_b64 exec, -1
    ds_read_b64_tr_b16 v[44:45], v67 offset:26624
    ds_read_b64_tr_b16 v[46:47], v67 offset:27136
    s_waitcnt lgkmcnt(8)
    v_mfma_f32_32x32x16_bf16 v[0:15], v[56:59], v[156:159], v[0:15]
    s_mov_b64 exec, s[38:39]
    buffer_load_dwordx4 v[136:139], v72, s[4:7], s37 offen offset:2048
    s_mov_b64 exec, -1
    ds_read_b64_tr_b16 v[48:49], v66 offset:28672
    ds_read_b64_tr_b16 v[50:51], v66 offset:29184
    v_mfma_f32_32x32x16_bf16 v[16:31], v[60:63], v[156:159], v[16:31]
    s_mov_b64 exec, s[38:39]
    buffer_load_dwordx4 v[140:143], v72, s[4:7], s37 offen offset:3072
    s_mov_b64 exec, -1
    ds_read_b64_tr_b16 v[52:53], v67 offset:28672
    ds_read_b64_tr_b16 v[54:55], v67 offset:29184
    s_waitcnt lgkmcnt(8)
    v_mfma_f32_32x32x16_bf16 v[0:15], v[32:35], v[160:163], v[0:15]
    ds_read_b64_tr_b16 v[56:57], v66 offset:30720
    ds_read_b64_tr_b16 v[58:59], v66 offset:31232
    v_mfma_f32_32x32x16_bf16 v[16:31], v[36:39], v[160:163], v[16:31]
    ds_read_b64_tr_b16 v[60:61], v67 offset:30720
    ds_read_b64_tr_b16 v[62:63], v67 offset:31232
    s_waitcnt lgkmcnt(8)
    v_mfma_f32_32x32x16_bf16 v[0:15], v[40:43], v[164:167], v[0:15]
    s_waitcnt vmcnt(63)
    s_barrier
    ds_read_b64_tr_b16 v[32:33], v66 offset:32768
    ds_read_b64_tr_b16 v[34:35], v66 offset:33280
    v_mfma_f32_32x32x16_bf16 v[16:31], v[44:47], v[164:167], v[16:31]
    s_add_u32 s30, s29, 65536
    s_mov_b32 m0, s30
    s_add_u32 s36, s54, 11
    s_and_b32 s36, s36, 31
    s_lshl_b32 s36, s36, 18
    s_add_u32 s36, s36, s26
    buffer_load_dwordx4 v68, s[8:11], s36 offen offset:0 lds
    ds_read_b64_tr_b16 v[36:37], v67 offset:32768
    ds_read_b64_tr_b16 v[38:39], v67 offset:33280
    s_waitcnt lgkmcnt(8)
    v_mfma_f32_32x32x16_bf16 v[0:15], v[48:51], v[168:171], v[0:15]
    buffer_load_dwordx4 v69, s[8:11], s36 offen offset:1024 lds
    ds_read_b64_tr_b16 v[40:41], v66 offset:34816
    ds_read_b64_tr_b16 v[42:43], v66 offset:35328
    v_mfma_f32_32x32x16_bf16 v[16:31], v[52:55], v[168:171], v[16:31]
    buffer_load_dwordx4 v70, s[8:11], s36 offen offset:2048 lds
    ds_read_b64_tr_b16 v[44:45], v67 offset:34816
    ds_read_b64_tr_b16 v[46:47], v67 offset:35328
    s_waitcnt lgkmcnt(8)
    v_mfma_f32_32x32x16_bf16 v[0:15], v[56:59], v[172:175], v[0:15]
    buffer_load_dwordx4 v71, s[8:11], s36 offen offset:3072 lds
    ds_read_b64_tr_b16 v[48:49], v66 offset:36864
    ds_read_b64_tr_b16 v[50:51], v66 offset:37376
    v_mfma_f32_32x32x16_bf16 v[16:31], v[60:63], v[172:175], v[16:31]
    ds_read_b64_tr_b16 v[52:53], v67 offset:36864
    ds_read_b64_tr_b16 v[54:55], v67 offset:37376
    s_waitcnt vmcnt(16)
    s_waitcnt lgkmcnt(8)
    v_mfma_f32_32x32x16_bf16 v[0:15], v[32:35], v[80:83], v[0:15]
    s_add_u32 s37, s54, 8
    s_and_b32 s37, s37, 31
    s_lshl_b32 s37, s37, 13
    s_add_u32 s37, s37, s25
    s_add_u32 s37, s37, 0
    s_mov_b64 exec, s[38:39]
    buffer_load_dwordx4 v[144:147], v72, s[4:7], s37 offen offset:0
    s_mov_b64 exec, -1
    ds_read_b64_tr_b16 v[56:57], v66 offset:38912
    ds_read_b64_tr_b16 v[58:59], v66 offset:39424
    v_mfma_f32_32x32x16_bf16 v[16:31], v[36:39], v[80:83], v[16:31]
    s_mov_b64 exec, s[38:39]
    buffer_load_dwordx4 v[148:151], v72, s[4:7], s37 offen offset:1024
    s_mov_b64 exec, -1
    ds_read_b64_tr_b16 v[60:61], v67 offset:38912
    ds_read_b64_tr_b16 v[62:63], v67 offset:39424
    s_waitcnt lgkmcnt(8)
    v_mfma_f32_32x32x16_bf16 v[0:15], v[40:43], v[84:87], v[0:15]
    s_mov_b64 exec, s[38:39]
    buffer_load_dwordx4 v[152:155], v72, s[4:7], s37 offen offset:2048
    s_mov_b64 exec, -1
    ds_read_b64_tr_b16 v[32:33], v66 offset:40960
    ds_read_b64_tr_b16 v[34:35], v66 offset:41472
    v_mfma_f32_32x32x16_bf16 v[16:31], v[44:47], v[84:87], v[16:31]
    s_mov_b64 exec, s[38:39]
    buffer_load_dwordx4 v[156:159], v72, s[4:7], s37 offen offset:3072
    s_mov_b64 exec, -1
    ds_read_b64_tr_b16 v[36:37], v67 offset:40960
    ds_read_b64_tr_b16 v[38:39], v67 offset:41472
    s_waitcnt lgkmcnt(8)
    v_mfma_f32_32x32x16_bf16 v[0:15], v[48:51], v[88:91], v[0:15]
    s_add_u32 s37, s54, 8
    s_and_b32 s37, s37, 31
    s_lshl_b32 s37, s37, 13
    s_add_u32 s37, s37, s25
    s_add_u32 s37, s37, 4096
    s_mov_b64 exec, s[38:39]
    buffer_load_dwordx4 v[160:163], v72, s[4:7], s37 offen offset:0
    s_mov_b64 exec, -1
    ds_read_b64_tr_b16 v[40:41], v66 offset:43008
    ds_read_b64_tr_b16 v[42:43], v66 offset:43520
    v_mfma_f32_32x32x16_bf16 v[16:31], v[52:55], v[88:91], v[16:31]
    s_mov_b64 exec, s[38:39]
    buffer_load_dwordx4 v[164:167], v72, s[4:7], s37 offen offset:1024
    s_mov_b64 exec, -1
    ds_read_b64_tr_b16 v[44:45], v67 offset:43008
    ds_read_b64_tr_b16 v[46:47], v67 offset:43520
    s_waitcnt lgkmcnt(8)
    v_mfma_f32_32x32x16_bf16 v[0:15], v[56:59], v[92:95], v[0:15]
    s_mov_b64 exec, s[38:39]
    buffer_load_dwordx4 v[168:171], v72, s[4:7], s37 offen offset:2048
    s_mov_b64 exec, -1
    ds_read_b64_tr_b16 v[48:49], v66 offset:45056
    ds_read_b64_tr_b16 v[50:51], v66 offset:45568
    v_mfma_f32_32x32x16_bf16 v[16:31], v[60:63], v[92:95], v[16:31]
    s_mov_b64 exec, s[38:39]
    buffer_load_dwordx4 v[172:175], v72, s[4:7], s37 offen offset:3072
    s_mov_b64 exec, -1
    ds_read_b64_tr_b16 v[52:53], v67 offset:45056
    ds_read_b64_tr_b16 v[54:55], v67 offset:45568
    s_waitcnt lgkmcnt(8)
    v_mfma_f32_32x32x16_bf16 v[0:15], v[32:35], v[96:99], v[0:15]
    ds_read_b64_tr_b16 v[56:57], v66 offset:47104
    ds_read_b64_tr_b16 v[58:59], v66 offset:47616
    v_mfma_f32_32x32x16_bf16 v[16:31], v[36:39], v[96:99], v[16:31]
    ds_read_b64_tr_b16 v[60:61], v67 offset:47104
    ds_read_b64_tr_b16 v[62:63], v67 offset:47616
    s_waitcnt lgkmcnt(8)
    v_mfma_f32_32x32x16_bf16 v[0:15], v[40:43], v[100:103], v[0:15]
    s_waitcnt vmcnt(56)
    s_barrier
    ds_read_b64_tr_b16 v[32:33], v64 offset:0
    ds_read_b64_tr_b16 v[34:35], v64 offset:512
    v_mfma_f32_32x32x16_bf16 v[16:31], v[44:47], v[100:103], v[16:31]
    s_add_u32 s30, s29, 81920
    s_mov_b32 m0, s30
    s_add_u32 s36, s54, 12
    s_and_b32 s36, s36, 31
    s_lshl_b32 s36, s36, 18
    s_add_u32 s36, s36, s26
    buffer_load_dwordx4 v68, s[8:11], s36 offen offset:0 lds
    ds_read_b64_tr_b16 v[36:37], v65 offset:0
    ds_read_b64_tr_b16 v[38:39], v65 offset:512
    s_waitcnt lgkmcnt(8)
    v_mfma_f32_32x32x16_bf16 v[0:15], v[48:51], v[104:107], v[0:15]
    buffer_load_dwordx4 v69, s[8:11], s36 offen offset:1024 lds
    ds_read_b64_tr_b16 v[40:41], v64 offset:2048
    ds_read_b64_tr_b16 v[42:43], v64 offset:2560
    v_mfma_f32_32x32x16_bf16 v[16:31], v[52:55], v[104:107], v[16:31]
    buffer_load_dwordx4 v70, s[8:11], s36 offen offset:2048 lds
    ds_read_b64_tr_b16 v[44:45], v65 offset:2048
    ds_read_b64_tr_b16 v[46:47], v65 offset:2560
    s_waitcnt lgkmcnt(8)
    v_mfma_f32_32x32x16_bf16 v[0:15], v[56:59], v[108:111], v[0:15]
    buffer_load_dwordx4 v71, s[8:11], s36 offen offset:3072 lds
    ds_read_b64_tr_b16 v[48:49], v64 offset:4096
    ds_read_b64_tr_b16 v[50:51], v64 offset:4608
    v_mfma_f32_32x32x16_bf16 v[16:31], v[60:63], v[108:111], v[16:31]
    ds_read_b64_tr_b16 v[52:53], v65 offset:4096
    ds_read_b64_tr_b16 v[54:55], v65 offset:4608
    s_waitcnt vmcnt(16)
    s_waitcnt lgkmcnt(8)
    v_mfma_f32_32x32x16_bf16 v[0:15], v[32:35], v[112:115], v[0:15]
    s_add_u32 s37, s54, 9
    s_and_b32 s37, s37, 31
    s_lshl_b32 s37, s37, 13
    s_add_u32 s37, s37, s25
    s_add_u32 s37, s37, 0
    s_mov_b64 exec, s[38:39]
    buffer_load_dwordx4 v[80:83], v72, s[4:7], s37 offen offset:0
    s_mov_b64 exec, -1
    ds_read_b64_tr_b16 v[56:57], v64 offset:6144
    ds_read_b64_tr_b16 v[58:59], v64 offset:6656
    v_mfma_f32_32x32x16_bf16 v[16:31], v[36:39], v[112:115], v[16:31]
    s_mov_b64 exec, s[38:39]
    buffer_load_dwordx4 v[84:87], v72, s[4:7], s37 offen offset:1024
    s_mov_b64 exec, -1
    ds_read_b64_tr_b16 v[60:61], v65 offset:6144
    ds_read_b64_tr_b16 v[62:63], v65 offset:6656
    s_waitcnt lgkmcnt(8)
    v_mfma_f32_32x32x16_bf16 v[0:15], v[40:43], v[116:119], v[0:15]
    s_mov_b64 exec, s[38:39]
    buffer_load_dwordx4 v[88:91], v72, s[4:7], s37 offen offset:2048
    s_mov_b64 exec, -1
    ds_read_b64_tr_b16 v[32:33], v64 offset:8192
    ds_read_b64_tr_b16 v[34:35], v64 offset:8704
    v_mfma_f32_32x32x16_bf16 v[16:31], v[44:47], v[116:119], v[16:31]
    s_mov_b64 exec, s[38:39]
    buffer_load_dwordx4 v[92:95], v72, s[4:7], s37 offen offset:3072
    s_mov_b64 exec, -1
    ds_read_b64_tr_b16 v[36:37], v65 offset:8192
    ds_read_b64_tr_b16 v[38:39], v65 offset:8704
    s_waitcnt lgkmcnt(8)
    v_mfma_f32_32x32x16_bf16 v[0:15], v[48:51], v[120:123], v[0:15]
    s_add_u32 s37, s54, 9
    s_and_b32 s37, s37, 31
    s_lshl_b32 s37, s37, 13
    s_add_u32 s37, s37, s25
    s_add_u32 s37, s37, 4096
    s_mov_b64 exec, s[38:39]
    buffer_load_dwordx4 v[96:99], v72, s[4:7], s37 offen offset:0
    s_mov_b64 exec, -1
    ds_read_b64_tr_b16 v[40:41], v64 offset:10240
    ds_read_b64_tr_b16 v[42:43], v64 offset:10752
    v_mfma_f32_32x32x16_bf16 v[16:31], v[52:55], v[120:123], v[16:31]
    s_mov_b64 exec, s[38:39]
    buffer_load_dwordx4 v[100:103], v72, s[4:7], s37 offen offset:1024
    s_mov_b64 exec, -1
    ds_read_b64_tr_b16 v[44:45], v65 offset:10240
    ds_read_b64_tr_b16 v[46:47], v65 offset:10752
    s_waitcnt lgkmcnt(8)
    v_mfma_f32_32x32x16_bf16 v[0:15], v[56:59], v[124:127], v[0:15]
    s_mov_b64 exec, s[38:39]
    buffer_load_dwordx4 v[104:107], v72, s[4:7], s37 offen offset:2048
    s_mov_b64 exec, -1
    ds_read_b64_tr_b16 v[48:49], v64 offset:12288
    ds_read_b64_tr_b16 v[50:51], v64 offset:12800
    v_mfma_f32_32x32x16_bf16 v[16:31], v[60:63], v[124:127], v[16:31]
    s_mov_b64 exec, s[38:39]
    buffer_load_dwordx4 v[108:111], v72, s[4:7], s37 offen offset:3072
    s_mov_b64 exec, -1
    ds_read_b64_tr_b16 v[52:53], v65 offset:12288
    ds_read_b64_tr_b16 v[54:55], v65 offset:12800
    s_waitcnt lgkmcnt(8)
    v_mfma_f32_32x32x16_bf16 v[0:15], v[32:35], v[128:131], v[0:15]
    ds_read_b64_tr_b16 v[56:57], v64 offset:14336
    ds_read_b64_tr_b16 v[58:59], v64 offset:14848
    v_mfma_f32_32x32x16_bf16 v[16:31], v[36:39], v[128:131], v[16:31]
    ds_read_b64_tr_b16 v[60:61], v65 offset:14336
    ds_read_b64_tr_b16 v[62:63], v65 offset:14848
    s_waitcnt lgkmcnt(8)
    v_mfma_f32_32x32x16_bf16 v[0:15], v[40:43], v[132:135], v[0:15]
    s_waitcnt vmcnt(56)
    s_barrier
    ds_read_b64_tr_b16 v[32:33], v64 offset:16384
    ds_read_b64_tr_b16 v[34:35], v64 offset:16896
    v_mfma_f32_32x32x16_bf16 v[16:31], v[44:47], v[132:135], v[16:31]
    s_add_u32 s30, s29, 98304
    s_mov_b32 m0, s30
    s_add_u32 s36, s54, 13
    s_and_b32 s36, s36, 31
    s_lshl_b32 s36, s36, 18
    s_add_u32 s36, s36, s26
    buffer_load_dwordx4 v68, s[8:11], s36 offen offset:0 lds
    ds_read_b64_tr_b16 v[36:37], v65 offset:16384
    ds_read_b64_tr_b16 v[38:39], v65 offset:16896
    s_waitcnt lgkmcnt(8)
    v_mfma_f32_32x32x16_bf16 v[0:15], v[48:51], v[136:139], v[0:15]
    buffer_load_dwordx4 v69, s[8:11], s36 offen offset:1024 lds
    ds_read_b64_tr_b16 v[40:41], v64 offset:18432
    ds_read_b64_tr_b16 v[42:43], v64 offset:18944
    v_mfma_f32_32x32x16_bf16 v[16:31], v[52:55], v[136:139], v[16:31]
    buffer_load_dwordx4 v70, s[8:11], s36 offen offset:2048 lds
    ds_read_b64_tr_b16 v[44:45], v65 offset:18432
    ds_read_b64_tr_b16 v[46:47], v65 offset:18944
    s_waitcnt lgkmcnt(8)
    v_mfma_f32_32x32x16_bf16 v[0:15], v[56:59], v[140:143], v[0:15]
    buffer_load_dwordx4 v71, s[8:11], s36 offen offset:3072 lds
    ds_read_b64_tr_b16 v[48:49], v64 offset:20480
    ds_read_b64_tr_b16 v[50:51], v64 offset:20992
    v_mfma_f32_32x32x16_bf16 v[16:31], v[60:63], v[140:143], v[16:31]
    ds_read_b64_tr_b16 v[52:53], v65 offset:20480
    ds_read_b64_tr_b16 v[54:55], v65 offset:20992
    s_waitcnt vmcnt(16)
    s_waitcnt lgkmcnt(8)
    v_mfma_f32_32x32x16_bf16 v[0:15], v[32:35], v[144:147], v[0:15]
    s_add_u32 s37, s54, 10
    s_and_b32 s37, s37, 31
    s_lshl_b32 s37, s37, 13
    s_add_u32 s37, s37, s25
    s_add_u32 s37, s37, 0
    s_mov_b64 exec, s[38:39]
    buffer_load_dwordx4 v[112:115], v72, s[4:7], s37 offen offset:0
    s_mov_b64 exec, -1
    ds_read_b64_tr_b16 v[56:57], v64 offset:22528
    ds_read_b64_tr_b16 v[58:59], v64 offset:23040
    v_mfma_f32_32x32x16_bf16 v[16:31], v[36:39], v[144:147], v[16:31]
    s_mov_b64 exec, s[38:39]
    buffer_load_dwordx4 v[116:119], v72, s[4:7], s37 offen offset:1024
    s_mov_b64 exec, -1
    ds_read_b64_tr_b16 v[60:61], v65 offset:22528
    ds_read_b64_tr_b16 v[62:63], v65 offset:23040
    s_waitcnt lgkmcnt(8)
    v_mfma_f32_32x32x16_bf16 v[0:15], v[40:43], v[148:151], v[0:15]
    s_mov_b64 exec, s[38:39]
    buffer_load_dwordx4 v[120:123], v72, s[4:7], s37 offen offset:2048
    s_mov_b64 exec, -1
    ds_read_b64_tr_b16 v[32:33], v64 offset:24576
    ds_read_b64_tr_b16 v[34:35], v64 offset:25088
    v_mfma_f32_32x32x16_bf16 v[16:31], v[44:47], v[148:151], v[16:31]
    s_mov_b64 exec, s[38:39]
    buffer_load_dwordx4 v[124:127], v72, s[4:7], s37 offen offset:3072
    s_mov_b64 exec, -1
    ds_read_b64_tr_b16 v[36:37], v65 offset:24576
    ds_read_b64_tr_b16 v[38:39], v65 offset:25088
    s_waitcnt lgkmcnt(8)
    v_mfma_f32_32x32x16_bf16 v[0:15], v[48:51], v[152:155], v[0:15]
    s_add_u32 s37, s54, 10
    s_and_b32 s37, s37, 31
    s_lshl_b32 s37, s37, 13
    s_add_u32 s37, s37, s25
    s_add_u32 s37, s37, 4096
    s_mov_b64 exec, s[38:39]
    buffer_load_dwordx4 v[128:131], v72, s[4:7], s37 offen offset:0
    s_mov_b64 exec, -1
    ds_read_b64_tr_b16 v[40:41], v64 offset:26624
    ds_read_b64_tr_b16 v[42:43], v64 offset:27136
    v_mfma_f32_32x32x16_bf16 v[16:31], v[52:55], v[152:155], v[16:31]
    s_mov_b64 exec, s[38:39]
    buffer_load_dwordx4 v[132:135], v72, s[4:7], s37 offen offset:1024
    s_mov_b64 exec, -1
    ds_read_b64_tr_b16 v[44:45], v65 offset:26624
    ds_read_b64_tr_b16 v[46:47], v65 offset:27136
    s_waitcnt lgkmcnt(8)
    v_mfma_f32_32x32x16_bf16 v[0:15], v[56:59], v[156:159], v[0:15]
    s_mov_b64 exec, s[38:39]
    buffer_load_dwordx4 v[136:139], v72, s[4:7], s37 offen offset:2048
    s_mov_b64 exec, -1
    ds_read_b64_tr_b16 v[48:49], v64 offset:28672
    ds_read_b64_tr_b16 v[50:51], v64 offset:29184
    v_mfma_f32_32x32x16_bf16 v[16:31], v[60:63], v[156:159], v[16:31]
    s_mov_b64 exec, s[38:39]
    buffer_load_dwordx4 v[140:143], v72, s[4:7], s37 offen offset:3072
    s_mov_b64 exec, -1
    ds_read_b64_tr_b16 v[52:53], v65 offset:28672
    ds_read_b64_tr_b16 v[54:55], v65 offset:29184
    s_waitcnt lgkmcnt(8)
    v_mfma_f32_32x32x16_bf16 v[0:15], v[32:35], v[160:163], v[0:15]
    ds_read_b64_tr_b16 v[56:57], v64 offset:30720
    ds_read_b64_tr_b16 v[58:59], v64 offset:31232
    v_mfma_f32_32x32x16_bf16 v[16:31], v[36:39], v[160:163], v[16:31]
    ds_read_b64_tr_b16 v[60:61], v65 offset:30720
    ds_read_b64_tr_b16 v[62:63], v65 offset:31232
    s_waitcnt lgkmcnt(8)
    v_mfma_f32_32x32x16_bf16 v[0:15], v[40:43], v[164:167], v[0:15]
    s_waitcnt vmcnt(56)
    s_barrier
    ds_read_b64_tr_b16 v[32:33], v64 offset:32768
    ds_read_b64_tr_b16 v[34:35], v64 offset:33280
    v_mfma_f32_32x32x16_bf16 v[16:31], v[44:47], v[164:167], v[16:31]
    s_add_u32 s30, s29, 0
    s_mov_b32 m0, s30
    s_add_u32 s36, s54, 14
    s_and_b32 s36, s36, 31
    s_lshl_b32 s36, s36, 18
    s_add_u32 s36, s36, s26
    buffer_load_dwordx4 v68, s[8:11], s36 offen offset:0 lds
    ds_read_b64_tr_b16 v[36:37], v65 offset:32768
    ds_read_b64_tr_b16 v[38:39], v65 offset:33280
    s_waitcnt lgkmcnt(8)
    v_mfma_f32_32x32x16_bf16 v[0:15], v[48:51], v[168:171], v[0:15]
    buffer_load_dwordx4 v69, s[8:11], s36 offen offset:1024 lds
    ds_read_b64_tr_b16 v[40:41], v64 offset:34816
    ds_read_b64_tr_b16 v[42:43], v64 offset:35328
    v_mfma_f32_32x32x16_bf16 v[16:31], v[52:55], v[168:171], v[16:31]
    buffer_load_dwordx4 v70, s[8:11], s36 offen offset:2048 lds
    ds_read_b64_tr_b16 v[44:45], v65 offset:34816
    ds_read_b64_tr_b16 v[46:47], v65 offset:35328
    s_waitcnt lgkmcnt(8)
    v_mfma_f32_32x32x16_bf16 v[0:15], v[56:59], v[172:175], v[0:15]
    buffer_load_dwordx4 v71, s[8:11], s36 offen offset:3072 lds
    ds_read_b64_tr_b16 v[48:49], v64 offset:36864
    ds_read_b64_tr_b16 v[50:51], v64 offset:37376
    v_mfma_f32_32x32x16_bf16 v[16:31], v[60:63], v[172:175], v[16:31]
    ds_read_b64_tr_b16 v[52:53], v65 offset:36864
    ds_read_b64_tr_b16 v[54:55], v65 offset:37376
    s_waitcnt vmcnt(16)
    s_waitcnt lgkmcnt(8)
    v_mfma_f32_32x32x16_bf16 v[0:15], v[32:35], v[80:83], v[0:15]
    s_add_u32 s37, s54, 11
    s_and_b32 s37, s37, 31
    s_lshl_b32 s37, s37, 13
    s_add_u32 s37, s37, s25
    s_add_u32 s37, s37, 0
    s_mov_b64 exec, s[38:39]
    buffer_load_dwordx4 v[144:147], v72, s[4:7], s37 offen offset:0
    s_mov_b64 exec, -1
    ds_read_b64_tr_b16 v[56:57], v64 offset:38912
    ds_read_b64_tr_b16 v[58:59], v64 offset:39424
    v_mfma_f32_32x32x16_bf16 v[16:31], v[36:39], v[80:83], v[16:31]
    s_mov_b64 exec, s[38:39]
    buffer_load_dwordx4 v[148:151], v72, s[4:7], s37 offen offset:1024
    s_mov_b64 exec, -1
    ds_read_b64_tr_b16 v[60:61], v65 offset:38912
    ds_read_b64_tr_b16 v[62:63], v65 offset:39424
    s_waitcnt lgkmcnt(8)
    v_mfma_f32_32x32x16_bf16 v[0:15], v[40:43], v[84:87], v[0:15]
    s_mov_b64 exec, s[38:39]
    buffer_load_dwordx4 v[152:155], v72, s[4:7], s37 offen offset:2048
    s_mov_b64 exec, -1
    ds_read_b64_tr_b16 v[32:33], v64 offset:40960
    ds_read_b64_tr_b16 v[34:35], v64 offset:41472
    v_mfma_f32_32x32x16_bf16 v[16:31], v[44:47], v[84:87], v[16:31]
    s_mov_b64 exec, s[38:39]
    buffer_load_dwordx4 v[156:159], v72, s[4:7], s37 offen offset:3072
    s_mov_b64 exec, -1
    ds_read_b64_tr_b16 v[36:37], v65 offset:40960
    ds_read_b64_tr_b16 v[38:39], v65 offset:41472
    s_waitcnt lgkmcnt(8)
    v_mfma_f32_32x32x16_bf16 v[0:15], v[48:51], v[88:91], v[0:15]
    s_add_u32 s37, s54, 11
    s_and_b32 s37, s37, 31
    s_lshl_b32 s37, s37, 13
    s_add_u32 s37, s37, s25
    s_add_u32 s37, s37, 4096
    s_mov_b64 exec, s[38:39]
    buffer_load_dwordx4 v[160:163], v72, s[4:7], s37 offen offset:0
    s_mov_b64 exec, -1
    ds_read_b64_tr_b16 v[40:41], v64 offset:43008
    ds_read_b64_tr_b16 v[42:43], v64 offset:43520
    v_mfma_f32_32x32x16_bf16 v[16:31], v[52:55], v[88:91], v[16:31]
    s_mov_b64 exec, s[38:39]
    buffer_load_dwordx4 v[164:167], v72, s[4:7], s37 offen offset:1024
    s_mov_b64 exec, -1
    ds_read_b64_tr_b16 v[44:45], v65 offset:43008
    ds_read_b64_tr_b16 v[46:47], v65 offset:43520
    s_waitcnt lgkmcnt(8)
    v_mfma_f32_32x32x16_bf16 v[0:15], v[56:59], v[92:95], v[0:15]
    s_mov_b64 exec, s[38:39]
    buffer_load_dwordx4 v[168:171], v72, s[4:7], s37 offen offset:2048
    s_mov_b64 exec, -1
    ds_read_b64_tr_b16 v[48:49], v64 offset:45056
    ds_read_b64_tr_b16 v[50:51], v64 offset:45568
    v_mfma_f32_32x32x16_bf16 v[16:31], v[60:63], v[92:95], v[16:31]
    s_mov_b64 exec, s[38:39]
    buffer_load_dwordx4 v[172:175], v72, s[4:7], s37 offen offset:3072
    s_mov_b64 exec, -1
    ds_read_b64_tr_b16 v[52:53], v65 offset:45056
    ds_read_b64_tr_b16 v[54:55], v65 offset:45568
    s_waitcnt lgkmcnt(8)
    v_mfma_f32_32x32x16_bf16 v[0:15], v[32:35], v[96:99], v[0:15]
    ds_read_b64_tr_b16 v[56:57], v64 offset:47104
    ds_read_b64_tr_b16 v[58:59], v64 offset:47616
    v_mfma_f32_32x32x16_bf16 v[16:31], v[36:39], v[96:99], v[16:31]
    ds_read_b64_tr_b16 v[60:61], v65 offset:47104
    ds_read_b64_tr_b16 v[62:63], v65 offset:47616
    s_waitcnt lgkmcnt(8)
    v_mfma_f32_32x32x16_bf16 v[0:15], v[40:43], v[100:103], v[0:15]
    s_waitcnt vmcnt(56)
    s_barrier
    ds_read_b64_tr_b16 v[32:33], v64 offset:49152
    ds_read_b64_tr_b16 v[34:35], v64 offset:49664
    v_mfma_f32_32x32x16_bf16 v[16:31], v[44:47], v[100:103], v[16:31]
    s_add_u32 s30, s29, 16384
    s_mov_b32 m0, s30
    s_add_u32 s36, s54, 15
    s_and_b32 s36, s36, 31
    s_lshl_b32 s36, s36, 18
    s_add_u32 s36, s36, s26
    buffer_load_dwordx4 v68, s[8:11], s36 offen offset:0 lds
    ds_read_b64_tr_b16 v[36:37], v65 offset:49152
    ds_read_b64_tr_b16 v[38:39], v65 offset:49664
    s_waitcnt lgkmcnt(8)
    v_mfma_f32_32x32x16_bf16 v[0:15], v[48:51], v[104:107], v[0:15]
    buffer_load_dwordx4 v69, s[8:11], s36 offen offset:1024 lds
    ds_read_b64_tr_b16 v[40:41], v64 offset:51200
    ds_read_b64_tr_b16 v[42:43], v64 offset:51712
    v_mfma_f32_32x32x16_bf16 v[16:31], v[52:55], v[104:107], v[16:31]
    buffer_load_dwordx4 v70, s[8:11], s36 offen offset:2048 lds
    ds_read_b64_tr_b16 v[44:45], v65 offset:51200
    ds_read_b64_tr_b16 v[46:47], v65 offset:51712
    s_waitcnt lgkmcnt(8)
    v_mfma_f32_32x32x16_bf16 v[0:15], v[56:59], v[108:111], v[0:15]
    buffer_load_dwordx4 v71, s[8:11], s36 offen offset:3072 lds
    ds_read_b64_tr_b16 v[48:49], v64 offset:53248
    ds_read_b64_tr_b16 v[50:51], v64 offset:53760
    v_mfma_f32_32x32x16_bf16 v[16:31], v[60:63], v[108:111], v[16:31]
    ds_read_b64_tr_b16 v[52:53], v65 offset:53248
    ds_read_b64_tr_b16 v[54:55], v65 offset:53760
    s_waitcnt vmcnt(16)
    s_waitcnt lgkmcnt(8)
    v_mfma_f32_32x32x16_bf16 v[0:15], v[32:35], v[112:115], v[0:15]
    s_add_u32 s37, s54, 12
    s_and_b32 s37, s37, 31
    s_lshl_b32 s37, s37, 13
    s_add_u32 s37, s37, s25
    s_add_u32 s37, s37, 0
    s_mov_b64 exec, s[38:39]
    buffer_load_dwordx4 v[80:83], v72, s[4:7], s37 offen offset:0
    s_mov_b64 exec, -1
    ds_read_b64_tr_b16 v[56:57], v64 offset:55296
    ds_read_b64_tr_b16 v[58:59], v64 offset:55808
    v_mfma_f32_32x32x16_bf16 v[16:31], v[36:39], v[112:115], v[16:31]
    s_mov_b64 exec, s[38:39]
    buffer_load_dwordx4 v[84:87], v72, s[4:7], s37 offen offset:1024
    s_mov_b64 exec, -1
    ds_read_b64_tr_b16 v[60:61], v65 offset:55296
    ds_read_b64_tr_b16 v[62:63], v65 offset:55808
    s_waitcnt lgkmcnt(8)
    v_mfma_f32_32x32x16_bf16 v[0:15], v[40:43], v[116:119], v[0:15]
    s_mov_b64 exec, s[38:39]
    buffer_load_dwordx4 v[88:91], v72, s[4:7], s37 offen offset:2048
    s_mov_b64 exec, -1
    ds_read_b64_tr_b16 v[32:33], v64 offset:57344
    ds_read_b64_tr_b16 v[34:35], v64 offset:57856
    v_mfma_f32_32x32x16_bf16 v[16:31], v[44:47], v[116:119], v[16:31]
    s_mov_b64 exec, s[38:39]
    buffer_load_dwordx4 v[92:95], v72, s[4:7], s37 offen offset:3072
    s_mov_b64 exec, -1
    ds_read_b64_tr_b16 v[36:37], v65 offset:57344
    ds_read_b64_tr_b16 v[38:39], v65 offset:57856
    s_waitcnt lgkmcnt(8)
    v_mfma_f32_32x32x16_bf16 v[0:15], v[48:51], v[120:123], v[0:15]
    s_add_u32 s37, s54, 12
    s_and_b32 s37, s37, 31
    s_lshl_b32 s37, s37, 13
    s_add_u32 s37, s37, s25
    s_add_u32 s37, s37, 4096
    s_mov_b64 exec, s[38:39]
    buffer_load_dwordx4 v[96:99], v72, s[4:7], s37 offen offset:0
    s_mov_b64 exec, -1
    ds_read_b64_tr_b16 v[40:41], v64 offset:59392
    ds_read_b64_tr_b16 v[42:43], v64 offset:59904
    v_mfma_f32_32x32x16_bf16 v[16:31], v[52:55], v[120:123], v[16:31]
    s_mov_b64 exec, s[38:39]
    buffer_load_dwordx4 v[100:103], v72, s[4:7], s37 offen offset:1024
    s_mov_b64 exec, -1
    ds_read_b64_tr_b16 v[44:45], v65 offset:59392
    ds_read_b64_tr_b16 v[46:47], v65 offset:59904
    s_waitcnt lgkmcnt(8)
    v_mfma_f32_32x32x16_bf16 v[0:15], v[56:59], v[124:127], v[0:15]
    s_mov_b64 exec, s[38:39]
    buffer_load_dwordx4 v[104:107], v72, s[4:7], s37 offen offset:2048
    s_mov_b64 exec, -1
    ds_read_b64_tr_b16 v[48:49], v64 offset:61440
    ds_read_b64_tr_b16 v[50:51], v64 offset:61952
    v_mfma_f32_32x32x16_bf16 v[16:31], v[60:63], v[124:127], v[16:31]
    s_mov_b64 exec, s[38:39]
    buffer_load_dwordx4 v[108:111], v72, s[4:7], s37 offen offset:3072
    s_mov_b64 exec, -1
    ds_read_b64_tr_b16 v[52:53], v65 offset:61440
    ds_read_b64_tr_b16 v[54:55], v65 offset:61952
    s_waitcnt lgkmcnt(8)
    v_mfma_f32_32x32x16_bf16 v[0:15], v[32:35], v[128:131], v[0:15]
    ds_read_b64_tr_b16 v[56:57], v64 offset:63488
    ds_read_b64_tr_b16 v[58:59], v64 offset:64000
    v_mfma_f32_32x32x16_bf16 v[16:31], v[36:39], v[128:131], v[16:31]
    ds_read_b64_tr_b16 v[60:61], v65 offset:63488
    ds_read_b64_tr_b16 v[62:63], v65 offset:64000
    s_waitcnt lgkmcnt(8)
    v_mfma_f32_32x32x16_bf16 v[0:15], v[40:43], v[132:135], v[0:15]
    s_waitcnt vmcnt(56)
    s_barrier
    ds_read_b64_tr_b16 v[32:33], v66 offset:0
    ds_read_b64_tr_b16 v[34:35], v66 offset:512
    v_mfma_f32_32x32x16_bf16 v[16:31], v[44:47], v[132:135], v[16:31]
    s_add_u32 s30, s29, 32768
    s_mov_b32 m0, s30
    s_add_u32 s36, s54, 16
    s_and_b32 s36, s36, 31
    s_lshl_b32 s36, s36, 18
    s_add_u32 s36, s36, s26
    buffer_load_dwordx4 v68, s[8:11], s36 offen offset:0 lds
    ds_read_b64_tr_b16 v[36:37], v67 offset:0
    ds_read_b64_tr_b16 v[38:39], v67 offset:512
    s_waitcnt lgkmcnt(8)
    v_mfma_f32_32x32x16_bf16 v[0:15], v[48:51], v[136:139], v[0:15]
    buffer_load_dwordx4 v69, s[8:11], s36 offen offset:1024 lds
    ds_read_b64_tr_b16 v[40:41], v66 offset:2048
    ds_read_b64_tr_b16 v[42:43], v66 offset:2560
    v_mfma_f32_32x32x16_bf16 v[16:31], v[52:55], v[136:139], v[16:31]
    buffer_load_dwordx4 v70, s[8:11], s36 offen offset:2048 lds
    ds_read_b64_tr_b16 v[44:45], v67 offset:2048
    ds_read_b64_tr_b16 v[46:47], v67 offset:2560
    s_waitcnt lgkmcnt(8)
    v_mfma_f32_32x32x16_bf16 v[0:15], v[56:59], v[140:143], v[0:15]
    buffer_load_dwordx4 v71, s[8:11], s36 offen offset:3072 lds
    ds_read_b64_tr_b16 v[48:49], v66 offset:4096
    ds_read_b64_tr_b16 v[50:51], v66 offset:4608
    v_mfma_f32_32x32x16_bf16 v[16:31], v[60:63], v[140:143], v[16:31]
    ds_read_b64_tr_b16 v[52:53], v67 offset:4096
    ds_read_b64_tr_b16 v[54:55], v67 offset:4608
    s_waitcnt vmcnt(16)
    s_waitcnt lgkmcnt(8)
    v_mfma_f32_32x32x16_bf16 v[0:15], v[32:35], v[144:147], v[0:15]
    s_add_u32 s37, s54, 13
    s_and_b32 s37, s37, 31
    s_lshl_b32 s37, s37, 13
    s_add_u32 s37, s37, s25
    s_add_u32 s37, s37, 0
    s_mov_b64 exec, s[38:39]
    buffer_load_dwordx4 v[112:115], v72, s[4:7], s37 offen offset:0
    s_mov_b64 exec, -1
    ds_read_b64_tr_b16 v[56:57], v66 offset:6144
    ds_read_b64_tr_b16 v[58:59], v66 offset:6656
    v_mfma_f32_32x32x16_bf16 v[16:31], v[36:39], v[144:147], v[16:31]
    s_mov_b64 exec, s[38:39]
    buffer_load_dwordx4 v[116:119], v72, s[4:7], s37 offen offset:1024
    s_mov_b64 exec, -1
    ds_read_b64_tr_b16 v[60:61], v67 offset:6144
    ds_read_b64_tr_b16 v[62:63], v67 offset:6656
    s_waitcnt lgkmcnt(8)
    v_mfma_f32_32x32x16_bf16 v[0:15], v[40:43], v[148:151], v[0:15]
    s_mov_b64 exec, s[38:39]
    buffer_load_dwordx4 v[120:123], v72, s[4:7], s37 offen offset:2048
    s_mov_b64 exec, -1
    ds_read_b64_tr_b16 v[32:33], v66 offset:8192
    ds_read_b64_tr_b16 v[34:35], v66 offset:8704
    v_mfma_f32_32x32x16_bf16 v[16:31], v[44:47], v[148:151], v[16:31]
    s_mov_b64 exec, s[38:39]
    buffer_load_dwordx4 v[124:127], v72, s[4:7], s37 offen offset:3072
    s_mov_b64 exec, -1
    ds_read_b64_tr_b16 v[36:37], v67 offset:8192
    ds_read_b64_tr_b16 v[38:39], v67 offset:8704
    s_waitcnt lgkmcnt(8)
    v_mfma_f32_32x32x16_bf16 v[0:15], v[48:51], v[152:155], v[0:15]
    s_add_u32 s37, s54, 13
    s_and_b32 s37, s37, 31
    s_lshl_b32 s37, s37, 13
    s_add_u32 s37, s37, s25
    s_add_u32 s37, s37, 4096
    s_mov_b64 exec, s[38:39]
    buffer_load_dwordx4 v[128:131], v72, s[4:7], s37 offen offset:0
    s_mov_b64 exec, -1
    ds_read_b64_tr_b16 v[40:41], v66 offset:10240
    ds_read_b64_tr_b16 v[42:43], v66 offset:10752
    v_mfma_f32_32x32x16_bf16 v[16:31], v[52:55], v[152:155], v[16:31]
    s_mov_b64 exec, s[38:39]
    buffer_load_dwordx4 v[132:135], v72, s[4:7], s37 offen offset:1024
    s_mov_b64 exec, -1
    ds_read_b64_tr_b16 v[44:45], v67 offset:10240
    ds_read_b64_tr_b16 v[46:47], v67 offset:10752
    s_waitcnt lgkmcnt(8)
    v_mfma_f32_32x32x16_bf16 v[0:15], v[56:59], v[156:159], v[0:15]
    s_mov_b64 exec, s[38:39]
    buffer_load_dwordx4 v[136:139], v72, s[4:7], s37 offen offset:2048
    s_mov_b64 exec, -1
    ds_read_b64_tr_b16 v[48:49], v66 offset:12288
    ds_read_b64_tr_b16 v[50:51], v66 offset:12800
    v_mfma_f32_32x32x16_bf16 v[16:31], v[60:63], v[156:159], v[16:31]
    s_mov_b64 exec, s[38:39]
    buffer_load_dwordx4 v[140:143], v72, s[4:7], s37 offen offset:3072
    s_mov_b64 exec, -1
    ds_read_b64_tr_b16 v[52:53], v67 offset:12288
    ds_read_b64_tr_b16 v[54:55], v67 offset:12800
    s_waitcnt lgkmcnt(8)
    v_mfma_f32_32x32x16_bf16 v[0:15], v[32:35], v[160:163], v[0:15]
    ds_read_b64_tr_b16 v[56:57], v66 offset:14336
    ds_read_b64_tr_b16 v[58:59], v66 offset:14848
    v_mfma_f32_32x32x16_bf16 v[16:31], v[36:39], v[160:163], v[16:31]
    ds_read_b64_tr_b16 v[60:61], v67 offset:14336
    ds_read_b64_tr_b16 v[62:63], v67 offset:14848
    s_waitcnt lgkmcnt(8)
    v_mfma_f32_32x32x16_bf16 v[0:15], v[40:43], v[164:167], v[0:15]
    s_waitcnt vmcnt(56)
    s_barrier
    ds_read_b64_tr_b16 v[32:33], v66 offset:16384
    ds_read_b64_tr_b16 v[34:35], v66 offset:16896
    v_mfma_f32_32x32x16_bf16 v[16:31], v[44:47], v[164:167], v[16:31]
    s_add_u32 s30, s29, 49152
    s_mov_b32 m0, s30
    s_add_u32 s36, s54, 17
    s_and_b32 s36, s36, 31
    s_lshl_b32 s36, s36, 18
    s_add_u32 s36, s36, s26
    buffer_load_dwordx4 v68, s[8:11], s36 offen offset:0 lds
    ds_read_b64_tr_b16 v[36:37], v67 offset:16384
    ds_read_b64_tr_b16 v[38:39], v67 offset:16896
    s_waitcnt lgkmcnt(8)
    v_mfma_f32_32x32x16_bf16 v[0:15], v[48:51], v[168:171], v[0:15]
    buffer_load_dwordx4 v69, s[8:11], s36 offen offset:1024 lds
    ds_read_b64_tr_b16 v[40:41], v66 offset:18432
    ds_read_b64_tr_b16 v[42:43], v66 offset:18944
    v_mfma_f32_32x32x16_bf16 v[16:31], v[52:55], v[168:171], v[16:31]
    buffer_load_dwordx4 v70, s[8:11], s36 offen offset:2048 lds
    ds_read_b64_tr_b16 v[44:45], v67 offset:18432
    ds_read_b64_tr_b16 v[46:47], v67 offset:18944
    s_waitcnt lgkmcnt(8)
    v_mfma_f32_32x32x16_bf16 v[0:15], v[56:59], v[172:175], v[0:15]
    buffer_load_dwordx4 v71, s[8:11], s36 offen offset:3072 lds
    ds_read_b64_tr_b16 v[48:49], v66 offset:20480
    ds_read_b64_tr_b16 v[50:51], v66 offset:20992
    v_mfma_f32_32x32x16_bf16 v[16:31], v[60:63], v[172:175], v[16:31]
    ds_read_b64_tr_b16 v[52:53], v67 offset:20480
    ds_read_b64_tr_b16 v[54:55], v67 offset:20992
    s_waitcnt vmcnt(16)
    s_waitcnt lgkmcnt(8)
    v_mfma_f32_32x32x16_bf16 v[0:15], v[32:35], v[80:83], v[0:15]
    s_add_u32 s37, s54, 14
    s_and_b32 s37, s37, 31
    s_lshl_b32 s37, s37, 13
    s_add_u32 s37, s37, s25
    s_add_u32 s37, s37, 0
    s_mov_b64 exec, s[38:39]
    buffer_load_dwordx4 v[144:147], v72, s[4:7], s37 offen offset:0
    s_mov_b64 exec, -1
    ds_read_b64_tr_b16 v[56:57], v66 offset:22528
    ds_read_b64_tr_b16 v[58:59], v66 offset:23040
    v_mfma_f32_32x32x16_bf16 v[16:31], v[36:39], v[80:83], v[16:31]
    s_mov_b64 exec, s[38:39]
    buffer_load_dwordx4 v[148:151], v72, s[4:7], s37 offen offset:1024
    s_mov_b64 exec, -1
    ds_read_b64_tr_b16 v[60:61], v67 offset:22528
    ds_read_b64_tr_b16 v[62:63], v67 offset:23040
    s_waitcnt lgkmcnt(8)
    v_mfma_f32_32x32x16_bf16 v[0:15], v[40:43], v[84:87], v[0:15]
    s_mov_b64 exec, s[38:39]
    buffer_load_dwordx4 v[152:155], v72, s[4:7], s37 offen offset:2048
    s_mov_b64 exec, -1
    ds_read_b64_tr_b16 v[32:33], v66 offset:24576
    ds_read_b64_tr_b16 v[34:35], v66 offset:25088
    v_mfma_f32_32x32x16_bf16 v[16:31], v[44:47], v[84:87], v[16:31]
    s_mov_b64 exec, s[38:39]
    buffer_load_dwordx4 v[156:159], v72, s[4:7], s37 offen offset:3072
    s_mov_b64 exec, -1
    ds_read_b64_tr_b16 v[36:37], v67 offset:24576
    ds_read_b64_tr_b16 v[38:39], v67 offset:25088
    s_waitcnt lgkmcnt(8)
    v_mfma_f32_32x32x16_bf16 v[0:15], v[48:51], v[88:91], v[0:15]
    s_add_u32 s37, s54, 14
    s_and_b32 s37, s37, 31
    s_lshl_b32 s37, s37, 13
    s_add_u32 s37, s37, s25
    s_add_u32 s37, s37, 4096
    s_mov_b64 exec, s[38:39]
    buffer_load_dwordx4 v[160:163], v72, s[4:7], s37 offen offset:0
    s_mov_b64 exec, -1
    ds_read_b64_tr_b16 v[40:41], v66 offset:26624
    ds_read_b64_tr_b16 v[42:43], v66 offset:27136
    v_mfma_f32_32x32x16_bf16 v[16:31], v[52:55], v[88:91], v[16:31]
    s_mov_b64 exec, s[38:39]
    buffer_load_dwordx4 v[164:167], v72, s[4:7], s37 offen offset:1024
    s_mov_b64 exec, -1
    ds_read_b64_tr_b16 v[44:45], v67 offset:26624
    ds_read_b64_tr_b16 v[46:47], v67 offset:27136
    s_waitcnt lgkmcnt(8)
    v_mfma_f32_32x32x16_bf16 v[0:15], v[56:59], v[92:95], v[0:15]
    s_mov_b64 exec, s[38:39]
    buffer_load_dwordx4 v[168:171], v72, s[4:7], s37 offen offset:2048
    s_mov_b64 exec, -1
    ds_read_b64_tr_b16 v[48:49], v66 offset:28672
    ds_read_b64_tr_b16 v[50:51], v66 offset:29184
    v_mfma_f32_32x32x16_bf16 v[16:31], v[60:63], v[92:95], v[16:31]
    s_mov_b64 exec, s[38:39]
    buffer_load_dwordx4 v[172:175], v72, s[4:7], s37 offen offset:3072
    s_mov_b64 exec, -1
    ds_read_b64_tr_b16 v[52:53], v67 offset:28672
    ds_read_b64_tr_b16 v[54:55], v67 offset:29184
    s_waitcnt lgkmcnt(8)
    v_mfma_f32_32x32x16_bf16 v[0:15], v[32:35], v[96:99], v[0:15]
    ds_read_b64_tr_b16 v[56:57], v66 offset:30720
    ds_read_b64_tr_b16 v[58:59], v66 offset:31232
    v_mfma_f32_32x32x16_bf16 v[16:31], v[36:39], v[96:99], v[16:31]
    ds_read_b64_tr_b16 v[60:61], v67 offset:30720
    ds_read_b64_tr_b16 v[62:63], v67 offset:31232
    s_waitcnt lgkmcnt(8)
    v_mfma_f32_32x32x16_bf16 v[0:15], v[40:43], v[100:103], v[0:15]
    s_waitcnt vmcnt(56)
    s_barrier
    ds_read_b64_tr_b16 v[32:33], v66 offset:32768
    ds_read_b64_tr_b16 v[34:35], v66 offset:33280
    v_mfma_f32_32x32x16_bf16 v[16:31], v[44:47], v[100:103], v[16:31]
    s_add_u32 s30, s29, 65536
    s_mov_b32 m0, s30
    s_add_u32 s36, s54, 18
    s_and_b32 s36, s36, 31
    s_lshl_b32 s36, s36, 18
    s_add_u32 s36, s36, s26
    buffer_load_dwordx4 v68, s[8:11], s36 offen offset:0 lds
    ds_read_b64_tr_b16 v[36:37], v67 offset:32768
    ds_read_b64_tr_b16 v[38:39], v67 offset:33280
    s_waitcnt lgkmcnt(8)
    v_mfma_f32_32x32x16_bf16 v[0:15], v[48:51], v[104:107], v[0:15]
    buffer_load_dwordx4 v69, s[8:11], s36 offen offset:1024 lds
    ds_read_b64_tr_b16 v[40:41], v66 offset:34816
    ds_read_b64_tr_b16 v[42:43], v66 offset:35328
    v_mfma_f32_32x32x16_bf16 v[16:31], v[52:55], v[104:107], v[16:31]
    buffer_load_dwordx4 v70, s[8:11], s36 offen offset:2048 lds
    ds_read_b64_tr_b16 v[44:45], v67 offset:34816
    ds_read_b64_tr_b16 v[46:47], v67 offset:35328
    s_waitcnt lgkmcnt(8)
    v_mfma_f32_32x32x16_bf16 v[0:15], v[56:59], v[108:111], v[0:15]
    buffer_load_dwordx4 v71, s[8:11], s36 offen offset:3072 lds
    ds_read_b64_tr_b16 v[48:49], v66 offset:36864
    ds_read_b64_tr_b16 v[50:51], v66 offset:37376
    v_mfma_f32_32x32x16_bf16 v[16:31], v[60:63], v[108:111], v[16:31]
    ds_read_b64_tr_b16 v[52:53], v67 offset:36864
    ds_read_b64_tr_b16 v[54:55], v67 offset:37376
    s_waitcnt vmcnt(16)
    s_waitcnt lgkmcnt(8)
    v_mfma_f32_32x32x16_bf16 v[0:15], v[32:35], v[112:115], v[0:15]
    s_add_u32 s37, s54, 15
    s_and_b32 s37, s37, 31
    s_lshl_b32 s37, s37, 13
    s_add_u32 s37, s37, s25
    s_add_u32 s37, s37, 0
    s_mov_b64 exec, s[38:39]
    buffer_load_dwordx4 v[80:83], v72, s[4:7], s37 offen offset:0
    s_mov_b64 exec, -1
    ds_read_b64_tr_b16 v[56:57], v66 offset:38912
    ds_read_b64_tr_b16 v[58:59], v66 offset:39424
    v_mfma_f32_32x32x16_bf16 v[16:31], v[36:39], v[112:115], v[16:31]
    s_mov_b64 exec, s[38:39]
    buffer_load_dwordx4 v[84:87], v72, s[4:7], s37 offen offset:1024
    s_mov_b64 exec, -1
    ds_read_b64_tr_b16 v[60:61], v67 offset:38912
    ds_read_b64_tr_b16 v[62:63], v67 offset:39424
    s_waitcnt lgkmcnt(8)
    v_mfma_f32_32x32x16_bf16 v[0:15], v[40:43], v[116:119], v[0:15]
    s_mov_b64 exec, s[38:39]
    buffer_load_dwordx4 v[88:91], v72, s[4:7], s37 offen offset:2048
    s_mov_b64 exec, -1
    ds_read_b64_tr_b16 v[32:33], v66 offset:40960
    ds_read_b64_tr_b16 v[34:35], v66 offset:41472
    v_mfma_f32_32x32x16_bf16 v[16:31], v[44:47], v[116:119], v[16:31]
    s_mov_b64 exec, s[38:39]
    buffer_load_dwordx4 v[92:95], v72, s[4:7], s37 offen offset:3072
    s_mov_b64 exec, -1
    ds_read_b64_tr_b16 v[36:37], v67 offset:40960
    ds_read_b64_tr_b16 v[38:39], v67 offset:41472
    s_waitcnt lgkmcnt(8)
    v_mfma_f32_32x32x16_bf16 v[0:15], v[48:51], v[120:123], v[0:15]
    s_add_u32 s37, s54, 15
    s_and_b32 s37, s37, 31
    s_lshl_b32 s37, s37, 13
    s_add_u32 s37, s37, s25
    s_add_u32 s37, s37, 4096
    s_mov_b64 exec, s[38:39]
    buffer_load_dwordx4 v[96:99], v72, s[4:7], s37 offen offset:0
    s_mov_b64 exec, -1
    ds_read_b64_tr_b16 v[40:41], v66 offset:43008
    ds_read_b64_tr_b16 v[42:43], v66 offset:43520
    v_mfma_f32_32x32x16_bf16 v[16:31], v[52:55], v[120:123], v[16:31]
    s_mov_b64 exec, s[38:39]
    buffer_load_dwordx4 v[100:103], v72, s[4:7], s37 offen offset:1024
    s_mov_b64 exec, -1
    ds_read_b64_tr_b16 v[44:45], v67 offset:43008
    ds_read_b64_tr_b16 v[46:47], v67 offset:43520
    s_waitcnt lgkmcnt(8)
    v_mfma_f32_32x32x16_bf16 v[0:15], v[56:59], v[124:127], v[0:15]
    s_mov_b64 exec, s[38:39]
    buffer_load_dwordx4 v[104:107], v72, s[4:7], s37 offen offset:2048
    s_mov_b64 exec, -1
    ds_read_b64_tr_b16 v[48:49], v66 offset:45056
    ds_read_b64_tr_b16 v[50:51], v66 offset:45568
    v_mfma_f32_32x32x16_bf16 v[16:31], v[60:63], v[124:127], v[16:31]
    s_mov_b64 exec, s[38:39]
    buffer_load_dwordx4 v[108:111], v72, s[4:7], s37 offen offset:3072
    s_mov_b64 exec, -1
    ds_read_b64_tr_b16 v[52:53], v67 offset:45056
    ds_read_b64_tr_b16 v[54:55], v67 offset:45568
    s_waitcnt lgkmcnt(8)
    v_mfma_f32_32x32x16_bf16 v[0:15], v[32:35], v[128:131], v[0:15]
    ds_read_b64_tr_b16 v[56:57], v66 offset:47104
    ds_read_b64_tr_b16 v[58:59], v66 offset:47616
    v_mfma_f32_32x32x16_bf16 v[16:31], v[36:39], v[128:131], v[16:31]
    ds_read_b64_tr_b16 v[60:61], v67 offset:47104
    ds_read_b64_tr_b16 v[62:63], v67 offset:47616
    s_waitcnt lgkmcnt(8)
    v_mfma_f32_32x32x16_bf16 v[0:15], v[40:43], v[132:135], v[0:15]
    s_waitcnt vmcnt(56)
    s_barrier
    ds_read_b64_tr_b16 v[32:33], v64 offset:0
    ds_read_b64_tr_b16 v[34:35], v64 offset:512
    v_mfma_f32_32x32x16_bf16 v[16:31], v[44:47], v[132:135], v[16:31]
    s_add_u32 s30, s29, 81920
    s_mov_b32 m0, s30
    s_add_u32 s36, s54, 19
    s_and_b32 s36, s36, 31
    s_lshl_b32 s36, s36, 18
    s_add_u32 s36, s36, s26
    buffer_load_dwordx4 v68, s[8:11], s36 offen offset:0 lds
    ds_read_b64_tr_b16 v[36:37], v65 offset:0
    ds_read_b64_tr_b16 v[38:39], v65 offset:512
    s_waitcnt lgkmcnt(8)
    v_mfma_f32_32x32x16_bf16 v[0:15], v[48:51], v[136:139], v[0:15]
    buffer_load_dwordx4 v69, s[8:11], s36 offen offset:1024 lds
    ds_read_b64_tr_b16 v[40:41], v64 offset:2048
    ds_read_b64_tr_b16 v[42:43], v64 offset:2560
    v_mfma_f32_32x32x16_bf16 v[16:31], v[52:55], v[136:139], v[16:31]
    buffer_load_dwordx4 v70, s[8:11], s36 offen offset:2048 lds
    ds_read_b64_tr_b16 v[44:45], v65 offset:2048
    ds_read_b64_tr_b16 v[46:47], v65 offset:2560
    s_waitcnt lgkmcnt(8)
    v_mfma_f32_32x32x16_bf16 v[0:15], v[56:59], v[140:143], v[0:15]
    buffer_load_dwordx4 v71, s[8:11], s36 offen offset:3072 lds
    ds_read_b64_tr_b16 v[48:49], v64 offset:4096
    ds_read_b64_tr_b16 v[50:51], v64 offset:4608
    v_mfma_f32_32x32x16_bf16 v[16:31], v[60:63], v[140:143], v[16:31]
    ds_read_b64_tr_b16 v[52:53], v65 offset:4096
    ds_read_b64_tr_b16 v[54:55], v65 offset:4608
    s_waitcnt vmcnt(16)
    s_waitcnt lgkmcnt(8)
    v_mfma_f32_32x32x16_bf16 v[0:15], v[32:35], v[144:147], v[0:15]
    s_add_u32 s37, s54, 16
    s_and_b32 s37, s37, 31
    s_lshl_b32 s37, s37, 13
    s_add_u32 s37, s37, s25
    s_add_u32 s37, s37, 0
    s_mov_b64 exec, s[38:39]
    buffer_load_dwordx4 v[112:115], v72, s[4:7], s37 offen offset:0
    s_mov_b64 exec, -1
    ds_read_b64_tr_b16 v[56:57], v64 offset:6144
    ds_read_b64_tr_b16 v[58:59], v64 offset:6656
    v_mfma_f32_32x32x16_bf16 v[16:31], v[36:39], v[144:147], v[16:31]
    s_mov_b64 exec, s[38:39]
    buffer_load_dwordx4 v[116:119], v72, s[4:7], s37 offen offset:1024
    s_mov_b64 exec, -1
    ds_read_b64_tr_b16 v[60:61], v65 offset:6144
    ds_read_b64_tr_b16 v[62:63], v65 offset:6656
    s_waitcnt lgkmcnt(8)
    v_mfma_f32_32x32x16_bf16 v[0:15], v[40:43], v[148:151], v[0:15]
    s_mov_b64 exec, s[38:39]
    buffer_load_dwordx4 v[120:123], v72, s[4:7], s37 offen offset:2048
    s_mov_b64 exec, -1
    ds_read_b64_tr_b16 v[32:33], v64 offset:8192
    ds_read_b64_tr_b16 v[34:35], v64 offset:8704
    v_mfma_f32_32x32x16_bf16 v[16:31], v[44:47], v[148:151], v[16:31]
    s_mov_b64 exec, s[38:39]
    buffer_load_dwordx4 v[124:127], v72, s[4:7], s37 offen offset:3072
    s_mov_b64 exec, -1
    ds_read_b64_tr_b16 v[36:37], v65 offset:8192
    ds_read_b64_tr_b16 v[38:39], v65 offset:8704
    s_waitcnt lgkmcnt(8)
    v_mfma_f32_32x32x16_bf16 v[0:15], v[48:51], v[152:155], v[0:15]
    s_add_u32 s37, s54, 16
    s_and_b32 s37, s37, 31
    s_lshl_b32 s37, s37, 13
    s_add_u32 s37, s37, s25
    s_add_u32 s37, s37, 4096
    s_mov_b64 exec, s[38:39]
    buffer_load_dwordx4 v[128:131], v72, s[4:7], s37 offen offset:0
    s_mov_b64 exec, -1
    ds_read_b64_tr_b16 v[40:41], v64 offset:10240
    ds_read_b64_tr_b16 v[42:43], v64 offset:10752
    v_mfma_f32_32x32x16_bf16 v[16:31], v[52:55], v[152:155], v[16:31]
    s_mov_b64 exec, s[38:39]
    buffer_load_dwordx4 v[132:135], v72, s[4:7], s37 offen offset:1024
    s_mov_b64 exec, -1
    ds_read_b64_tr_b16 v[44:45], v65 offset:10240
    ds_read_b64_tr_b16 v[46:47], v65 offset:10752
    s_waitcnt lgkmcnt(8)
    v_mfma_f32_32x32x16_bf16 v[0:15], v[56:59], v[156:159], v[0:15]
    s_mov_b64 exec, s[38:39]
    buffer_load_dwordx4 v[136:139], v72, s[4:7], s37 offen offset:2048
    s_mov_b64 exec, -1
    ds_read_b64_tr_b16 v[48:49], v64 offset:12288
    ds_read_b64_tr_b16 v[50:51], v64 offset:12800
    v_mfma_f32_32x32x16_bf16 v[16:31], v[60:63], v[156:159], v[16:31]
    s_mov_b64 exec, s[38:39]
    buffer_load_dwordx4 v[140:143], v72, s[4:7], s37 offen offset:3072
    s_mov_b64 exec, -1
    ds_read_b64_tr_b16 v[52:53], v65 offset:12288
    ds_read_b64_tr_b16 v[54:55], v65 offset:12800
    s_waitcnt lgkmcnt(8)
    v_mfma_f32_32x32x16_bf16 v[0:15], v[32:35], v[160:163], v[0:15]
    ds_read_b64_tr_b16 v[56:57], v64 offset:14336
    ds_read_b64_tr_b16 v[58:59], v64 offset:14848
    v_mfma_f32_32x32x16_bf16 v[16:31], v[36:39], v[160:163], v[16:31]
    ds_read_b64_tr_b16 v[60:61], v65 offset:14336
    ds_read_b64_tr_b16 v[62:63], v65 offset:14848
    s_waitcnt lgkmcnt(8)
    v_mfma_f32_32x32x16_bf16 v[0:15], v[40:43], v[164:167], v[0:15]
    s_waitcnt vmcnt(56)
    s_barrier
    ds_read_b64_tr_b16 v[32:33], v64 offset:16384
    ds_read_b64_tr_b16 v[34:35], v64 offset:16896
    v_mfma_f32_32x32x16_bf16 v[16:31], v[44:47], v[164:167], v[16:31]
    s_add_u32 s30, s29, 98304
    s_mov_b32 m0, s30
    s_add_u32 s36, s54, 20
    s_and_b32 s36, s36, 31
    s_lshl_b32 s36, s36, 18
    s_add_u32 s36, s36, s26
    buffer_load_dwordx4 v68, s[8:11], s36 offen offset:0 lds
    ds_read_b64_tr_b16 v[36:37], v65 offset:16384
    ds_read_b64_tr_b16 v[38:39], v65 offset:16896
    s_waitcnt lgkmcnt(8)
    v_mfma_f32_32x32x16_bf16 v[0:15], v[48:51], v[168:171], v[0:15]
    buffer_load_dwordx4 v69, s[8:11], s36 offen offset:1024 lds
    ds_read_b64_tr_b16 v[40:41], v64 offset:18432
    ds_read_b64_tr_b16 v[42:43], v64 offset:18944
    v_mfma_f32_32x32x16_bf16 v[16:31], v[52:55], v[168:171], v[16:31]
    buffer_load_dwordx4 v70, s[8:11], s36 offen offset:2048 lds
    ds_read_b64_tr_b16 v[44:45], v65 offset:18432
    ds_read_b64_tr_b16 v[46:47], v65 offset:18944
    s_waitcnt lgkmcnt(8)
    v_mfma_f32_32x32x16_bf16 v[0:15], v[56:59], v[172:175], v[0:15]
    buffer_load_dwordx4 v71, s[8:11], s36 offen offset:3072 lds
    ds_read_b64_tr_b16 v[48:49], v64 offset:20480
    ds_read_b64_tr_b16 v[50:51], v64 offset:20992
    v_mfma_f32_32x32x16_bf16 v[16:31], v[60:63], v[172:175], v[16:31]
    ds_read_b64_tr_b16 v[52:53], v65 offset:20480
    ds_read_b64_tr_b16 v[54:55], v65 offset:20992
    s_waitcnt vmcnt(16)
    s_waitcnt lgkmcnt(8)
    v_mfma_f32_32x32x16_bf16 v[0:15], v[32:35], v[80:83], v[0:15]
    s_add_u32 s37, s54, 17
    s_and_b32 s37, s37, 31
    s_lshl_b32 s37, s37, 13
    s_add_u32 s37, s37, s25
    s_add_u32 s37, s37, 0
    s_mov_b64 exec, s[38:39]
    buffer_load_dwordx4 v[144:147], v72, s[4:7], s37 offen offset:0
    s_mov_b64 exec, -1
    ds_read_b64_tr_b16 v[56:57], v64 offset:22528
    ds_read_b64_tr_b16 v[58:59], v64 offset:23040
    v_mfma_f32_32x32x16_bf16 v[16:31], v[36:39], v[80:83], v[16:31]
    s_mov_b64 exec, s[38:39]
    buffer_load_dwordx4 v[148:151], v72, s[4:7], s37 offen offset:1024
    s_mov_b64 exec, -1
    ds_read_b64_tr_b16 v[60:61], v65 offset:22528
    ds_read_b64_tr_b16 v[62:63], v65 offset:23040
    s_waitcnt lgkmcnt(8)
    v_mfma_f32_32x32x16_bf16 v[0:15], v[40:43], v[84:87], v[0:15]
    s_mov_b64 exec, s[38:39]
    buffer_load_dwordx4 v[152:155], v72, s[4:7], s37 offen offset:2048
    s_mov_b64 exec, -1
    ds_read_b64_tr_b16 v[32:33], v64 offset:24576
    ds_read_b64_tr_b16 v[34:35], v64 offset:25088
    v_mfma_f32_32x32x16_bf16 v[16:31], v[44:47], v[84:87], v[16:31]
    s_mov_b64 exec, s[38:39]
    buffer_load_dwordx4 v[156:159], v72, s[4:7], s37 offen offset:3072
    s_mov_b64 exec, -1
    ds_read_b64_tr_b16 v[36:37], v65 offset:24576
    ds_read_b64_tr_b16 v[38:39], v65 offset:25088
    s_waitcnt lgkmcnt(8)
    v_mfma_f32_32x32x16_bf16 v[0:15], v[48:51], v[88:91], v[0:15]
    s_add_u32 s37, s54, 17
    s_and_b32 s37, s37, 31
    s_lshl_b32 s37, s37, 13
    s_add_u32 s37, s37, s25
    s_add_u32 s37, s37, 4096
    s_mov_b64 exec, s[38:39]
    buffer_load_dwordx4 v[160:163], v72, s[4:7], s37 offen offset:0
    s_mov_b64 exec, -1
    ds_read_b64_tr_b16 v[40:41], v64 offset:26624
    ds_read_b64_tr_b16 v[42:43], v64 offset:27136
    v_mfma_f32_32x32x16_bf16 v[16:31], v[52:55], v[88:91], v[16:31]
    s_mov_b64 exec, s[38:39]
    buffer_load_dwordx4 v[164:167], v72, s[4:7], s37 offen offset:1024
    s_mov_b64 exec, -1
    ds_read_b64_tr_b16 v[44:45], v65 offset:26624
    ds_read_b64_tr_b16 v[46:47], v65 offset:27136
    s_waitcnt lgkmcnt(8)
    v_mfma_f32_32x32x16_bf16 v[0:15], v[56:59], v[92:95], v[0:15]
    s_mov_b64 exec, s[38:39]
    buffer_load_dwordx4 v[168:171], v72, s[4:7], s37 offen offset:2048
    s_mov_b64 exec, -1
    ds_read_b64_tr_b16 v[48:49], v64 offset:28672
    ds_read_b64_tr_b16 v[50:51], v64 offset:29184
    v_mfma_f32_32x32x16_bf16 v[16:31], v[60:63], v[92:95], v[16:31]
    s_mov_b64 exec, s[38:39]
    buffer_load_dwordx4 v[172:175], v72, s[4:7], s37 offen offset:3072
    s_mov_b64 exec, -1
    ds_read_b64_tr_b16 v[52:53], v65 offset:28672
    ds_read_b64_tr_b16 v[54:55], v65 offset:29184
    s_waitcnt lgkmcnt(8)
    v_mfma_f32_32x32x16_bf16 v[0:15], v[32:35], v[96:99], v[0:15]
    ds_read_b64_tr_b16 v[56:57], v64 offset:30720
    ds_read_b64_tr_b16 v[58:59], v64 offset:31232
    v_mfma_f32_32x32x16_bf16 v[16:31], v[36:39], v[96:99], v[16:31]
    ds_read_b64_tr_b16 v[60:61], v65 offset:30720
    ds_read_b64_tr_b16 v[62:63], v65 offset:31232
    s_waitcnt lgkmcnt(8)
    v_mfma_f32_32x32x16_bf16 v[0:15], v[40:43], v[100:103], v[0:15]
    s_waitcnt vmcnt(56)
    s_barrier
    ds_read_b64_tr_b16 v[32:33], v64 offset:32768
    ds_read_b64_tr_b16 v[34:35], v64 offset:33280
    v_mfma_f32_32x32x16_bf16 v[16:31], v[44:47], v[100:103], v[16:31]
    s_add_u32 s30, s29, 0
    s_mov_b32 m0, s30
    s_add_u32 s36, s54, 21
    s_and_b32 s36, s36, 31
    s_lshl_b32 s36, s36, 18
    s_add_u32 s36, s36, s26
    buffer_load_dwordx4 v68, s[8:11], s36 offen offset:0 lds
    ds_read_b64_tr_b16 v[36:37], v65 offset:32768
    ds_read_b64_tr_b16 v[38:39], v65 offset:33280
    s_waitcnt lgkmcnt(8)
    v_mfma_f32_32x32x16_bf16 v[0:15], v[48:51], v[104:107], v[0:15]
    buffer_load_dwordx4 v69, s[8:11], s36 offen offset:1024 lds
    ds_read_b64_tr_b16 v[40:41], v64 offset:34816
    ds_read_b64_tr_b16 v[42:43], v64 offset:35328
    v_mfma_f32_32x32x16_bf16 v[16:31], v[52:55], v[104:107], v[16:31]
    buffer_load_dwordx4 v70, s[8:11], s36 offen offset:2048 lds
    ds_read_b64_tr_b16 v[44:45], v65 offset:34816
    ds_read_b64_tr_b16 v[46:47], v65 offset:35328
    s_waitcnt lgkmcnt(8)
    v_mfma_f32_32x32x16_bf16 v[0:15], v[56:59], v[108:111], v[0:15]
    buffer_load_dwordx4 v71, s[8:11], s36 offen offset:3072 lds
    ds_read_b64_tr_b16 v[48:49], v64 offset:36864
    ds_read_b64_tr_b16 v[50:51], v64 offset:37376
    v_mfma_f32_32x32x16_bf16 v[16:31], v[60:63], v[108:111], v[16:31]
    ds_read_b64_tr_b16 v[52:53], v65 offset:36864
    ds_read_b64_tr_b16 v[54:55], v65 offset:37376
    s_waitcnt vmcnt(16)
    s_waitcnt lgkmcnt(8)
    v_mfma_f32_32x32x16_bf16 v[0:15], v[32:35], v[112:115], v[0:15]
    s_add_u32 s37, s54, 18
    s_and_b32 s37, s37, 31
    s_lshl_b32 s37, s37, 13
    s_add_u32 s37, s37, s25
    s_add_u32 s37, s37, 0
    s_mov_b64 exec, s[38:39]
    buffer_load_dwordx4 v[80:83], v72, s[4:7], s37 offen offset:0
    s_mov_b64 exec, -1
    ds_read_b64_tr_b16 v[56:57], v64 offset:38912
    ds_read_b64_tr_b16 v[58:59], v64 offset:39424
    v_mfma_f32_32x32x16_bf16 v[16:31], v[36:39], v[112:115], v[16:31]
    s_mov_b64 exec, s[38:39]
    buffer_load_dwordx4 v[84:87], v72, s[4:7], s37 offen offset:1024
    s_mov_b64 exec, -1
    ds_read_b64_tr_b16 v[60:61], v65 offset:38912
    ds_read_b64_tr_b16 v[62:63], v65 offset:39424
    s_waitcnt lgkmcnt(8)
    v_mfma_f32_32x32x16_bf16 v[0:15], v[40:43], v[116:119], v[0:15]
    s_mov_b64 exec, s[38:39]
    buffer_load_dwordx4 v[88:91], v72, s[4:7], s37 offen offset:2048
    s_mov_b64 exec, -1
    ds_read_b64_tr_b16 v[32:33], v64 offset:40960
    ds_read_b64_tr_b16 v[34:35], v64 offset:41472
    v_mfma_f32_32x32x16_bf16 v[16:31], v[44:47], v[116:119], v[16:31]
    s_mov_b64 exec, s[38:39]
    buffer_load_dwordx4 v[92:95], v72, s[4:7], s37 offen offset:3072
    s_mov_b64 exec, -1
    ds_read_b64_tr_b16 v[36:37], v65 offset:40960
    ds_read_b64_tr_b16 v[38:39], v65 offset:41472
    s_waitcnt lgkmcnt(8)
    v_mfma_f32_32x32x16_bf16 v[0:15], v[48:51], v[120:123], v[0:15]
    s_add_u32 s37, s54, 18
    s_and_b32 s37, s37, 31
    s_lshl_b32 s37, s37, 13
    s_add_u32 s37, s37, s25
    s_add_u32 s37, s37, 4096
    s_mov_b64 exec, s[38:39]
    buffer_load_dwordx4 v[96:99], v72, s[4:7], s37 offen offset:0
    s_mov_b64 exec, -1
    ds_read_b64_tr_b16 v[40:41], v64 offset:43008
    ds_read_b64_tr_b16 v[42:43], v64 offset:43520
    v_mfma_f32_32x32x16_bf16 v[16:31], v[52:55], v[120:123], v[16:31]
    s_mov_b64 exec, s[38:39]
    buffer_load_dwordx4 v[100:103], v72, s[4:7], s37 offen offset:1024
    s_mov_b64 exec, -1
    ds_read_b64_tr_b16 v[44:45], v65 offset:43008
    ds_read_b64_tr_b16 v[46:47], v65 offset:43520
    s_waitcnt lgkmcnt(8)
    v_mfma_f32_32x32x16_bf16 v[0:15], v[56:59], v[124:127], v[0:15]
    s_mov_b64 exec, s[38:39]
    buffer_load_dwordx4 v[104:107], v72, s[4:7], s37 offen offset:2048
    s_mov_b64 exec, -1
    ds_read_b64_tr_b16 v[48:49], v64 offset:45056
    ds_read_b64_tr_b16 v[50:51], v64 offset:45568
    v_mfma_f32_32x32x16_bf16 v[16:31], v[60:63], v[124:127], v[16:31]
    s_mov_b64 exec, s[38:39]
    buffer_load_dwordx4 v[108:111], v72, s[4:7], s37 offen offset:3072
    s_mov_b64 exec, -1
    ds_read_b64_tr_b16 v[52:53], v65 offset:45056
    ds_read_b64_tr_b16 v[54:55], v65 offset:45568
    s_waitcnt lgkmcnt(8)
    v_mfma_f32_32x32x16_bf16 v[0:15], v[32:35], v[128:131], v[0:15]
    ds_read_b64_tr_b16 v[56:57], v64 offset:47104
    ds_read_b64_tr_b16 v[58:59], v64 offset:47616
    v_mfma_f32_32x32x16_bf16 v[16:31], v[36:39], v[128:131], v[16:31]
    ds_read_b64_tr_b16 v[60:61], v65 offset:47104
    ds_read_b64_tr_b16 v[62:63], v65 offset:47616
    s_waitcnt lgkmcnt(8)
    v_mfma_f32_32x32x16_bf16 v[0:15], v[40:43], v[132:135], v[0:15]
    s_waitcnt vmcnt(56)
    s_barrier
    ds_read_b64_tr_b16 v[32:33], v64 offset:49152
    ds_read_b64_tr_b16 v[34:35], v64 offset:49664
    v_mfma_f32_32x32x16_bf16 v[16:31], v[44:47], v[132:135], v[16:31]
    s_add_u32 s30, s29, 16384
    s_mov_b32 m0, s30
    s_add_u32 s36, s54, 22
    s_and_b32 s36, s36, 31
    s_lshl_b32 s36, s36, 18
    s_add_u32 s36, s36, s26
    buffer_load_dwordx4 v68, s[8:11], s36 offen offset:0 lds
    ds_read_b64_tr_b16 v[36:37], v65 offset:49152
    ds_read_b64_tr_b16 v[38:39], v65 offset:49664
    s_waitcnt lgkmcnt(8)
    v_mfma_f32_32x32x16_bf16 v[0:15], v[48:51], v[136:139], v[0:15]
    buffer_load_dwordx4 v69, s[8:11], s36 offen offset:1024 lds
    ds_read_b64_tr_b16 v[40:41], v64 offset:51200
    ds_read_b64_tr_b16 v[42:43], v64 offset:51712
    v_mfma_f32_32x32x16_bf16 v[16:31], v[52:55], v[136:139], v[16:31]
    buffer_load_dwordx4 v70, s[8:11], s36 offen offset:2048 lds
    ds_read_b64_tr_b16 v[44:45], v65 offset:51200
    ds_read_b64_tr_b16 v[46:47], v65 offset:51712
    s_waitcnt lgkmcnt(8)
    v_mfma_f32_32x32x16_bf16 v[0:15], v[56:59], v[140:143], v[0:15]
    buffer_load_dwordx4 v71, s[8:11], s36 offen offset:3072 lds
    ds_read_b64_tr_b16 v[48:49], v64 offset:53248
    ds_read_b64_tr_b16 v[50:51], v64 offset:53760
    v_mfma_f32_32x32x16_bf16 v[16:31], v[60:63], v[140:143], v[16:31]
    ds_read_b64_tr_b16 v[52:53], v65 offset:53248
    ds_read_b64_tr_b16 v[54:55], v65 offset:53760
    s_waitcnt vmcnt(16)
    s_waitcnt lgkmcnt(8)
    v_mfma_f32_32x32x16_bf16 v[0:15], v[32:35], v[144:147], v[0:15]
    s_add_u32 s37, s54, 19
    s_and_b32 s37, s37, 31
    s_lshl_b32 s37, s37, 13
    s_add_u32 s37, s37, s25
    s_add_u32 s37, s37, 0
    s_mov_b64 exec, s[38:39]
    buffer_load_dwordx4 v[112:115], v72, s[4:7], s37 offen offset:0
    s_mov_b64 exec, -1
    ds_read_b64_tr_b16 v[56:57], v64 offset:55296
    ds_read_b64_tr_b16 v[58:59], v64 offset:55808
    v_mfma_f32_32x32x16_bf16 v[16:31], v[36:39], v[144:147], v[16:31]
    s_mov_b64 exec, s[38:39]
    buffer_load_dwordx4 v[116:119], v72, s[4:7], s37 offen offset:1024
    s_mov_b64 exec, -1
    ds_read_b64_tr_b16 v[60:61], v65 offset:55296
    ds_read_b64_tr_b16 v[62:63], v65 offset:55808
    s_waitcnt lgkmcnt(8)
    v_mfma_f32_32x32x16_bf16 v[0:15], v[40:43], v[148:151], v[0:15]
    s_mov_b64 exec, s[38:39]
    buffer_load_dwordx4 v[120:123], v72, s[4:7], s37 offen offset:2048
    s_mov_b64 exec, -1
    ds_read_b64_tr_b16 v[32:33], v64 offset:57344
    ds_read_b64_tr_b16 v[34:35], v64 offset:57856
    v_mfma_f32_32x32x16_bf16 v[16:31], v[44:47], v[148:151], v[16:31]
    s_mov_b64 exec, s[38:39]
    buffer_load_dwordx4 v[124:127], v72, s[4:7], s37 offen offset:3072
    s_mov_b64 exec, -1
    ds_read_b64_tr_b16 v[36:37], v65 offset:57344
    ds_read_b64_tr_b16 v[38:39], v65 offset:57856
    s_waitcnt lgkmcnt(8)
    v_mfma_f32_32x32x16_bf16 v[0:15], v[48:51], v[152:155], v[0:15]
    s_add_u32 s37, s54, 19
    s_and_b32 s37, s37, 31
    s_lshl_b32 s37, s37, 13
    s_add_u32 s37, s37, s25
    s_add_u32 s37, s37, 4096
    s_mov_b64 exec, s[38:39]
    buffer_load_dwordx4 v[128:131], v72, s[4:7], s37 offen offset:0
    s_mov_b64 exec, -1
    ds_read_b64_tr_b16 v[40:41], v64 offset:59392
    ds_read_b64_tr_b16 v[42:43], v64 offset:59904
    v_mfma_f32_32x32x16_bf16 v[16:31], v[52:55], v[152:155], v[16:31]
    s_mov_b64 exec, s[38:39]
    buffer_load_dwordx4 v[132:135], v72, s[4:7], s37 offen offset:1024
    s_mov_b64 exec, -1
    ds_read_b64_tr_b16 v[44:45], v65 offset:59392
    ds_read_b64_tr_b16 v[46:47], v65 offset:59904
    s_waitcnt lgkmcnt(8)
    v_mfma_f32_32x32x16_bf16 v[0:15], v[56:59], v[156:159], v[0:15]
    s_mov_b64 exec, s[38:39]
    buffer_load_dwordx4 v[136:139], v72, s[4:7], s37 offen offset:2048
    s_mov_b64 exec, -1
    ds_read_b64_tr_b16 v[48:49], v64 offset:61440
    ds_read_b64_tr_b16 v[50:51], v64 offset:61952
    v_mfma_f32_32x32x16_bf16 v[16:31], v[60:63], v[156:159], v[16:31]
    s_mov_b64 exec, s[38:39]
    buffer_load_dwordx4 v[140:143], v72, s[4:7], s37 offen offset:3072
    s_mov_b64 exec, -1
    ds_read_b64_tr_b16 v[52:53], v65 offset:61440
    ds_read_b64_tr_b16 v[54:55], v65 offset:61952
    s_waitcnt lgkmcnt(8)
    v_mfma_f32_32x32x16_bf16 v[0:15], v[32:35], v[160:163], v[0:15]
    ds_read_b64_tr_b16 v[56:57], v64 offset:63488
    ds_read_b64_tr_b16 v[58:59], v64 offset:64000
    v_mfma_f32_32x32x16_bf16 v[16:31], v[36:39], v[160:163], v[16:31]
    ds_read_b64_tr_b16 v[60:61], v65 offset:63488
    ds_read_b64_tr_b16 v[62:63], v65 offset:64000
    s_waitcnt lgkmcnt(8)
    v_mfma_f32_32x32x16_bf16 v[0:15], v[40:43], v[164:167], v[0:15]
    s_waitcnt vmcnt(56)
    s_barrier
    ds_read_b64_tr_b16 v[32:33], v66 offset:0
    ds_read_b64_tr_b16 v[34:35], v66 offset:512
    v_mfma_f32_32x32x16_bf16 v[16:31], v[44:47], v[164:167], v[16:31]
    s_add_u32 s30, s29, 32768
    s_mov_b32 m0, s30
    s_add_u32 s36, s54, 23
    s_and_b32 s36, s36, 31
    s_lshl_b32 s36, s36, 18
    s_add_u32 s36, s36, s26
    buffer_load_dwordx4 v68, s[8:11], s36 offen offset:0 lds
    ds_read_b64_tr_b16 v[36:37], v67 offset:0
    ds_read_b64_tr_b16 v[38:39], v67 offset:512
    s_waitcnt lgkmcnt(8)
    v_mfma_f32_32x32x16_bf16 v[0:15], v[48:51], v[168:171], v[0:15]
    buffer_load_dwordx4 v69, s[8:11], s36 offen offset:1024 lds
    ds_read_b64_tr_b16 v[40:41], v66 offset:2048
    ds_read_b64_tr_b16 v[42:43], v66 offset:2560
    v_mfma_f32_32x32x16_bf16 v[16:31], v[52:55], v[168:171], v[16:31]
    buffer_load_dwordx4 v70, s[8:11], s36 offen offset:2048 lds
    ds_read_b64_tr_b16 v[44:45], v67 offset:2048
    ds_read_b64_tr_b16 v[46:47], v67 offset:2560
    s_waitcnt lgkmcnt(8)
    v_mfma_f32_32x32x16_bf16 v[0:15], v[56:59], v[172:175], v[0:15]
    buffer_load_dwordx4 v71, s[8:11], s36 offen offset:3072 lds
    ds_read_b64_tr_b16 v[48:49], v66 offset:4096
    ds_read_b64_tr_b16 v[50:51], v66 offset:4608
    v_mfma_f32_32x32x16_bf16 v[16:31], v[60:63], v[172:175], v[16:31]
    ds_read_b64_tr_b16 v[52:53], v67 offset:4096
    ds_read_b64_tr_b16 v[54:55], v67 offset:4608
    s_waitcnt vmcnt(16)
    s_waitcnt lgkmcnt(8)
    v_mfma_f32_32x32x16_bf16 v[0:15], v[32:35], v[80:83], v[0:15]
    s_add_u32 s37, s54, 20
    s_and_b32 s37, s37, 31
    s_lshl_b32 s37, s37, 13
    s_add_u32 s37, s37, s25
    s_add_u32 s37, s37, 0
    s_mov_b64 exec, s[38:39]
    buffer_load_dwordx4 v[144:147], v72, s[4:7], s37 offen offset:0
    s_mov_b64 exec, -1
    ds_read_b64_tr_b16 v[56:57], v66 offset:6144
    ds_read_b64_tr_b16 v[58:59], v66 offset:6656
    v_mfma_f32_32x32x16_bf16 v[16:31], v[36:39], v[80:83], v[16:31]
    s_mov_b64 exec, s[38:39]
    buffer_load_dwordx4 v[148:151], v72, s[4:7], s37 offen offset:1024
    s_mov_b64 exec, -1
    ds_read_b64_tr_b16 v[60:61], v67 offset:6144
    ds_read_b64_tr_b16 v[62:63], v67 offset:6656
    s_waitcnt lgkmcnt(8)
    v_mfma_f32_32x32x16_bf16 v[0:15], v[40:43], v[84:87], v[0:15]
    s_mov_b64 exec, s[38:39]
    buffer_load_dwordx4 v[152:155], v72, s[4:7], s37 offen offset:2048
    s_mov_b64 exec, -1
    ds_read_b64_tr_b16 v[32:33], v66 offset:8192
    ds_read_b64_tr_b16 v[34:35], v66 offset:8704
    v_mfma_f32_32x32x16_bf16 v[16:31], v[44:47], v[84:87], v[16:31]
    s_mov_b64 exec, s[38:39]
    buffer_load_dwordx4 v[156:159], v72, s[4:7], s37 offen offset:3072
    s_mov_b64 exec, -1
    ds_read_b64_tr_b16 v[36:37], v67 offset:8192
    ds_read_b64_tr_b16 v[38:39], v67 offset:8704
    s_waitcnt lgkmcnt(8)
    v_mfma_f32_32x32x16_bf16 v[0:15], v[48:51], v[88:91], v[0:15]
    s_add_u32 s37, s54, 20
    s_and_b32 s37, s37, 31
    s_lshl_b32 s37, s37, 13
    s_add_u32 s37, s37, s25
    s_add_u32 s37, s37, 4096
    s_mov_b64 exec, s[38:39]
    buffer_load_dwordx4 v[160:163], v72, s[4:7], s37 offen offset:0
    s_mov_b64 exec, -1
    ds_read_b64_tr_b16 v[40:41], v66 offset:10240
    ds_read_b64_tr_b16 v[42:43], v66 offset:10752
    v_mfma_f32_32x32x16_bf16 v[16:31], v[52:55], v[88:91], v[16:31]
    s_mov_b64 exec, s[38:39]
    buffer_load_dwordx4 v[164:167], v72, s[4:7], s37 offen offset:1024
    s_mov_b64 exec, -1
    ds_read_b64_tr_b16 v[44:45], v67 offset:10240
    ds_read_b64_tr_b16 v[46:47], v67 offset:10752
    s_waitcnt lgkmcnt(8)
    v_mfma_f32_32x32x16_bf16 v[0:15], v[56:59], v[92:95], v[0:15]
    s_mov_b64 exec, s[38:39]
    buffer_load_dwordx4 v[168:171], v72, s[4:7], s37 offen offset:2048
    s_mov_b64 exec, -1
    ds_read_b64_tr_b16 v[48:49], v66 offset:12288
    ds_read_b64_tr_b16 v[50:51], v66 offset:12800
    v_mfma_f32_32x32x16_bf16 v[16:31], v[60:63], v[92:95], v[16:31]
    s_mov_b64 exec, s[38:39]
    buffer_load_dwordx4 v[172:175], v72, s[4:7], s37 offen offset:3072
    s_mov_b64 exec, -1
    ds_read_b64_tr_b16 v[52:53], v67 offset:12288
    ds_read_b64_tr_b16 v[54:55], v67 offset:12800
    s_waitcnt lgkmcnt(8)
    v_mfma_f32_32x32x16_bf16 v[0:15], v[32:35], v[96:99], v[0:15]
    ds_read_b64_tr_b16 v[56:57], v66 offset:14336
    ds_read_b64_tr_b16 v[58:59], v66 offset:14848
    v_mfma_f32_32x32x16_bf16 v[16:31], v[36:39], v[96:99], v[16:31]
    ds_read_b64_tr_b16 v[60:61], v67 offset:14336
    ds_read_b64_tr_b16 v[62:63], v67 offset:14848
    s_waitcnt lgkmcnt(8)
    v_mfma_f32_32x32x16_bf16 v[0:15], v[40:43], v[100:103], v[0:15]
    s_waitcnt vmcnt(56)
    s_barrier
    ds_read_b64_tr_b16 v[32:33], v66 offset:16384
    ds_read_b64_tr_b16 v[34:35], v66 offset:16896
    v_mfma_f32_32x32x16_bf16 v[16:31], v[44:47], v[100:103], v[16:31]
    s_add_u32 s30, s29, 49152
    s_mov_b32 m0, s30
    s_add_u32 s36, s54, 24
    s_and_b32 s36, s36, 31
    s_lshl_b32 s36, s36, 18
    s_add_u32 s36, s36, s26
    buffer_load_dwordx4 v68, s[8:11], s36 offen offset:0 lds
    ds_read_b64_tr_b16 v[36:37], v67 offset:16384
    ds_read_b64_tr_b16 v[38:39], v67 offset:16896
    s_waitcnt lgkmcnt(8)
    v_mfma_f32_32x32x16_bf16 v[0:15], v[48:51], v[104:107], v[0:15]
    buffer_load_dwordx4 v69, s[8:11], s36 offen offset:1024 lds
    ds_read_b64_tr_b16 v[40:41], v66 offset:18432
    ds_read_b64_tr_b16 v[42:43], v66 offset:18944
    v_mfma_f32_32x32x16_bf16 v[16:31], v[52:55], v[104:107], v[16:31]
    buffer_load_dwordx4 v70, s[8:11], s36 offen offset:2048 lds
    ds_read_b64_tr_b16 v[44:45], v67 offset:18432
    ds_read_b64_tr_b16 v[46:47], v67 offset:18944
    s_waitcnt lgkmcnt(8)
    v_mfma_f32_32x32x16_bf16 v[0:15], v[56:59], v[108:111], v[0:15]
    buffer_load_dwordx4 v71, s[8:11], s36 offen offset:3072 lds
    ds_read_b64_tr_b16 v[48:49], v66 offset:20480
    ds_read_b64_tr_b16 v[50:51], v66 offset:20992
    v_mfma_f32_32x32x16_bf16 v[16:31], v[60:63], v[108:111], v[16:31]
    ds_read_b64_tr_b16 v[52:53], v67 offset:20480
    ds_read_b64_tr_b16 v[54:55], v67 offset:20992
    s_waitcnt vmcnt(16)
    s_waitcnt lgkmcnt(8)
    v_mfma_f32_32x32x16_bf16 v[0:15], v[32:35], v[112:115], v[0:15]
    s_add_u32 s37, s54, 21
    s_and_b32 s37, s37, 31
    s_lshl_b32 s37, s37, 13
    s_add_u32 s37, s37, s25
    s_add_u32 s37, s37, 0
    s_mov_b64 exec, s[38:39]
    buffer_load_dwordx4 v[80:83], v72, s[4:7], s37 offen offset:0
    s_mov_b64 exec, -1
    ds_read_b64_tr_b16 v[56:57], v66 offset:22528
    ds_read_b64_tr_b16 v[58:59], v66 offset:23040
    v_mfma_f32_32x32x16_bf16 v[16:31], v[36:39], v[112:115], v[16:31]
    s_mov_b64 exec, s[38:39]
    buffer_load_dwordx4 v[84:87], v72, s[4:7], s37 offen offset:1024
    s_mov_b64 exec, -1
    ds_read_b64_tr_b16 v[60:61], v67 offset:22528
    ds_read_b64_tr_b16 v[62:63], v67 offset:23040
    s_waitcnt lgkmcnt(8)
    v_mfma_f32_32x32x16_bf16 v[0:15], v[40:43], v[116:119], v[0:15]
    s_mov_b64 exec, s[38:39]
    buffer_load_dwordx4 v[88:91], v72, s[4:7], s37 offen offset:2048
    s_mov_b64 exec, -1
    ds_read_b64_tr_b16 v[32:33], v66 offset:24576
    ds_read_b64_tr_b16 v[34:35], v66 offset:25088
    v_mfma_f32_32x32x16_bf16 v[16:31], v[44:47], v[116:119], v[16:31]
    s_mov_b64 exec, s[38:39]
    buffer_load_dwordx4 v[92:95], v72, s[4:7], s37 offen offset:3072
    s_mov_b64 exec, -1
    ds_read_b64_tr_b16 v[36:37], v67 offset:24576
    ds_read_b64_tr_b16 v[38:39], v67 offset:25088
    s_waitcnt lgkmcnt(8)
    v_mfma_f32_32x32x16_bf16 v[0:15], v[48:51], v[120:123], v[0:15]
    s_add_u32 s37, s54, 21
    s_and_b32 s37, s37, 31
    s_lshl_b32 s37, s37, 13
    s_add_u32 s37, s37, s25
    s_add_u32 s37, s37, 4096
    s_mov_b64 exec, s[38:39]
    buffer_load_dwordx4 v[96:99], v72, s[4:7], s37 offen offset:0
    s_mov_b64 exec, -1
    ds_read_b64_tr_b16 v[40:41], v66 offset:26624
    ds_read_b64_tr_b16 v[42:43], v66 offset:27136
    v_mfma_f32_32x32x16_bf16 v[16:31], v[52:55], v[120:123], v[16:31]
    s_mov_b64 exec, s[38:39]
    buffer_load_dwordx4 v[100:103], v72, s[4:7], s37 offen offset:1024
    s_mov_b64 exec, -1
    ds_read_b64_tr_b16 v[44:45], v67 offset:26624
    ds_read_b64_tr_b16 v[46:47], v67 offset:27136
    s_waitcnt lgkmcnt(8)
    v_mfma_f32_32x32x16_bf16 v[0:15], v[56:59], v[124:127], v[0:15]
    s_mov_b64 exec, s[38:39]
    buffer_load_dwordx4 v[104:107], v72, s[4:7], s37 offen offset:2048
    s_mov_b64 exec, -1
    ds_read_b64_tr_b16 v[48:49], v66 offset:28672
    ds_read_b64_tr_b16 v[50:51], v66 offset:29184
    v_mfma_f32_32x32x16_bf16 v[16:31], v[60:63], v[124:127], v[16:31]
    s_mov_b64 exec, s[38:39]
    buffer_load_dwordx4 v[108:111], v72, s[4:7], s37 offen offset:3072
    s_mov_b64 exec, -1
    ds_read_b64_tr_b16 v[52:53], v67 offset:28672
    ds_read_b64_tr_b16 v[54:55], v67 offset:29184
    s_waitcnt lgkmcnt(8)
    v_mfma_f32_32x32x16_bf16 v[0:15], v[32:35], v[128:131], v[0:15]
    ds_read_b64_tr_b16 v[56:57], v66 offset:30720
    ds_read_b64_tr_b16 v[58:59], v66 offset:31232
    v_mfma_f32_32x32x16_bf16 v[16:31], v[36:39], v[128:131], v[16:31]
    ds_read_b64_tr_b16 v[60:61], v67 offset:30720
    ds_read_b64_tr_b16 v[62:63], v67 offset:31232
    s_waitcnt lgkmcnt(8)
    v_mfma_f32_32x32x16_bf16 v[0:15], v[40:43], v[132:135], v[0:15]
    s_waitcnt vmcnt(56)
    s_barrier
    ds_read_b64_tr_b16 v[32:33], v66 offset:32768
    ds_read_b64_tr_b16 v[34:35], v66 offset:33280
    v_mfma_f32_32x32x16_bf16 v[16:31], v[44:47], v[132:135], v[16:31]
    s_add_u32 s30, s29, 65536
    s_mov_b32 m0, s30
    s_add_u32 s36, s54, 25
    s_and_b32 s36, s36, 31
    s_lshl_b32 s36, s36, 18
    s_add_u32 s36, s36, s26
    buffer_load_dwordx4 v68, s[8:11], s36 offen offset:0 lds
    ds_read_b64_tr_b16 v[36:37], v67 offset:32768
    ds_read_b64_tr_b16 v[38:39], v67 offset:33280
    s_waitcnt lgkmcnt(8)
    v_mfma_f32_32x32x16_bf16 v[0:15], v[48:51], v[136:139], v[0:15]
    buffer_load_dwordx4 v69, s[8:11], s36 offen offset:1024 lds
    ds_read_b64_tr_b16 v[40:41], v66 offset:34816
    ds_read_b64_tr_b16 v[42:43], v66 offset:35328
    v_mfma_f32_32x32x16_bf16 v[16:31], v[52:55], v[136:139], v[16:31]
    buffer_load_dwordx4 v70, s[8:11], s36 offen offset:2048 lds
    ds_read_b64_tr_b16 v[44:45], v67 offset:34816
    ds_read_b64_tr_b16 v[46:47], v67 offset:35328
    s_waitcnt lgkmcnt(8)
    v_mfma_f32_32x32x16_bf16 v[0:15], v[56:59], v[140:143], v[0:15]
    buffer_load_dwordx4 v71, s[8:11], s36 offen offset:3072 lds
    ds_read_b64_tr_b16 v[48:49], v66 offset:36864
    ds_read_b64_tr_b16 v[50:51], v66 offset:37376
    v_mfma_f32_32x32x16_bf16 v[16:31], v[60:63], v[140:143], v[16:31]
    ds_read_b64_tr_b16 v[52:53], v67 offset:36864
    ds_read_b64_tr_b16 v[54:55], v67 offset:37376
    s_waitcnt vmcnt(16)
    s_waitcnt lgkmcnt(8)
    v_mfma_f32_32x32x16_bf16 v[0:15], v[32:35], v[144:147], v[0:15]
    s_add_u32 s37, s54, 22
    s_and_b32 s37, s37, 31
    s_lshl_b32 s37, s37, 13
    s_add_u32 s37, s37, s25
    s_add_u32 s37, s37, 0
    s_mov_b64 exec, s[38:39]
    buffer_load_dwordx4 v[112:115], v72, s[4:7], s37 offen offset:0
    s_mov_b64 exec, -1
    ds_read_b64_tr_b16 v[56:57], v66 offset:38912
    ds_read_b64_tr_b16 v[58:59], v66 offset:39424
    v_mfma_f32_32x32x16_bf16 v[16:31], v[36:39], v[144:147], v[16:31]
    s_mov_b64 exec, s[38:39]
    buffer_load_dwordx4 v[116:119], v72, s[4:7], s37 offen offset:1024
    s_mov_b64 exec, -1
    ds_read_b64_tr_b16 v[60:61], v67 offset:38912
    ds_read_b64_tr_b16 v[62:63], v67 offset:39424
    s_waitcnt lgkmcnt(8)
    v_mfma_f32_32x32x16_bf16 v[0:15], v[40:43], v[148:151], v[0:15]
    s_mov_b64 exec, s[38:39]
    buffer_load_dwordx4 v[120:123], v72, s[4:7], s37 offen offset:2048
    s_mov_b64 exec, -1
    ds_read_b64_tr_b16 v[32:33], v66 offset:40960
    ds_read_b64_tr_b16 v[34:35], v66 offset:41472
    v_mfma_f32_32x32x16_bf16 v[16:31], v[44:47], v[148:151], v[16:31]
    s_mov_b64 exec, s[38:39]
    buffer_load_dwordx4 v[124:127], v72, s[4:7], s37 offen offset:3072
    s_mov_b64 exec, -1
    ds_read_b64_tr_b16 v[36:37], v67 offset:40960
    ds_read_b64_tr_b16 v[38:39], v67 offset:41472
    s_waitcnt lgkmcnt(8)
    v_mfma_f32_32x32x16_bf16 v[0:15], v[48:51], v[152:155], v[0:15]
    s_add_u32 s37, s54, 22
    s_and_b32 s37, s37, 31
    s_lshl_b32 s37, s37, 13
    s_add_u32 s37, s37, s25
    s_add_u32 s37, s37, 4096
    s_mov_b64 exec, s[38:39]
    buffer_load_dwordx4 v[128:131], v72, s[4:7], s37 offen offset:0
    s_mov_b64 exec, -1
    ds_read_b64_tr_b16 v[40:41], v66 offset:43008
    ds_read_b64_tr_b16 v[42:43], v66 offset:43520
    v_mfma_f32_32x32x16_bf16 v[16:31], v[52:55], v[152:155], v[16:31]
    s_mov_b64 exec, s[38:39]
    buffer_load_dwordx4 v[132:135], v72, s[4:7], s37 offen offset:1024
    s_mov_b64 exec, -1
    ds_read_b64_tr_b16 v[44:45], v67 offset:43008
    ds_read_b64_tr_b16 v[46:47], v67 offset:43520
    s_waitcnt lgkmcnt(8)
    v_mfma_f32_32x32x16_bf16 v[0:15], v[56:59], v[156:159], v[0:15]
    s_mov_b64 exec, s[38:39]
    buffer_load_dwordx4 v[136:139], v72, s[4:7], s37 offen offset:2048
    s_mov_b64 exec, -1
    ds_read_b64_tr_b16 v[48:49], v66 offset:45056
    ds_read_b64_tr_b16 v[50:51], v66 offset:45568
    v_mfma_f32_32x32x16_bf16 v[16:31], v[60:63], v[156:159], v[16:31]
    s_mov_b64 exec, s[38:39]
    buffer_load_dwordx4 v[140:143], v72, s[4:7], s37 offen offset:3072
    s_mov_b64 exec, -1
    ds_read_b64_tr_b16 v[52:53], v67 offset:45056
    ds_read_b64_tr_b16 v[54:55], v67 offset:45568
    s_waitcnt lgkmcnt(8)
    v_mfma_f32_32x32x16_bf16 v[0:15], v[32:35], v[160:163], v[0:15]
    ds_read_b64_tr_b16 v[56:57], v66 offset:47104
    ds_read_b64_tr_b16 v[58:59], v66 offset:47616
    v_mfma_f32_32x32x16_bf16 v[16:31], v[36:39], v[160:163], v[16:31]
    ds_read_b64_tr_b16 v[60:61], v67 offset:47104
    ds_read_b64_tr_b16 v[62:63], v67 offset:47616
    s_waitcnt lgkmcnt(8)
    v_mfma_f32_32x32x16_bf16 v[0:15], v[40:43], v[164:167], v[0:15]
    s_waitcnt vmcnt(56)
    s_barrier
    ds_read_b64_tr_b16 v[32:33], v64 offset:0
    ds_read_b64_tr_b16 v[34:35], v64 offset:512
    v_mfma_f32_32x32x16_bf16 v[16:31], v[44:47], v[164:167], v[16:31]
    s_add_u32 s30, s29, 81920
    s_mov_b32 m0, s30
    s_add_u32 s36, s54, 26
    s_and_b32 s36, s36, 31
    s_lshl_b32 s36, s36, 18
    s_add_u32 s36, s36, s26
    buffer_load_dwordx4 v68, s[8:11], s36 offen offset:0 lds
    ds_read_b64_tr_b16 v[36:37], v65 offset:0
    ds_read_b64_tr_b16 v[38:39], v65 offset:512
    s_waitcnt lgkmcnt(8)
    v_mfma_f32_32x32x16_bf16 v[0:15], v[48:51], v[168:171], v[0:15]
    buffer_load_dwordx4 v69, s[8:11], s36 offen offset:1024 lds
    ds_read_b64_tr_b16 v[40:41], v64 offset:2048
    ds_read_b64_tr_b16 v[42:43], v64 offset:2560
    v_mfma_f32_32x32x16_bf16 v[16:31], v[52:55], v[168:171], v[16:31]
    buffer_load_dwordx4 v70, s[8:11], s36 offen offset:2048 lds
    ds_read_b64_tr_b16 v[44:45], v65 offset:2048
    ds_read_b64_tr_b16 v[46:47], v65 offset:2560
    s_waitcnt lgkmcnt(8)
    v_mfma_f32_32x32x16_bf16 v[0:15], v[56:59], v[172:175], v[0:15]
    buffer_load_dwordx4 v71, s[8:11], s36 offen offset:3072 lds
    ds_read_b64_tr_b16 v[48:49], v64 offset:4096
    ds_read_b64_tr_b16 v[50:51], v64 offset:4608
    v_mfma_f32_32x32x16_bf16 v[16:31], v[60:63], v[172:175], v[16:31]
    ds_read_b64_tr_b16 v[52:53], v65 offset:4096
    ds_read_b64_tr_b16 v[54:55], v65 offset:4608
    s_waitcnt vmcnt(16)
    s_waitcnt lgkmcnt(8)
    v_mfma_f32_32x32x16_bf16 v[0:15], v[32:35], v[80:83], v[0:15]
    s_add_u32 s37, s54, 23
    s_and_b32 s37, s37, 31
    s_lshl_b32 s37, s37, 13
    s_add_u32 s37, s37, s25
    s_add_u32 s37, s37, 0
    s_mov_b64 exec, s[38:39]
    buffer_load_dwordx4 v[144:147], v72, s[4:7], s37 offen offset:0
    s_mov_b64 exec, -1
    ds_read_b64_tr_b16 v[56:57], v64 offset:6144
    ds_read_b64_tr_b16 v[58:59], v64 offset:6656
    v_mfma_f32_32x32x16_bf16 v[16:31], v[36:39], v[80:83], v[16:31]
    s_mov_b64 exec, s[38:39]
    buffer_load_dwordx4 v[148:151], v72, s[4:7], s37 offen offset:1024
    s_mov_b64 exec, -1
    ds_read_b64_tr_b16 v[60:61], v65 offset:6144
    ds_read_b64_tr_b16 v[62:63], v65 offset:6656
    s_waitcnt lgkmcnt(8)
    v_mfma_f32_32x32x16_bf16 v[0:15], v[40:43], v[84:87], v[0:15]
    s_mov_b64 exec, s[38:39]
    buffer_load_dwordx4 v[152:155], v72, s[4:7], s37 offen offset:2048
    s_mov_b64 exec, -1
    ds_read_b64_tr_b16 v[32:33], v64 offset:8192
    ds_read_b64_tr_b16 v[34:35], v64 offset:8704
    v_mfma_f32_32x32x16_bf16 v[16:31], v[44:47], v[84:87], v[16:31]
    s_mov_b64 exec, s[38:39]
    buffer_load_dwordx4 v[156:159], v72, s[4:7], s37 offen offset:3072
    s_mov_b64 exec, -1
    ds_read_b64_tr_b16 v[36:37], v65 offset:8192
    ds_read_b64_tr_b16 v[38:39], v65 offset:8704
    s_waitcnt lgkmcnt(8)
    v_mfma_f32_32x32x16_bf16 v[0:15], v[48:51], v[88:91], v[0:15]
    s_add_u32 s37, s54, 23
    s_and_b32 s37, s37, 31
    s_lshl_b32 s37, s37, 13
    s_add_u32 s37, s37, s25
    s_add_u32 s37, s37, 4096
    s_mov_b64 exec, s[38:39]
    buffer_load_dwordx4 v[160:163], v72, s[4:7], s37 offen offset:0
    s_mov_b64 exec, -1
    ds_read_b64_tr_b16 v[40:41], v64 offset:10240
    ds_read_b64_tr_b16 v[42:43], v64 offset:10752
    v_mfma_f32_32x32x16_bf16 v[16:31], v[52:55], v[88:91], v[16:31]
    s_mov_b64 exec, s[38:39]
    buffer_load_dwordx4 v[164:167], v72, s[4:7], s37 offen offset:1024
    s_mov_b64 exec, -1
    ds_read_b64_tr_b16 v[44:45], v65 offset:10240
    ds_read_b64_tr_b16 v[46:47], v65 offset:10752
    s_waitcnt lgkmcnt(8)
    v_mfma_f32_32x32x16_bf16 v[0:15], v[56:59], v[92:95], v[0:15]
    s_mov_b64 exec, s[38:39]
    buffer_load_dwordx4 v[168:171], v72, s[4:7], s37 offen offset:2048
    s_mov_b64 exec, -1
    ds_read_b64_tr_b16 v[48:49], v64 offset:12288
    ds_read_b64_tr_b16 v[50:51], v64 offset:12800
    v_mfma_f32_32x32x16_bf16 v[16:31], v[60:63], v[92:95], v[16:31]
    s_mov_b64 exec, s[38:39]
    buffer_load_dwordx4 v[172:175], v72, s[4:7], s37 offen offset:3072
    s_mov_b64 exec, -1
    ds_read_b64_tr_b16 v[52:53], v65 offset:12288
    ds_read_b64_tr_b16 v[54:55], v65 offset:12800
    s_waitcnt lgkmcnt(8)
    v_mfma_f32_32x32x16_bf16 v[0:15], v[32:35], v[96:99], v[0:15]
    ds_read_b64_tr_b16 v[56:57], v64 offset:14336
    ds_read_b64_tr_b16 v[58:59], v64 offset:14848
    v_mfma_f32_32x32x16_bf16 v[16:31], v[36:39], v[96:99], v[16:31]
    ds_read_b64_tr_b16 v[60:61], v65 offset:14336
    ds_read_b64_tr_b16 v[62:63], v65 offset:14848
    s_waitcnt lgkmcnt(8)
    v_mfma_f32_32x32x16_bf16 v[0:15], v[40:43], v[100:103], v[0:15]
    s_waitcnt vmcnt(56)
    s_barrier
    ds_read_b64_tr_b16 v[32:33], v64 offset:16384
    ds_read_b64_tr_b16 v[34:35], v64 offset:16896
    v_mfma_f32_32x32x16_bf16 v[16:31], v[44:47], v[100:103], v[16:31]
    s_add_u32 s30, s29, 98304
    s_mov_b32 m0, s30
    s_add_u32 s36, s54, 27
    s_and_b32 s36, s36, 31
    s_lshl_b32 s36, s36, 18
    s_add_u32 s36, s36, s26
    buffer_load_dwordx4 v68, s[8:11], s36 offen offset:0 lds
    ds_read_b64_tr_b16 v[36:37], v65 offset:16384
    ds_read_b64_tr_b16 v[38:39], v65 offset:16896
    s_waitcnt lgkmcnt(8)
    v_mfma_f32_32x32x16_bf16 v[0:15], v[48:51], v[104:107], v[0:15]
    buffer_load_dwordx4 v69, s[8:11], s36 offen offset:1024 lds
    ds_read_b64_tr_b16 v[40:41], v64 offset:18432
    ds_read_b64_tr_b16 v[42:43], v64 offset:18944
    v_mfma_f32_32x32x16_bf16 v[16:31], v[52:55], v[104:107], v[16:31]
    buffer_load_dwordx4 v70, s[8:11], s36 offen offset:2048 lds
    ds_read_b64_tr_b16 v[44:45], v65 offset:18432
    ds_read_b64_tr_b16 v[46:47], v65 offset:18944
    s_waitcnt lgkmcnt(8)
    v_mfma_f32_32x32x16_bf16 v[0:15], v[56:59], v[108:111], v[0:15]
    buffer_load_dwordx4 v71, s[8:11], s36 offen offset:3072 lds
    ds_read_b64_tr_b16 v[48:49], v64 offset:20480
    ds_read_b64_tr_b16 v[50:51], v64 offset:20992
    v_mfma_f32_32x32x16_bf16 v[16:31], v[60:63], v[108:111], v[16:31]
    ds_read_b64_tr_b16 v[52:53], v65 offset:20480
    ds_read_b64_tr_b16 v[54:55], v65 offset:20992
    s_waitcnt vmcnt(16)
    s_waitcnt lgkmcnt(8)
    v_mfma_f32_32x32x16_bf16 v[0:15], v[32:35], v[112:115], v[0:15]
    s_add_u32 s37, s54, 24
    s_and_b32 s37, s37, 31
    s_lshl_b32 s37, s37, 13
    s_add_u32 s37, s37, s25
    s_add_u32 s37, s37, 0
    s_mov_b64 exec, s[38:39]
    buffer_load_dwordx4 v[80:83], v72, s[4:7], s37 offen offset:0
    s_mov_b64 exec, -1
    ds_read_b64_tr_b16 v[56:57], v64 offset:22528
    ds_read_b64_tr_b16 v[58:59], v64 offset:23040
    v_mfma_f32_32x32x16_bf16 v[16:31], v[36:39], v[112:115], v[16:31]
    s_mov_b64 exec, s[38:39]
    buffer_load_dwordx4 v[84:87], v72, s[4:7], s37 offen offset:1024
    s_mov_b64 exec, -1
    ds_read_b64_tr_b16 v[60:61], v65 offset:22528
    ds_read_b64_tr_b16 v[62:63], v65 offset:23040
    s_waitcnt lgkmcnt(8)
    v_mfma_f32_32x32x16_bf16 v[0:15], v[40:43], v[116:119], v[0:15]
    s_mov_b64 exec, s[38:39]
    buffer_load_dwordx4 v[88:91], v72, s[4:7], s37 offen offset:2048
    s_mov_b64 exec, -1
    ds_read_b64_tr_b16 v[32:33], v64 offset:24576
    ds_read_b64_tr_b16 v[34:35], v64 offset:25088
    v_mfma_f32_32x32x16_bf16 v[16:31], v[44:47], v[116:119], v[16:31]
    s_mov_b64 exec, s[38:39]
    buffer_load_dwordx4 v[92:95], v72, s[4:7], s37 offen offset:3072
    s_mov_b64 exec, -1
    ds_read_b64_tr_b16 v[36:37], v65 offset:24576
    ds_read_b64_tr_b16 v[38:39], v65 offset:25088
    s_waitcnt lgkmcnt(8)
    v_mfma_f32_32x32x16_bf16 v[0:15], v[48:51], v[120:123], v[0:15]
    s_add_u32 s37, s54, 24
    s_and_b32 s37, s37, 31
    s_lshl_b32 s37, s37, 13
    s_add_u32 s37, s37, s25
    s_add_u32 s37, s37, 4096
    s_mov_b64 exec, s[38:39]
    buffer_load_dwordx4 v[96:99], v72, s[4:7], s37 offen offset:0
    s_mov_b64 exec, -1
    ds_read_b64_tr_b16 v[40:41], v64 offset:26624
    ds_read_b64_tr_b16 v[42:43], v64 offset:27136
    v_mfma_f32_32x32x16_bf16 v[16:31], v[52:55], v[120:123], v[16:31]
    s_mov_b64 exec, s[38:39]
    buffer_load_dwordx4 v[100:103], v72, s[4:7], s37 offen offset:1024
    s_mov_b64 exec, -1
    ds_read_b64_tr_b16 v[44:45], v65 offset:26624
    ds_read_b64_tr_b16 v[46:47], v65 offset:27136
    s_waitcnt lgkmcnt(8)
    v_mfma_f32_32x32x16_bf16 v[0:15], v[56:59], v[124:127], v[0:15]
    s_mov_b64 exec, s[38:39]
    buffer_load_dwordx4 v[104:107], v72, s[4:7], s37 offen offset:2048
    s_mov_b64 exec, -1
    ds_read_b64_tr_b16 v[48:49], v64 offset:28672
    ds_read_b64_tr_b16 v[50:51], v64 offset:29184
    v_mfma_f32_32x32x16_bf16 v[16:31], v[60:63], v[124:127], v[16:31]
    s_mov_b64 exec, s[38:39]
    buffer_load_dwordx4 v[108:111], v72, s[4:7], s37 offen offset:3072
    s_mov_b64 exec, -1
    ds_read_b64_tr_b16 v[52:53], v65 offset:28672
    ds_read_b64_tr_b16 v[54:55], v65 offset:29184
    s_waitcnt lgkmcnt(8)
    v_mfma_f32_32x32x16_bf16 v[0:15], v[32:35], v[128:131], v[0:15]
    ds_read_b64_tr_b16 v[56:57], v64 offset:30720
    ds_read_b64_tr_b16 v[58:59], v64 offset:31232
    v_mfma_f32_32x32x16_bf16 v[16:31], v[36:39], v[128:131], v[16:31]
    ds_read_b64_tr_b16 v[60:61], v65 offset:30720
    ds_read_b64_tr_b16 v[62:63], v65 offset:31232
    s_waitcnt lgkmcnt(8)
    v_mfma_f32_32x32x16_bf16 v[0:15], v[40:43], v[132:135], v[0:15]
    s_waitcnt vmcnt(56)
    s_barrier
    ds_read_b64_tr_b16 v[32:33], v64 offset:32768
    ds_read_b64_tr_b16 v[34:35], v64 offset:33280
    v_mfma_f32_32x32x16_bf16 v[16:31], v[44:47], v[132:135], v[16:31]
    s_add_u32 s30, s29, 0
    s_mov_b32 m0, s30
    s_add_u32 s36, s54, 28
    s_and_b32 s36, s36, 31
    s_lshl_b32 s36, s36, 18
    s_add_u32 s36, s36, s26
    buffer_load_dwordx4 v68, s[8:11], s36 offen offset:0 lds
    ds_read_b64_tr_b16 v[36:37], v65 offset:32768
    ds_read_b64_tr_b16 v[38:39], v65 offset:33280
    s_waitcnt lgkmcnt(8)
    v_mfma_f32_32x32x16_bf16 v[0:15], v[48:51], v[136:139], v[0:15]
    buffer_load_dwordx4 v69, s[8:11], s36 offen offset:1024 lds
    ds_read_b64_tr_b16 v[40:41], v64 offset:34816
    ds_read_b64_tr_b16 v[42:43], v64 offset:35328
    v_mfma_f32_32x32x16_bf16 v[16:31], v[52:55], v[136:139], v[16:31]
    buffer_load_dwordx4 v70, s[8:11], s36 offen offset:2048 lds
    ds_read_b64_tr_b16 v[44:45], v65 offset:34816
    ds_read_b64_tr_b16 v[46:47], v65 offset:35328
    s_waitcnt lgkmcnt(8)
    v_mfma_f32_32x32x16_bf16 v[0:15], v[56:59], v[140:143], v[0:15]
    buffer_load_dwordx4 v71, s[8:11], s36 offen offset:3072 lds
    ds_read_b64_tr_b16 v[48:49], v64 offset:36864
    ds_read_b64_tr_b16 v[50:51], v64 offset:37376
    v_mfma_f32_32x32x16_bf16 v[16:31], v[60:63], v[140:143], v[16:31]
    ds_read_b64_tr_b16 v[52:53], v65 offset:36864
    ds_read_b64_tr_b16 v[54:55], v65 offset:37376
    s_waitcnt vmcnt(16)
    s_waitcnt lgkmcnt(8)
    v_mfma_f32_32x32x16_bf16 v[0:15], v[32:35], v[144:147], v[0:15]
    s_add_u32 s37, s54, 25
    s_and_b32 s37, s37, 31
    s_lshl_b32 s37, s37, 13
    s_add_u32 s37, s37, s25
    s_add_u32 s37, s37, 0
    s_mov_b64 exec, s[38:39]
    buffer_load_dwordx4 v[112:115], v72, s[4:7], s37 offen offset:0
    s_mov_b64 exec, -1
    ds_read_b64_tr_b16 v[56:57], v64 offset:38912
    ds_read_b64_tr_b16 v[58:59], v64 offset:39424
    v_mfma_f32_32x32x16_bf16 v[16:31], v[36:39], v[144:147], v[16:31]
    s_mov_b64 exec, s[38:39]
    buffer_load_dwordx4 v[116:119], v72, s[4:7], s37 offen offset:1024
    s_mov_b64 exec, -1
    ds_read_b64_tr_b16 v[60:61], v65 offset:38912
    ds_read_b64_tr_b16 v[62:63], v65 offset:39424
    s_waitcnt lgkmcnt(8)
    v_mfma_f32_32x32x16_bf16 v[0:15], v[40:43], v[148:151], v[0:15]
    s_mov_b64 exec, s[38:39]
    buffer_load_dwordx4 v[120:123], v72, s[4:7], s37 offen offset:2048
    s_mov_b64 exec, -1
    ds_read_b64_tr_b16 v[32:33], v64 offset:40960
    ds_read_b64_tr_b16 v[34:35], v64 offset:41472
    v_mfma_f32_32x32x16_bf16 v[16:31], v[44:47], v[148:151], v[16:31]
    s_mov_b64 exec, s[38:39]
    buffer_load_dwordx4 v[124:127], v72, s[4:7], s37 offen offset:3072
    s_mov_b64 exec, -1
    ds_read_b64_tr_b16 v[36:37], v65 offset:40960
    ds_read_b64_tr_b16 v[38:39], v65 offset:41472
    s_waitcnt lgkmcnt(8)
    v_mfma_f32_32x32x16_bf16 v[0:15], v[48:51], v[152:155], v[0:15]
    s_add_u32 s37, s54, 25
    s_and_b32 s37, s37, 31
    s_lshl_b32 s37, s37, 13
    s_add_u32 s37, s37, s25
    s_add_u32 s37, s37, 4096
    s_mov_b64 exec, s[38:39]
    buffer_load_dwordx4 v[128:131], v72, s[4:7], s37 offen offset:0
    s_mov_b64 exec, -1
    ds_read_b64_tr_b16 v[40:41], v64 offset:43008
    ds_read_b64_tr_b16 v[42:43], v64 offset:43520
    v_mfma_f32_32x32x16_bf16 v[16:31], v[52:55], v[152:155], v[16:31]
    s_mov_b64 exec, s[38:39]
    buffer_load_dwordx4 v[132:135], v72, s[4:7], s37 offen offset:1024
    s_mov_b64 exec, -1
    ds_read_b64_tr_b16 v[44:45], v65 offset:43008
    ds_read_b64_tr_b16 v[46:47], v65 offset:43520
    s_waitcnt lgkmcnt(8)
    v_mfma_f32_32x32x16_bf16 v[0:15], v[56:59], v[156:159], v[0:15]
    s_mov_b64 exec, s[38:39]
    buffer_load_dwordx4 v[136:139], v72, s[4:7], s37 offen offset:2048
    s_mov_b64 exec, -1
    ds_read_b64_tr_b16 v[48:49], v64 offset:45056
    ds_read_b64_tr_b16 v[50:51], v64 offset:45568
    v_mfma_f32_32x32x16_bf16 v[16:31], v[60:63], v[156:159], v[16:31]
    s_mov_b64 exec, s[38:39]
    buffer_load_dwordx4 v[140:143], v72, s[4:7], s37 offen offset:3072
    s_mov_b64 exec, -1
    ds_read_b64_tr_b16 v[52:53], v65 offset:45056
    ds_read_b64_tr_b16 v[54:55], v65 offset:45568
    s_waitcnt lgkmcnt(8)
    v_mfma_f32_32x32x16_bf16 v[0:15], v[32:35], v[160:163], v[0:15]
    ds_read_b64_tr_b16 v[56:57], v64 offset:47104
    ds_read_b64_tr_b16 v[58:59], v64 offset:47616
    v_mfma_f32_32x32x16_bf16 v[16:31], v[36:39], v[160:163], v[16:31]
    ds_read_b64_tr_b16 v[60:61], v65 offset:47104
    ds_read_b64_tr_b16 v[62:63], v65 offset:47616
    s_waitcnt lgkmcnt(8)
    v_mfma_f32_32x32x16_bf16 v[0:15], v[40:43], v[164:167], v[0:15]
    s_waitcnt vmcnt(56)
    s_barrier
    ds_read_b64_tr_b16 v[32:33], v64 offset:49152
    ds_read_b64_tr_b16 v[34:35], v64 offset:49664
    v_mfma_f32_32x32x16_bf16 v[16:31], v[44:47], v[164:167], v[16:31]
    s_add_u32 s30, s29, 16384
    s_mov_b32 m0, s30
    s_add_u32 s36, s54, 29
    s_and_b32 s36, s36, 31
    s_lshl_b32 s36, s36, 18
    s_add_u32 s36, s36, s26
    buffer_load_dwordx4 v68, s[8:11], s36 offen offset:0 lds
    ds_read_b64_tr_b16 v[36:37], v65 offset:49152
    ds_read_b64_tr_b16 v[38:39], v65 offset:49664
    s_waitcnt lgkmcnt(8)
    v_mfma_f32_32x32x16_bf16 v[0:15], v[48:51], v[168:171], v[0:15]
    buffer_load_dwordx4 v69, s[8:11], s36 offen offset:1024 lds
    ds_read_b64_tr_b16 v[40:41], v64 offset:51200
    ds_read_b64_tr_b16 v[42:43], v64 offset:51712
    v_mfma_f32_32x32x16_bf16 v[16:31], v[52:55], v[168:171], v[16:31]
    buffer_load_dwordx4 v70, s[8:11], s36 offen offset:2048 lds
    ds_read_b64_tr_b16 v[44:45], v65 offset:51200
    ds_read_b64_tr_b16 v[46:47], v65 offset:51712
    s_waitcnt lgkmcnt(8)
    v_mfma_f32_32x32x16_bf16 v[0:15], v[56:59], v[172:175], v[0:15]
    buffer_load_dwordx4 v71, s[8:11], s36 offen offset:3072 lds
    ds_read_b64_tr_b16 v[48:49], v64 offset:53248
    ds_read_b64_tr_b16 v[50:51], v64 offset:53760
    v_mfma_f32_32x32x16_bf16 v[16:31], v[60:63], v[172:175], v[16:31]
    ds_read_b64_tr_b16 v[52:53], v65 offset:53248
    ds_read_b64_tr_b16 v[54:55], v65 offset:53760
    s_waitcnt vmcnt(16)
    s_waitcnt lgkmcnt(8)
    v_mfma_f32_32x32x16_bf16 v[0:15], v[32:35], v[80:83], v[0:15]
    s_add_u32 s37, s54, 26
    s_and_b32 s37, s37, 31
    s_lshl_b32 s37, s37, 13
    s_add_u32 s37, s37, s25
    s_add_u32 s37, s37, 0
    s_mov_b64 exec, s[38:39]
    buffer_load_dwordx4 v[144:147], v72, s[4:7], s37 offen offset:0
    s_mov_b64 exec, -1
    ds_read_b64_tr_b16 v[56:57], v64 offset:55296
    ds_read_b64_tr_b16 v[58:59], v64 offset:55808
    v_mfma_f32_32x32x16_bf16 v[16:31], v[36:39], v[80:83], v[16:31]
    s_mov_b64 exec, s[38:39]
    buffer_load_dwordx4 v[148:151], v72, s[4:7], s37 offen offset:1024
    s_mov_b64 exec, -1
    ds_read_b64_tr_b16 v[60:61], v65 offset:55296
    ds_read_b64_tr_b16 v[62:63], v65 offset:55808
    s_waitcnt lgkmcnt(8)
    v_mfma_f32_32x32x16_bf16 v[0:15], v[40:43], v[84:87], v[0:15]
    s_mov_b64 exec, s[38:39]
    buffer_load_dwordx4 v[152:155], v72, s[4:7], s37 offen offset:2048
    s_mov_b64 exec, -1
    ds_read_b64_tr_b16 v[32:33], v64 offset:57344
    ds_read_b64_tr_b16 v[34:35], v64 offset:57856
    v_mfma_f32_32x32x16_bf16 v[16:31], v[44:47], v[84:87], v[16:31]
    s_mov_b64 exec, s[38:39]
    buffer_load_dwordx4 v[156:159], v72, s[4:7], s37 offen offset:3072
    s_mov_b64 exec, -1
    ds_read_b64_tr_b16 v[36:37], v65 offset:57344
    ds_read_b64_tr_b16 v[38:39], v65 offset:57856
    s_waitcnt lgkmcnt(8)
    v_mfma_f32_32x32x16_bf16 v[0:15], v[48:51], v[88:91], v[0:15]
    s_add_u32 s37, s54, 26
    s_and_b32 s37, s37, 31
    s_lshl_b32 s37, s37, 13
    s_add_u32 s37, s37, s25
    s_add_u32 s37, s37, 4096
    s_mov_b64 exec, s[38:39]
    buffer_load_dwordx4 v[160:163], v72, s[4:7], s37 offen offset:0
    s_mov_b64 exec, -1
    ds_read_b64_tr_b16 v[40:41], v64 offset:59392
    ds_read_b64_tr_b16 v[42:43], v64 offset:59904
    v_mfma_f32_32x32x16_bf16 v[16:31], v[52:55], v[88:91], v[16:31]
    s_mov_b64 exec, s[38:39]
    buffer_load_dwordx4 v[164:167], v72, s[4:7], s37 offen offset:1024
    s_mov_b64 exec, -1
    ds_read_b64_tr_b16 v[44:45], v65 offset:59392
    ds_read_b64_tr_b16 v[46:47], v65 offset:59904
    s_waitcnt lgkmcnt(8)
    v_mfma_f32_32x32x16_bf16 v[0:15], v[56:59], v[92:95], v[0:15]
    s_mov_b64 exec, s[38:39]
    buffer_load_dwordx4 v[168:171], v72, s[4:7], s37 offen offset:2048
    s_mov_b64 exec, -1
    ds_read_b64_tr_b16 v[48:49], v64 offset:61440
    ds_read_b64_tr_b16 v[50:51], v64 offset:61952
    v_mfma_f32_32x32x16_bf16 v[16:31], v[60:63], v[92:95], v[16:31]
    s_mov_b64 exec, s[38:39]
    buffer_load_dwordx4 v[172:175], v72, s[4:7], s37 offen offset:3072
    s_mov_b64 exec, -1
    ds_read_b64_tr_b16 v[52:53], v65 offset:61440
    ds_read_b64_tr_b16 v[54:55], v65 offset:61952
    s_waitcnt lgkmcnt(8)
    v_mfma_f32_32x32x16_bf16 v[0:15], v[32:35], v[96:99], v[0:15]
    ds_read_b64_tr_b16 v[56:57], v64 offset:63488
    ds_read_b64_tr_b16 v[58:59], v64 offset:64000
    v_mfma_f32_32x32x16_bf16 v[16:31], v[36:39], v[96:99], v[16:31]
    ds_read_b64_tr_b16 v[60:61], v65 offset:63488
    ds_read_b64_tr_b16 v[62:63], v65 offset:64000
    s_waitcnt lgkmcnt(8)
    v_mfma_f32_32x32x16_bf16 v[0:15], v[40:43], v[100:103], v[0:15]
    s_waitcnt vmcnt(56)
    s_barrier
    ds_read_b64_tr_b16 v[32:33], v66 offset:0
    ds_read_b64_tr_b16 v[34:35], v66 offset:512
    v_mfma_f32_32x32x16_bf16 v[16:31], v[44:47], v[100:103], v[16:31]
    s_add_u32 s30, s29, 32768
    s_mov_b32 m0, s30
    s_add_u32 s36, s54, 30
    s_and_b32 s36, s36, 31
    s_lshl_b32 s36, s36, 18
    s_add_u32 s36, s36, s26
    buffer_load_dwordx4 v68, s[8:11], s36 offen offset:0 lds
    ds_read_b64_tr_b16 v[36:37], v67 offset:0
    ds_read_b64_tr_b16 v[38:39], v67 offset:512
    s_waitcnt lgkmcnt(8)
    v_mfma_f32_32x32x16_bf16 v[0:15], v[48:51], v[104:107], v[0:15]
    buffer_load_dwordx4 v69, s[8:11], s36 offen offset:1024 lds
    ds_read_b64_tr_b16 v[40:41], v66 offset:2048
    ds_read_b64_tr_b16 v[42:43], v66 offset:2560
    v_mfma_f32_32x32x16_bf16 v[16:31], v[52:55], v[104:107], v[16:31]
    buffer_load_dwordx4 v70, s[8:11], s36 offen offset:2048 lds
    ds_read_b64_tr_b16 v[44:45], v67 offset:2048
    ds_read_b64_tr_b16 v[46:47], v67 offset:2560
    s_waitcnt lgkmcnt(8)
    v_mfma_f32_32x32x16_bf16 v[0:15], v[56:59], v[108:111], v[0:15]
    buffer_load_dwordx4 v71, s[8:11], s36 offen offset:3072 lds
    ds_read_b64_tr_b16 v[48:49], v66 offset:4096
    ds_read_b64_tr_b16 v[50:51], v66 offset:4608
    v_mfma_f32_32x32x16_bf16 v[16:31], v[60:63], v[108:111], v[16:31]
    ds_read_b64_tr_b16 v[52:53], v67 offset:4096
    ds_read_b64_tr_b16 v[54:55], v67 offset:4608
    s_waitcnt vmcnt(16)
    s_waitcnt lgkmcnt(8)
    v_mfma_f32_32x32x16_bf16 v[0:15], v[32:35], v[112:115], v[0:15]
    s_add_u32 s37, s54, 27
    s_and_b32 s37, s37, 31
    s_lshl_b32 s37, s37, 13
    s_add_u32 s37, s37, s25
    s_add_u32 s37, s37, 0
    s_mov_b64 exec, s[38:39]
    buffer_load_dwordx4 v[80:83], v72, s[4:7], s37 offen offset:0
    s_mov_b64 exec, -1
    ds_read_b64_tr_b16 v[56:57], v66 offset:6144
    ds_read_b64_tr_b16 v[58:59], v66 offset:6656
    v_mfma_f32_32x32x16_bf16 v[16:31], v[36:39], v[112:115], v[16:31]
    s_mov_b64 exec, s[38:39]
    buffer_load_dwordx4 v[84:87], v72, s[4:7], s37 offen offset:1024
    s_mov_b64 exec, -1
    ds_read_b64_tr_b16 v[60:61], v67 offset:6144
    ds_read_b64_tr_b16 v[62:63], v67 offset:6656
    s_waitcnt lgkmcnt(8)
    v_mfma_f32_32x32x16_bf16 v[0:15], v[40:43], v[116:119], v[0:15]
    s_mov_b64 exec, s[38:39]
    buffer_load_dwordx4 v[88:91], v72, s[4:7], s37 offen offset:2048
    s_mov_b64 exec, -1
    ds_read_b64_tr_b16 v[32:33], v66 offset:8192
    ds_read_b64_tr_b16 v[34:35], v66 offset:8704
    v_mfma_f32_32x32x16_bf16 v[16:31], v[44:47], v[116:119], v[16:31]
    s_mov_b64 exec, s[38:39]
    buffer_load_dwordx4 v[92:95], v72, s[4:7], s37 offen offset:3072
    s_mov_b64 exec, -1
    ds_read_b64_tr_b16 v[36:37], v67 offset:8192
    ds_read_b64_tr_b16 v[38:39], v67 offset:8704
    s_waitcnt lgkmcnt(8)
    v_mfma_f32_32x32x16_bf16 v[0:15], v[48:51], v[120:123], v[0:15]
    s_add_u32 s37, s54, 27
    s_and_b32 s37, s37, 31
    s_lshl_b32 s37, s37, 13
    s_add_u32 s37, s37, s25
    s_add_u32 s37, s37, 4096
    s_mov_b64 exec, s[38:39]
    buffer_load_dwordx4 v[96:99], v72, s[4:7], s37 offen offset:0
    s_mov_b64 exec, -1
    ds_read_b64_tr_b16 v[40:41], v66 offset:10240
    ds_read_b64_tr_b16 v[42:43], v66 offset:10752
    v_mfma_f32_32x32x16_bf16 v[16:31], v[52:55], v[120:123], v[16:31]
    s_mov_b64 exec, s[38:39]
    buffer_load_dwordx4 v[100:103], v72, s[4:7], s37 offen offset:1024
    s_mov_b64 exec, -1
    ds_read_b64_tr_b16 v[44:45], v67 offset:10240
    ds_read_b64_tr_b16 v[46:47], v67 offset:10752
    s_waitcnt lgkmcnt(8)
    v_mfma_f32_32x32x16_bf16 v[0:15], v[56:59], v[124:127], v[0:15]
    s_mov_b64 exec, s[38:39]
    buffer_load_dwordx4 v[104:107], v72, s[4:7], s37 offen offset:2048
    s_mov_b64 exec, -1
    ds_read_b64_tr_b16 v[48:49], v66 offset:12288
    ds_read_b64_tr_b16 v[50:51], v66 offset:12800
    v_mfma_f32_32x32x16_bf16 v[16:31], v[60:63], v[124:127], v[16:31]
    s_mov_b64 exec, s[38:39]
    buffer_load_dwordx4 v[108:111], v72, s[4:7], s37 offen offset:3072
    s_mov_b64 exec, -1
    ds_read_b64_tr_b16 v[52:53], v67 offset:12288
    ds_read_b64_tr_b16 v[54:55], v67 offset:12800
    s_waitcnt lgkmcnt(8)
    v_mfma_f32_32x32x16_bf16 v[0:15], v[32:35], v[128:131], v[0:15]
    ds_read_b64_tr_b16 v[56:57], v66 offset:14336
    ds_read_b64_tr_b16 v[58:59], v66 offset:14848
    v_mfma_f32_32x32x16_bf16 v[16:31], v[36:39], v[128:131], v[16:31]
    ds_read_b64_tr_b16 v[60:61], v67 offset:14336
    ds_read_b64_tr_b16 v[62:63], v67 offset:14848
    s_waitcnt lgkmcnt(8)
    v_mfma_f32_32x32x16_bf16 v[0:15], v[40:43], v[132:135], v[0:15]
    s_waitcnt vmcnt(56)
    s_barrier
    ds_read_b64_tr_b16 v[32:33], v66 offset:16384
    ds_read_b64_tr_b16 v[34:35], v66 offset:16896
    v_mfma_f32_32x32x16_bf16 v[16:31], v[44:47], v[132:135], v[16:31]
    s_add_u32 s30, s29, 49152
    s_mov_b32 m0, s30
    s_add_u32 s36, s54, 31
    s_and_b32 s36, s36, 31
    s_lshl_b32 s36, s36, 18
    s_add_u32 s36, s36, s26
    buffer_load_dwordx4 v68, s[8:11], s36 offen offset:0 lds
    ds_read_b64_tr_b16 v[36:37], v67 offset:16384
    ds_read_b64_tr_b16 v[38:39], v67 offset:16896
    s_waitcnt lgkmcnt(8)
    v_mfma_f32_32x32x16_bf16 v[0:15], v[48:51], v[136:139], v[0:15]
    buffer_load_dwordx4 v69, s[8:11], s36 offen offset:1024 lds
    ds_read_b64_tr_b16 v[40:41], v66 offset:18432
    ds_read_b64_tr_b16 v[42:43], v66 offset:18944
    v_mfma_f32_32x32x16_bf16 v[16:31], v[52:55], v[136:139], v[16:31]
    buffer_load_dwordx4 v70, s[8:11], s36 offen offset:2048 lds
    ds_read_b64_tr_b16 v[44:45], v67 offset:18432
    ds_read_b64_tr_b16 v[46:47], v67 offset:18944
    s_waitcnt lgkmcnt(8)
    v_mfma_f32_32x32x16_bf16 v[0:15], v[56:59], v[140:143], v[0:15]
    buffer_load_dwordx4 v71, s[8:11], s36 offen offset:3072 lds
    ds_read_b64_tr_b16 v[48:49], v66 offset:20480
    ds_read_b64_tr_b16 v[50:51], v66 offset:20992
    v_mfma_f32_32x32x16_bf16 v[16:31], v[60:63], v[140:143], v[16:31]
    ds_read_b64_tr_b16 v[52:53], v67 offset:20480
    ds_read_b64_tr_b16 v[54:55], v67 offset:20992
    s_waitcnt vmcnt(16)
    s_waitcnt lgkmcnt(8)
    v_mfma_f32_32x32x16_bf16 v[0:15], v[32:35], v[144:147], v[0:15]
    s_add_u32 s37, s54, 28
    s_and_b32 s37, s37, 31
    s_lshl_b32 s37, s37, 13
    s_add_u32 s37, s37, s25
    s_add_u32 s37, s37, 0
    s_mov_b64 exec, s[38:39]
    buffer_load_dwordx4 v[112:115], v72, s[4:7], s37 offen offset:0
    s_mov_b64 exec, -1
    ds_read_b64_tr_b16 v[56:57], v66 offset:22528
    ds_read_b64_tr_b16 v[58:59], v66 offset:23040
    v_mfma_f32_32x32x16_bf16 v[16:31], v[36:39], v[144:147], v[16:31]
    s_mov_b64 exec, s[38:39]
    buffer_load_dwordx4 v[116:119], v72, s[4:7], s37 offen offset:1024
    s_mov_b64 exec, -1
    ds_read_b64_tr_b16 v[60:61], v67 offset:22528
    ds_read_b64_tr_b16 v[62:63], v67 offset:23040
    s_waitcnt lgkmcnt(8)
    v_mfma_f32_32x32x16_bf16 v[0:15], v[40:43], v[148:151], v[0:15]
    s_mov_b64 exec, s[38:39]
    buffer_load_dwordx4 v[120:123], v72, s[4:7], s37 offen offset:2048
    s_mov_b64 exec, -1
    ds_read_b64_tr_b16 v[32:33], v66 offset:24576
    ds_read_b64_tr_b16 v[34:35], v66 offset:25088
    v_mfma_f32_32x32x16_bf16 v[16:31], v[44:47], v[148:151], v[16:31]
    s_mov_b64 exec, s[38:39]
    buffer_load_dwordx4 v[124:127], v72, s[4:7], s37 offen offset:3072
    s_mov_b64 exec, -1
    ds_read_b64_tr_b16 v[36:37], v67 offset:24576
    ds_read_b64_tr_b16 v[38:39], v67 offset:25088
    s_waitcnt lgkmcnt(8)
    v_mfma_f32_32x32x16_bf16 v[0:15], v[48:51], v[152:155], v[0:15]
    s_add_u32 s37, s54, 28
    s_and_b32 s37, s37, 31
    s_lshl_b32 s37, s37, 13
    s_add_u32 s37, s37, s25
    s_add_u32 s37, s37, 4096
    s_mov_b64 exec, s[38:39]
    buffer_load_dwordx4 v[128:131], v72, s[4:7], s37 offen offset:0
    s_mov_b64 exec, -1
    ds_read_b64_tr_b16 v[40:41], v66 offset:26624
    ds_read_b64_tr_b16 v[42:43], v66 offset:27136
    v_mfma_f32_32x32x16_bf16 v[16:31], v[52:55], v[152:155], v[16:31]
    s_mov_b64 exec, s[38:39]
    buffer_load_dwordx4 v[132:135], v72, s[4:7], s37 offen offset:1024
    s_mov_b64 exec, -1
    ds_read_b64_tr_b16 v[44:45], v67 offset:26624
    ds_read_b64_tr_b16 v[46:47], v67 offset:27136
    s_waitcnt lgkmcnt(8)
    v_mfma_f32_32x32x16_bf16 v[0:15], v[56:59], v[156:159], v[0:15]
    s_mov_b64 exec, s[38:39]
    buffer_load_dwordx4 v[136:139], v72, s[4:7], s37 offen offset:2048
    s_mov_b64 exec, -1
    ds_read_b64_tr_b16 v[48:49], v66 offset:28672
    ds_read_b64_tr_b16 v[50:51], v66 offset:29184
    v_mfma_f32_32x32x16_bf16 v[16:31], v[60:63], v[156:159], v[16:31]
    s_mov_b64 exec, s[38:39]
    buffer_load_dwordx4 v[140:143], v72, s[4:7], s37 offen offset:3072
    s_mov_b64 exec, -1
    ds_read_b64_tr_b16 v[52:53], v67 offset:28672
    ds_read_b64_tr_b16 v[54:55], v67 offset:29184
    s_waitcnt lgkmcnt(8)
    v_mfma_f32_32x32x16_bf16 v[0:15], v[32:35], v[160:163], v[0:15]
    ds_read_b64_tr_b16 v[56:57], v66 offset:30720
    ds_read_b64_tr_b16 v[58:59], v66 offset:31232
    v_mfma_f32_32x32x16_bf16 v[16:31], v[36:39], v[160:163], v[16:31]
    ds_read_b64_tr_b16 v[60:61], v67 offset:30720
    ds_read_b64_tr_b16 v[62:63], v67 offset:31232
    s_waitcnt lgkmcnt(8)
    v_mfma_f32_32x32x16_bf16 v[0:15], v[40:43], v[164:167], v[0:15]
    s_waitcnt vmcnt(56)
    s_barrier
    ds_read_b64_tr_b16 v[32:33], v66 offset:32768
    ds_read_b64_tr_b16 v[34:35], v66 offset:33280
    v_mfma_f32_32x32x16_bf16 v[16:31], v[44:47], v[164:167], v[16:31]
    ds_read_b64_tr_b16 v[36:37], v67 offset:32768
    ds_read_b64_tr_b16 v[38:39], v67 offset:33280
    s_waitcnt lgkmcnt(8)
    v_mfma_f32_32x32x16_bf16 v[0:15], v[48:51], v[168:171], v[0:15]
    ds_read_b64_tr_b16 v[40:41], v66 offset:34816
    ds_read_b64_tr_b16 v[42:43], v66 offset:35328
    v_mfma_f32_32x32x16_bf16 v[16:31], v[52:55], v[168:171], v[16:31]
    ds_read_b64_tr_b16 v[44:45], v67 offset:34816
    ds_read_b64_tr_b16 v[46:47], v67 offset:35328
    s_waitcnt lgkmcnt(8)
    v_mfma_f32_32x32x16_bf16 v[0:15], v[56:59], v[172:175], v[0:15]
    ds_read_b64_tr_b16 v[48:49], v66 offset:36864
    ds_read_b64_tr_b16 v[50:51], v66 offset:37376
    v_mfma_f32_32x32x16_bf16 v[16:31], v[60:63], v[172:175], v[16:31]
    ds_read_b64_tr_b16 v[52:53], v67 offset:36864
    ds_read_b64_tr_b16 v[54:55], v67 offset:37376
    s_waitcnt vmcnt(12)
    s_waitcnt lgkmcnt(8)
    v_mfma_f32_32x32x16_bf16 v[0:15], v[32:35], v[80:83], v[0:15]
    s_add_u32 s37, s54, 29
    s_and_b32 s37, s37, 31
    s_lshl_b32 s37, s37, 13
    s_add_u32 s37, s37, s25
    s_add_u32 s37, s37, 0
    s_mov_b64 exec, s[38:39]
    buffer_load_dwordx4 v[144:147], v72, s[4:7], s37 offen offset:0
    s_mov_b64 exec, -1
    ds_read_b64_tr_b16 v[56:57], v66 offset:38912
    ds_read_b64_tr_b16 v[58:59], v66 offset:39424
    v_mfma_f32_32x32x16_bf16 v[16:31], v[36:39], v[80:83], v[16:31]
    s_mov_b64 exec, s[38:39]
    buffer_load_dwordx4 v[148:151], v72, s[4:7], s37 offen offset:1024
    s_mov_b64 exec, -1
    ds_read_b64_tr_b16 v[60:61], v67 offset:38912
    ds_read_b64_tr_b16 v[62:63], v67 offset:39424
    s_waitcnt lgkmcnt(8)
    v_mfma_f32_32x32x16_bf16 v[0:15], v[40:43], v[84:87], v[0:15]
    s_mov_b64 exec, s[38:39]
    buffer_load_dwordx4 v[152:155], v72, s[4:7], s37 offen offset:2048
    s_mov_b64 exec, -1
    ds_read_b64_tr_b16 v[32:33], v66 offset:40960
    ds_read_b64_tr_b16 v[34:35], v66 offset:41472
    v_mfma_f32_32x32x16_bf16 v[16:31], v[44:47], v[84:87], v[16:31]
    s_mov_b64 exec, s[38:39]
    buffer_load_dwordx4 v[156:159], v72, s[4:7], s37 offen offset:3072
    s_mov_b64 exec, -1
    ds_read_b64_tr_b16 v[36:37], v67 offset:40960
    ds_read_b64_tr_b16 v[38:39], v67 offset:41472
    s_waitcnt lgkmcnt(8)
    v_mfma_f32_32x32x16_bf16 v[0:15], v[48:51], v[88:91], v[0:15]
    s_add_u32 s37, s54, 29
    s_and_b32 s37, s37, 31
    s_lshl_b32 s37, s37, 13
    s_add_u32 s37, s37, s25
    s_add_u32 s37, s37, 4096
    s_mov_b64 exec, s[38:39]
    buffer_load_dwordx4 v[160:163], v72, s[4:7], s37 offen offset:0
    s_mov_b64 exec, -1
    ds_read_b64_tr_b16 v[40:41], v66 offset:43008
    ds_read_b64_tr_b16 v[42:43], v66 offset:43520
    v_mfma_f32_32x32x16_bf16 v[16:31], v[52:55], v[88:91], v[16:31]
    s_mov_b64 exec, s[38:39]
    buffer_load_dwordx4 v[164:167], v72, s[4:7], s37 offen offset:1024
    s_mov_b64 exec, -1
    ds_read_b64_tr_b16 v[44:45], v67 offset:43008
    ds_read_b64_tr_b16 v[46:47], v67 offset:43520
    s_waitcnt lgkmcnt(8)
    v_mfma_f32_32x32x16_bf16 v[0:15], v[56:59], v[92:95], v[0:15]
    s_mov_b64 exec, s[38:39]
    buffer_load_dwordx4 v[168:171], v72, s[4:7], s37 offen offset:2048
    s_mov_b64 exec, -1
    ds_read_b64_tr_b16 v[48:49], v66 offset:45056
    ds_read_b64_tr_b16 v[50:51], v66 offset:45568
    v_mfma_f32_32x32x16_bf16 v[16:31], v[60:63], v[92:95], v[16:31]
    s_mov_b64 exec, s[38:39]
    buffer_load_dwordx4 v[172:175], v72, s[4:7], s37 offen offset:3072
    s_mov_b64 exec, -1
    ds_read_b64_tr_b16 v[52:53], v67 offset:45056
    ds_read_b64_tr_b16 v[54:55], v67 offset:45568
    s_waitcnt lgkmcnt(8)
    v_mfma_f32_32x32x16_bf16 v[0:15], v[32:35], v[96:99], v[0:15]
    ds_read_b64_tr_b16 v[56:57], v66 offset:47104
    ds_read_b64_tr_b16 v[58:59], v66 offset:47616
    v_mfma_f32_32x32x16_bf16 v[16:31], v[36:39], v[96:99], v[16:31]
    ds_read_b64_tr_b16 v[60:61], v67 offset:47104
    ds_read_b64_tr_b16 v[62:63], v67 offset:47616
    s_waitcnt lgkmcnt(8)
    v_mfma_f32_32x32x16_bf16 v[0:15], v[40:43], v[100:103], v[0:15]
    s_waitcnt vmcnt(52)
    s_barrier
    ds_read_b64_tr_b16 v[32:33], v64 offset:0
    ds_read_b64_tr_b16 v[34:35], v64 offset:512
    v_mfma_f32_32x32x16_bf16 v[16:31], v[44:47], v[100:103], v[16:31]
    ds_read_b64_tr_b16 v[36:37], v65 offset:0
    ds_read_b64_tr_b16 v[38:39], v65 offset:512
    s_waitcnt lgkmcnt(8)
    v_mfma_f32_32x32x16_bf16 v[0:15], v[48:51], v[104:107], v[0:15]
    ds_read_b64_tr_b16 v[40:41], v64 offset:2048
    ds_read_b64_tr_b16 v[42:43], v64 offset:2560
    v_mfma_f32_32x32x16_bf16 v[16:31], v[52:55], v[104:107], v[16:31]
    ds_read_b64_tr_b16 v[44:45], v65 offset:2048
    ds_read_b64_tr_b16 v[46:47], v65 offset:2560
    s_waitcnt lgkmcnt(8)
    v_mfma_f32_32x32x16_bf16 v[0:15], v[56:59], v[108:111], v[0:15]
    ds_read_b64_tr_b16 v[48:49], v64 offset:4096
    ds_read_b64_tr_b16 v[50:51], v64 offset:4608
    v_mfma_f32_32x32x16_bf16 v[16:31], v[60:63], v[108:111], v[16:31]
    ds_read_b64_tr_b16 v[52:53], v65 offset:4096
    ds_read_b64_tr_b16 v[54:55], v65 offset:4608
    s_waitcnt vmcnt(8)
    s_waitcnt lgkmcnt(8)
    v_mfma_f32_32x32x16_bf16 v[0:15], v[32:35], v[112:115], v[0:15]
    s_add_u32 s37, s54, 30
    s_and_b32 s37, s37, 31
    s_lshl_b32 s37, s37, 13
    s_add_u32 s37, s37, s25
    s_add_u32 s37, s37, 0
    s_mov_b64 exec, s[38:39]
    buffer_load_dwordx4 v[80:83], v72, s[4:7], s37 offen offset:0
    s_mov_b64 exec, -1
    ds_read_b64_tr_b16 v[56:57], v64 offset:6144
    ds_read_b64_tr_b16 v[58:59], v64 offset:6656
    v_mfma_f32_32x32x16_bf16 v[16:31], v[36:39], v[112:115], v[16:31]
    s_mov_b64 exec, s[38:39]
    buffer_load_dwordx4 v[84:87], v72, s[4:7], s37 offen offset:1024
    s_mov_b64 exec, -1
    ds_read_b64_tr_b16 v[60:61], v65 offset:6144
    ds_read_b64_tr_b16 v[62:63], v65 offset:6656
    s_waitcnt lgkmcnt(8)
    v_mfma_f32_32x32x16_bf16 v[0:15], v[40:43], v[116:119], v[0:15]
    s_mov_b64 exec, s[38:39]
    buffer_load_dwordx4 v[88:91], v72, s[4:7], s37 offen offset:2048
    s_mov_b64 exec, -1
    ds_read_b64_tr_b16 v[32:33], v64 offset:8192
    ds_read_b64_tr_b16 v[34:35], v64 offset:8704
    v_mfma_f32_32x32x16_bf16 v[16:31], v[44:47], v[116:119], v[16:31]
    s_mov_b64 exec, s[38:39]
    buffer_load_dwordx4 v[92:95], v72, s[4:7], s37 offen offset:3072
    s_mov_b64 exec, -1
    ds_read_b64_tr_b16 v[36:37], v65 offset:8192
    ds_read_b64_tr_b16 v[38:39], v65 offset:8704
    s_waitcnt lgkmcnt(8)
    v_mfma_f32_32x32x16_bf16 v[0:15], v[48:51], v[120:123], v[0:15]
    s_add_u32 s37, s54, 30
    s_and_b32 s37, s37, 31
    s_lshl_b32 s37, s37, 13
    s_add_u32 s37, s37, s25
    s_add_u32 s37, s37, 4096
    s_mov_b64 exec, s[38:39]
    buffer_load_dwordx4 v[96:99], v72, s[4:7], s37 offen offset:0
    s_mov_b64 exec, -1
    ds_read_b64_tr_b16 v[40:41], v64 offset:10240
    ds_read_b64_tr_b16 v[42:43], v64 offset:10752
    v_mfma_f32_32x32x16_bf16 v[16:31], v[52:55], v[120:123], v[16:31]
    s_mov_b64 exec, s[38:39]
    buffer_load_dwordx4 v[100:103], v72, s[4:7], s37 offen offset:1024
    s_mov_b64 exec, -1
    ds_read_b64_tr_b16 v[44:45], v65 offset:10240
    ds_read_b64_tr_b16 v[46:47], v65 offset:10752
    s_waitcnt lgkmcnt(8)
    v_mfma_f32_32x32x16_bf16 v[0:15], v[56:59], v[124:127], v[0:15]
    s_mov_b64 exec, s[38:39]
    buffer_load_dwordx4 v[104:107], v72, s[4:7], s37 offen offset:2048
    s_mov_b64 exec, -1
    ds_read_b64_tr_b16 v[48:49], v64 offset:12288
    ds_read_b64_tr_b16 v[50:51], v64 offset:12800
    v_mfma_f32_32x32x16_bf16 v[16:31], v[60:63], v[124:127], v[16:31]
    s_mov_b64 exec, s[38:39]
    buffer_load_dwordx4 v[108:111], v72, s[4:7], s37 offen offset:3072
    s_mov_b64 exec, -1
    ds_read_b64_tr_b16 v[52:53], v65 offset:12288
    ds_read_b64_tr_b16 v[54:55], v65 offset:12800
    s_waitcnt lgkmcnt(8)
    v_mfma_f32_32x32x16_bf16 v[0:15], v[32:35], v[128:131], v[0:15]
    ds_read_b64_tr_b16 v[56:57], v64 offset:14336
    ds_read_b64_tr_b16 v[58:59], v64 offset:14848
    v_mfma_f32_32x32x16_bf16 v[16:31], v[36:39], v[128:131], v[16:31]
    ds_read_b64_tr_b16 v[60:61], v65 offset:14336
    ds_read_b64_tr_b16 v[62:63], v65 offset:14848
    s_waitcnt lgkmcnt(8)
    v_mfma_f32_32x32x16_bf16 v[0:15], v[40:43], v[132:135], v[0:15]
    s_waitcnt vmcnt(48)
    s_barrier
    ds_read_b64_tr_b16 v[32:33], v64 offset:16384
    ds_read_b64_tr_b16 v[34:35], v64 offset:16896
    v_mfma_f32_32x32x16_bf16 v[16:31], v[44:47], v[132:135], v[16:31]
    ds_read_b64_tr_b16 v[36:37], v65 offset:16384
    ds_read_b64_tr_b16 v[38:39], v65 offset:16896
    s_waitcnt lgkmcnt(8)
    v_mfma_f32_32x32x16_bf16 v[0:15], v[48:51], v[136:139], v[0:15]
    ds_read_b64_tr_b16 v[40:41], v64 offset:18432
    ds_read_b64_tr_b16 v[42:43], v64 offset:18944
    v_mfma_f32_32x32x16_bf16 v[16:31], v[52:55], v[136:139], v[16:31]
    ds_read_b64_tr_b16 v[44:45], v65 offset:18432
    ds_read_b64_tr_b16 v[46:47], v65 offset:18944
    s_waitcnt lgkmcnt(8)
    v_mfma_f32_32x32x16_bf16 v[0:15], v[56:59], v[140:143], v[0:15]
    ds_read_b64_tr_b16 v[48:49], v64 offset:20480
    ds_read_b64_tr_b16 v[50:51], v64 offset:20992
    v_mfma_f32_32x32x16_bf16 v[16:31], v[60:63], v[140:143], v[16:31]
    ds_read_b64_tr_b16 v[52:53], v65 offset:20480
    ds_read_b64_tr_b16 v[54:55], v65 offset:20992
    s_waitcnt vmcnt(8)
    s_waitcnt lgkmcnt(8)
    v_mfma_f32_32x32x16_bf16 v[0:15], v[32:35], v[144:147], v[0:15]
    s_add_u32 s37, s54, 31
    s_and_b32 s37, s37, 31
    s_lshl_b32 s37, s37, 13
    s_add_u32 s37, s37, s25
    s_add_u32 s37, s37, 0
    s_mov_b64 exec, s[38:39]
    buffer_load_dwordx4 v[112:115], v72, s[4:7], s37 offen offset:0
    s_mov_b64 exec, -1
    ds_read_b64_tr_b16 v[56:57], v64 offset:22528
    ds_read_b64_tr_b16 v[58:59], v64 offset:23040
    v_mfma_f32_32x32x16_bf16 v[16:31], v[36:39], v[144:147], v[16:31]
    s_mov_b64 exec, s[38:39]
    buffer_load_dwordx4 v[116:119], v72, s[4:7], s37 offen offset:1024
    s_mov_b64 exec, -1
    ds_read_b64_tr_b16 v[60:61], v65 offset:22528
    ds_read_b64_tr_b16 v[62:63], v65 offset:23040
    s_waitcnt lgkmcnt(8)
    v_mfma_f32_32x32x16_bf16 v[0:15], v[40:43], v[148:151], v[0:15]
    s_mov_b64 exec, s[38:39]
    buffer_load_dwordx4 v[120:123], v72, s[4:7], s37 offen offset:2048
    s_mov_b64 exec, -1
    ds_read_b64_tr_b16 v[32:33], v64 offset:24576
    ds_read_b64_tr_b16 v[34:35], v64 offset:25088
    v_mfma_f32_32x32x16_bf16 v[16:31], v[44:47], v[148:151], v[16:31]
    s_mov_b64 exec, s[38:39]
    buffer_load_dwordx4 v[124:127], v72, s[4:7], s37 offen offset:3072
    s_mov_b64 exec, -1
    ds_read_b64_tr_b16 v[36:37], v65 offset:24576
    ds_read_b64_tr_b16 v[38:39], v65 offset:25088
    s_waitcnt lgkmcnt(8)
    v_mfma_f32_32x32x16_bf16 v[0:15], v[48:51], v[152:155], v[0:15]
    s_add_u32 s37, s54, 31
    s_and_b32 s37, s37, 31
    s_lshl_b32 s37, s37, 13
    s_add_u32 s37, s37, s25
    s_add_u32 s37, s37, 4096
    s_mov_b64 exec, s[38:39]
    buffer_load_dwordx4 v[128:131], v72, s[4:7], s37 offen offset:0
    s_mov_b64 exec, -1
    ds_read_b64_tr_b16 v[40:41], v64 offset:26624
    ds_read_b64_tr_b16 v[42:43], v64 offset:27136
    v_mfma_f32_32x32x16_bf16 v[16:31], v[52:55], v[152:155], v[16:31]
    s_mov_b64 exec, s[38:39]
    buffer_load_dwordx4 v[132:135], v72, s[4:7], s37 offen offset:1024
    s_mov_b64 exec, -1
    ds_read_b64_tr_b16 v[44:45], v65 offset:26624
    ds_read_b64_tr_b16 v[46:47], v65 offset:27136
    s_waitcnt lgkmcnt(8)
    v_mfma_f32_32x32x16_bf16 v[0:15], v[56:59], v[156:159], v[0:15]
    s_mov_b64 exec, s[38:39]
    buffer_load_dwordx4 v[136:139], v72, s[4:7], s37 offen offset:2048
    s_mov_b64 exec, -1
    ds_read_b64_tr_b16 v[48:49], v64 offset:28672
    ds_read_b64_tr_b16 v[50:51], v64 offset:29184
    v_mfma_f32_32x32x16_bf16 v[16:31], v[60:63], v[156:159], v[16:31]
    s_mov_b64 exec, s[38:39]
    buffer_load_dwordx4 v[140:143], v72, s[4:7], s37 offen offset:3072
    s_mov_b64 exec, -1
    ds_read_b64_tr_b16 v[52:53], v65 offset:28672
    ds_read_b64_tr_b16 v[54:55], v65 offset:29184
    s_waitcnt lgkmcnt(8)
    v_mfma_f32_32x32x16_bf16 v[0:15], v[32:35], v[160:163], v[0:15]
    ds_read_b64_tr_b16 v[56:57], v64 offset:30720
    ds_read_b64_tr_b16 v[58:59], v64 offset:31232
    v_mfma_f32_32x32x16_bf16 v[16:31], v[36:39], v[160:163], v[16:31]
    ds_read_b64_tr_b16 v[60:61], v65 offset:30720
    ds_read_b64_tr_b16 v[62:63], v65 offset:31232
    s_waitcnt lgkmcnt(8)
    v_mfma_f32_32x32x16_bf16 v[0:15], v[40:43], v[164:167], v[0:15]
    s_waitcnt vmcnt(44)
    s_barrier
    ds_read_b64_tr_b16 v[32:33], v64 offset:32768
    ds_read_b64_tr_b16 v[34:35], v64 offset:33280
    v_mfma_f32_32x32x16_bf16 v[16:31], v[44:47], v[164:167], v[16:31]
    ds_read_b64_tr_b16 v[36:37], v65 offset:32768
    ds_read_b64_tr_b16 v[38:39], v65 offset:33280
    s_waitcnt lgkmcnt(8)
    v_mfma_f32_32x32x16_bf16 v[0:15], v[48:51], v[168:171], v[0:15]
    ds_read_b64_tr_b16 v[40:41], v64 offset:34816
    ds_read_b64_tr_b16 v[42:43], v64 offset:35328
    v_mfma_f32_32x32x16_bf16 v[16:31], v[52:55], v[168:171], v[16:31]
    ds_read_b64_tr_b16 v[44:45], v65 offset:34816
    ds_read_b64_tr_b16 v[46:47], v65 offset:35328
    s_waitcnt lgkmcnt(8)
    v_mfma_f32_32x32x16_bf16 v[0:15], v[56:59], v[172:175], v[0:15]
    ds_read_b64_tr_b16 v[48:49], v64 offset:36864
    ds_read_b64_tr_b16 v[50:51], v64 offset:37376
    v_mfma_f32_32x32x16_bf16 v[16:31], v[60:63], v[172:175], v[16:31]
    ds_read_b64_tr_b16 v[52:53], v65 offset:36864
    ds_read_b64_tr_b16 v[54:55], v65 offset:37376
    s_waitcnt vmcnt(8)
    s_waitcnt lgkmcnt(8)
    v_mfma_f32_32x32x16_bf16 v[0:15], v[32:35], v[80:83], v[0:15]
    ds_read_b64_tr_b16 v[56:57], v64 offset:38912
    ds_read_b64_tr_b16 v[58:59], v64 offset:39424
    v_mfma_f32_32x32x16_bf16 v[16:31], v[36:39], v[80:83], v[16:31]
    ds_read_b64_tr_b16 v[60:61], v65 offset:38912
    ds_read_b64_tr_b16 v[62:63], v65 offset:39424
    s_waitcnt lgkmcnt(8)
    v_mfma_f32_32x32x16_bf16 v[0:15], v[40:43], v[84:87], v[0:15]
    ds_read_b64_tr_b16 v[32:33], v64 offset:40960
    ds_read_b64_tr_b16 v[34:35], v64 offset:41472
    v_mfma_f32_32x32x16_bf16 v[16:31], v[44:47], v[84:87], v[16:31]
    ds_read_b64_tr_b16 v[36:37], v65 offset:40960
    ds_read_b64_tr_b16 v[38:39], v65 offset:41472
    s_waitcnt lgkmcnt(8)
    v_mfma_f32_32x32x16_bf16 v[0:15], v[48:51], v[88:91], v[0:15]
    ds_read_b64_tr_b16 v[40:41], v64 offset:43008
    ds_read_b64_tr_b16 v[42:43], v64 offset:43520
    v_mfma_f32_32x32x16_bf16 v[16:31], v[52:55], v[88:91], v[16:31]
    ds_read_b64_tr_b16 v[44:45], v65 offset:43008
    ds_read_b64_tr_b16 v[46:47], v65 offset:43520
    s_waitcnt lgkmcnt(8)
    v_mfma_f32_32x32x16_bf16 v[0:15], v[56:59], v[92:95], v[0:15]
    ds_read_b64_tr_b16 v[48:49], v64 offset:45056
    ds_read_b64_tr_b16 v[50:51], v64 offset:45568
    v_mfma_f32_32x32x16_bf16 v[16:31], v[60:63], v[92:95], v[16:31]
    ds_read_b64_tr_b16 v[52:53], v65 offset:45056
    ds_read_b64_tr_b16 v[54:55], v65 offset:45568
    s_waitcnt lgkmcnt(8)
    v_mfma_f32_32x32x16_bf16 v[0:15], v[32:35], v[96:99], v[0:15]
    ds_read_b64_tr_b16 v[56:57], v64 offset:47104
    ds_read_b64_tr_b16 v[58:59], v64 offset:47616
    v_mfma_f32_32x32x16_bf16 v[16:31], v[36:39], v[96:99], v[16:31]
    ds_read_b64_tr_b16 v[60:61], v65 offset:47104
    ds_read_b64_tr_b16 v[62:63], v65 offset:47616
    s_waitcnt lgkmcnt(8)
    v_mfma_f32_32x32x16_bf16 v[0:15], v[40:43], v[100:103], v[0:15]
    s_waitcnt vmcnt(32)
    s_barrier
    ds_read_b64_tr_b16 v[32:33], v64 offset:49152
    ds_read_b64_tr_b16 v[34:35], v64 offset:49664
    v_mfma_f32_32x32x16_bf16 v[16:31], v[44:47], v[100:103], v[16:31]
    ds_read_b64_tr_b16 v[36:37], v65 offset:49152
    ds_read_b64_tr_b16 v[38:39], v65 offset:49664
    s_waitcnt lgkmcnt(8)
    v_mfma_f32_32x32x16_bf16 v[0:15], v[48:51], v[104:107], v[0:15]
    ds_read_b64_tr_b16 v[40:41], v64 offset:51200
    ds_read_b64_tr_b16 v[42:43], v64 offset:51712
    v_mfma_f32_32x32x16_bf16 v[16:31], v[52:55], v[104:107], v[16:31]
    ds_read_b64_tr_b16 v[44:45], v65 offset:51200
    ds_read_b64_tr_b16 v[46:47], v65 offset:51712
    s_waitcnt lgkmcnt(8)
    v_mfma_f32_32x32x16_bf16 v[0:15], v[56:59], v[108:111], v[0:15]
    ds_read_b64_tr_b16 v[48:49], v64 offset:53248
    ds_read_b64_tr_b16 v[50:51], v64 offset:53760
    v_mfma_f32_32x32x16_bf16 v[16:31], v[60:63], v[108:111], v[16:31]
    ds_read_b64_tr_b16 v[52:53], v65 offset:53248
    ds_read_b64_tr_b16 v[54:55], v65 offset:53760
    s_waitcnt vmcnt(0)
    s_waitcnt lgkmcnt(8)
    v_mfma_f32_32x32x16_bf16 v[0:15], v[32:35], v[112:115], v[0:15]
    ds_read_b64_tr_b16 v[56:57], v64 offset:55296
    ds_read_b64_tr_b16 v[58:59], v64 offset:55808
    v_mfma_f32_32x32x16_bf16 v[16:31], v[36:39], v[112:115], v[16:31]
    ds_read_b64_tr_b16 v[60:61], v65 offset:55296
    ds_read_b64_tr_b16 v[62:63], v65 offset:55808
    s_waitcnt lgkmcnt(8)
    v_mfma_f32_32x32x16_bf16 v[0:15], v[40:43], v[116:119], v[0:15]
    ds_read_b64_tr_b16 v[32:33], v64 offset:57344
    ds_read_b64_tr_b16 v[34:35], v64 offset:57856
    v_mfma_f32_32x32x16_bf16 v[16:31], v[44:47], v[116:119], v[16:31]
    ds_read_b64_tr_b16 v[36:37], v65 offset:57344
    ds_read_b64_tr_b16 v[38:39], v65 offset:57856
    s_waitcnt lgkmcnt(8)
    v_mfma_f32_32x32x16_bf16 v[0:15], v[48:51], v[120:123], v[0:15]
    ds_read_b64_tr_b16 v[40:41], v64 offset:59392
    ds_read_b64_tr_b16 v[42:43], v64 offset:59904
    v_mfma_f32_32x32x16_bf16 v[16:31], v[52:55], v[120:123], v[16:31]
    ds_read_b64_tr_b16 v[44:45], v65 offset:59392
    ds_read_b64_tr_b16 v[46:47], v65 offset:59904
    s_waitcnt lgkmcnt(8)
    v_mfma_f32_32x32x16_bf16 v[0:15], v[56:59], v[124:127], v[0:15]
    ds_read_b64_tr_b16 v[48:49], v64 offset:61440
    ds_read_b64_tr_b16 v[50:51], v64 offset:61952
    v_mfma_f32_32x32x16_bf16 v[16:31], v[60:63], v[124:127], v[16:31]
    ds_read_b64_tr_b16 v[52:53], v65 offset:61440
    ds_read_b64_tr_b16 v[54:55], v65 offset:61952
    s_waitcnt lgkmcnt(8)
    v_mfma_f32_32x32x16_bf16 v[0:15], v[32:35], v[128:131], v[0:15]
    ds_read_b64_tr_b16 v[56:57], v64 offset:63488
    ds_read_b64_tr_b16 v[58:59], v64 offset:64000
    v_mfma_f32_32x32x16_bf16 v[16:31], v[36:39], v[128:131], v[16:31]
    ds_read_b64_tr_b16 v[60:61], v65 offset:63488
    ds_read_b64_tr_b16 v[62:63], v65 offset:64000
    s_waitcnt lgkmcnt(8)
    v_mfma_f32_32x32x16_bf16 v[0:15], v[40:43], v[132:135], v[0:15]
    v_mfma_f32_32x32x16_bf16 v[16:31], v[44:47], v[132:135], v[16:31]
    s_waitcnt lgkmcnt(4)
    v_mfma_f32_32x32x16_bf16 v[0:15], v[48:51], v[136:139], v[0:15]
    v_mfma_f32_32x32x16_bf16 v[16:31], v[52:55], v[136:139], v[16:31]
    s_waitcnt lgkmcnt(0)
    v_mfma_f32_32x32x16_bf16 v[0:15], v[56:59], v[140:143], v[0:15]
    v_mfma_f32_32x32x16_bf16 v[16:31], v[60:63], v[140:143], v[16:31]
    s_nop 7
    s_nop 5
    v_cvt_pk_bf16_f32 v80, v0, v1
    v_cvt_pk_bf16_f32 v81, v2, v3
    v_cvt_pk_bf16_f32 v82, v4, v5
    v_cvt_pk_bf16_f32 v83, v6, v7
    v_cvt_pk_bf16_f32 v84, v8, v9
    v_cvt_pk_bf16_f32 v85, v10, v11
    v_cvt_pk_bf16_f32 v86, v12, v13
    v_cvt_pk_bf16_f32 v87, v14, v15
    v_cvt_pk_bf16_f32 v88, v16, v17
    v_cvt_pk_bf16_f32 v89, v18, v19
    v_cvt_pk_bf16_f32 v90, v20, v21
    v_cvt_pk_bf16_f32 v91, v22, v23
    v_cvt_pk_bf16_f32 v92, v24, v25
    v_cvt_pk_bf16_f32 v93, v26, v27
    v_cvt_pk_bf16_f32 v94, v28, v29
    v_cvt_pk_bf16_f32 v95, v30, v31
    s_and_saveexec_b64 s[42:43], s[40:41]
    s_cbranch_execz L_oproj_done
    buffer_store_dwordx4 v[80:83], v78, s[20:23], s28 offen offset:0
    buffer_store_dwordx4 v[84:87], v78, s[20:23], s28 offen offset:32
    buffer_store_dwordx4 v[88:91], v78, s[20:23], s28 offen offset:64
    buffer_store_dwordx4 v[92:95], v78, s[20:23], s28 offen offset:96
L_oproj_done:
    s_endpgm
.section .rodata,"a"
.p2align 6
.amdhsa_kernel attn_kernel
  .amdhsa_next_free_vgpr 256
  .amdhsa_next_free_sgpr 102
  .amdhsa_accum_offset 256
  .amdhsa_group_segment_fixed_size 0
  .amdhsa_kernarg_size 104
  .amdhsa_user_sgpr_count 2
  .amdhsa_user_sgpr_kernarg_segment_ptr 1
  .amdhsa_system_sgpr_workgroup_id_x 1
.end_amdhsa_kernel
.p2align 6
.amdhsa_kernel oproj_kernel
  .amdhsa_next_free_vgpr 176
  .amdhsa_next_free_sgpr 102
  .amdhsa_accum_offset 176
  .amdhsa_group_segment_fixed_size 0
  .amdhsa_kernarg_size 104
  .amdhsa_user_sgpr_count 2
  .amdhsa_user_sgpr_kernarg_segment_ptr 1
  .amdhsa_system_sgpr_workgroup_id_x 1
.end_amdhsa_kernel
```
